```python
import torch

def _softmax(x, axis=-1):
    return torch.softmax(x, dim=axis)
def _gelu(x):
    return torch.nn.functional.gelu(x, approximate="tanh")
def _silu(x):
    return torch.nn.functional.silu(x)
def _sigmoid(x):
    return torch.sigmoid(x)
def _layernorm(x, axis=-1, eps=1e-5):
    m = x.mean(dim=axis, keepdim=True)
    v = x.var(dim=axis, keepdim=True, unbiased=False)
    return (x - m) / torch.sqrt(v + eps)
def _scatter_add(tgt, idx, src, axis=0):
    return tgt.clone().index_add_(axis, idx, src)
def _segment_sum(src, seg, n):
    out = torch.zeros((n,) + src.shape[1:], dtype=src.dtype)
    return out.index_add_(0, seg, src)
def _pad(x, pw):
    flat = tuple(v for pair in reversed(pw) for v in pair)
    return torch.nn.functional.pad(x, flat)

kernel_name = 'interleave_layers__linear_kernel_hedgehog__glu_gated_reglu__prompt'

def setup_inputs():

    _w = (lambda a: (lambda t: t.to(torch.bfloat16) if t.is_floating_point() else t)(torch.as_tensor(a)))
    def _A_setup():
        B, S, D, H = 1, 2048, 640, 32
        Dh = D // H
        return {
            "x": _w((lambda *s: torch.randn(*s, dtype=torch.bfloat16) * 0.05)(B, S, D)),
            "wqkv": _w((lambda *s: torch.randn(*s, dtype=torch.bfloat16) * 0.4)(D, 3 * D)),
            "w_phi": _w((lambda *s: torch.randn(*s, dtype=torch.bfloat16) * 0.4)(H, Dh, Dh) * (Dh ** -0.5)),
            "wo": _w((lambda *s: torch.randn(*s, dtype=torch.bfloat16) * 0.05)(D, D)),
        }
    _A_in = _A_setup()

    def _B_setup():
        B, S, D, F = 1, 2048, 640, 1536
        return {
            "x": _w((lambda *s: torch.randn(*s, dtype=torch.bfloat16) * 0.05)(B, S, D)),
            "W_gate": _w((lambda *s: torch.randn(*s, dtype=torch.bfloat16) * 1.6)(D, F) * (2.0 / D) ** 0.5),
            "W_up": _w((lambda *s: torch.randn(*s, dtype=torch.bfloat16) * 1.6)(D, F) * (2.0 / D) ** 0.5),
            "W_down": _w((lambda *s: torch.randn(*s, dtype=torch.bfloat16) * 1.6)(F, D) * (1.0 / F) ** 0.5),
        }
    _B_in = _B_setup()

    return {
        "A_x": _A_in["x"],
        "A_wqkv": _A_in["wqkv"],
        "A_w_phi": _A_in["w_phi"],
        "A_wo": _A_in["wo"],
        "B_x": _B_in["x"],
        "B_W_gate": _B_in["W_gate"],
        "B_W_up": _B_in["W_up"],
        "B_W_down": _B_in["W_down"],
    }

def reference(A_x, A_wqkv, A_w_phi, A_wo, B_x, B_W_gate, B_W_up, B_W_down):
    def _A_ref(x, wqkv, w_phi, wo):
        B, S, D = x.shape
        H = 32; Dh = D // H
        qkv = (lambda x, *d: x.permute(*d))((x @ wqkv).reshape(B, S, 3, H, Dh), 2, 0, 3, 1, 4)
        q, k, v = qkv[0], qkv[1], qkv[2]
        pq = torch.einsum("bhsd,hdf->bhsf", q, w_phi)
        pk = torch.einsum("bhsd,hdf->bhsf", k, w_phi)
        phi_q = torch.concatenate([_softmax(pq, axis=-1), _softmax(-pq, axis=-1)], axis=-1)
        phi_k = torch.concatenate([_softmax(pk, axis=-1), _softmax(-pk, axis=-1)], axis=-1)
        kv = torch.einsum("bhsf,bhsd->bhfd", phi_k, v)
        z  = torch.einsum("bhsf->bhf", phi_k)
        num = torch.einsum("bhqf,bhfd->bhqd", phi_q, kv)
        den = torch.einsum("bhqf,bhf->bhq", phi_q, z)[..., None] + 1e-6
        o = num / den
        return (lambda x, *d: x.permute(*d))(o, 0, 2, 1, 3).reshape(B, S, D) @ wo

    def _B_ref(x, W_gate, W_up, W_down):
        gate = torch.einsum("bsd,df->bsf", x, W_gate)
        up = torch.einsum("bsd,df->bsf", x, W_up)
        gate = gate * (lambda x, dt: x.to(dt))(gate > 0, gate.dtype)
        h = gate * up
        return torch.einsum("bsf,fd->bsd", h, W_down)

    x = A_x
    x = x + _A_ref(_layernorm(x, axis=-1), A_wqkv, A_w_phi, A_wo)
    x = x + _B_ref(_layernorm(x, axis=-1), B_W_gate, B_W_up, B_W_down)
    x = x + _A_ref(_layernorm(x, axis=-1), A_wqkv, A_w_phi, A_wo)
    x = x + _B_ref(_layernorm(x, axis=-1), B_W_gate, B_W_up, B_W_down)
    return x
```

```asm
; @launch grid=(256,1,1) block=(256,1,1) lds=163840
.amdgcn_target "amdgcn-amd-amdhsa--gfx950"
.text
.globl interleave_layers__linear_kernel_hedgehog__glu_gated_reglu__prompt_kernel
.p2align 8
.type interleave_layers__linear_kernel_hedgehog__glu_gated_reglu__prompt_kernel,@function
interleave_layers__linear_kernel_hedgehog__glu_gated_reglu__prompt_kernel:
	s_cmp_ge_u32 s2, 256
	s_cbranch_scc1 L_exit
	s_load_dwordx16 s[16:31], s[0:1], 0
	s_load_dwordx2 s[32:33], s[0:1], 64
	s_load_dwordx2 s[34:35], s[0:1], 80
	v_lshrrev_b32 v1, 6, v0
	v_and_b32 v0, 63, v0
	v_readfirstlane_b32 s44, v1
	s_and_b32 s84, s2, 7
	s_lshr_b32 s80, s2, 3
	s_lshl_b32 s71, s84, 1
	s_and_b32 s72, s80, 1
	s_add_u32 s45, s71, s72
	s_lshr_b32 s46, s80, 1
	s_lshr_b32 s71, s46, 3
	s_lshl_b32 s71, s71, 2
	s_and_b32 s72, s46, 3
	s_add_u32 s47, s71, s72
	s_bfe_u32 s48, s46, 0x10002
	s_and_b32 s49, s44, 1
	s_lshr_b32 s50, s44, 1
	s_lshl_b32 s51, s44, 12
	s_lshl_b32 s87, s44, 10
	s_mov_b32 s68, 0
	s_mov_b32 s69, 0x400000
	v_lshlrev_b32 v1, 4, v0
	v_and_b32 v56, 15, v0
	v_lshrrev_b32 v57, 4, v0
	v_and_b32 v58, 31, v0
	v_lshrrev_b32 v59, 5, v0
	s_lshl_b32 s71, s45, 2
	s_lshl_b32 s72, s48, 1
	s_add_u32 s71, s71, s72
	s_add_u32 s76, s71, s49
	s_lshl_b32 s71, s76, 5
	s_lshl_b32 s72, s50, 4
	s_add_u32 s71, s71, s72
	s_mul_i32 s71, s71, 1280
	s_mul_i32 s72, s47, 160
	s_add_u32 s71, s71, s72
	v_mul_u32_u24 v60, 1280, v56
	v_add_u32 v60, s71, v60
	v_lshl_add_u32 v10, v57, 4, v60
	v_lshl_add_u32 v11, v57, 3, v60
	v_add_u32 v11, 128, v11
	s_lshl_b32 s75, s44, 14
	s_mov_b32 s83, 40960
	v_mov_b32 v61, 1073741824
	s_lshl_b32 s71, s80, 2
	s_add_u32 s71, s71, s44
	s_mul_i32 s71, s71, 384
	s_getpc_b64 s[100:101]
	s_add_u32 s100, s100, s71
	s_addc_u32 s101, s101, 0
	s_waitcnt lgkmcnt(0)
	s_load_dword s3, s[100:101], 0
	s_load_dword s3, s[100:101], 64
	s_load_dword s3, s[100:101], 128
	s_load_dword s3, s[100:101], 192
	s_load_dword s3, s[100:101], 256
	s_load_dword s3, s[100:101], 320
	s_mov_b32 s4, s34
	s_and_b32 s5, s35, 0xffff
	s_mov_b32 s6, 41066496
	s_mov_b32 s7, 0x20000
	s_mov_b32 s40, s16
	s_and_b32 s41, s17, 0xffff
	s_mov_b32 s42, 2621440
	s_mov_b32 s43, 0x20000
	s_cmp_lt_u32 s2, 80
	s_cbranch_scc1 L_q1
	s_cmp_lt_u32 s2, 160
	s_cbranch_scc1 L_g1
	s_cmp_lt_u32 s2, 228
	s_cbranch_scc1 L_c1
	s_branch L_j1
L_q1:
	s_mov_b32 s12, s18
	s_and_b32 s13, s19, 0xffff
	s_mov_b32 s14, 2457600
	s_mov_b32 s15, 0x20000
	s_lshr_b32 s82, s2, 2
	s_and_b32 s81, s2, 3
	s_lshl_b32 s71, s82, 2
	s_add_u32 s71, s71, s44
	s_mul_i32 s71, s71, 30720
	s_mul_i32 s72, s81, 320
	s_add_u32 s71, s71, s72
	s_mul_i32 s75, s44, 8320
	v_mul_u32_u24 v50, 13, v0
	v_lshrrev_b32 v50, 8, v50
	v_mul_u32_u24 v51, 960, v50
	v_add_u32 v51, v51, v1
	v_cmp_gt_u32 vcc, 60, v0
	s_nop 1
	v_cndmask_b32 v51, v61, v51, vcc
	s_add_u32 m0, s75, 0
	s_nop 0
	buffer_load_dwordx4 v51, s[12:15], s71 offen lds
	s_add_u32 m0, s75, 1040
	s_add_u32 s71, s71, 3840
	buffer_load_dwordx4 v51, s[12:15], s71 offen lds
	s_add_u32 m0, s75, 2080
	s_add_u32 s71, s71, 3840
	buffer_load_dwordx4 v51, s[12:15], s71 offen lds
	s_add_u32 m0, s75, 3120
	s_add_u32 s71, s71, 3840
	buffer_load_dwordx4 v51, s[12:15], s71 offen lds
	s_add_u32 m0, s75, 4160
	s_add_u32 s71, s71, 3840
	buffer_load_dwordx4 v51, s[12:15], s71 offen lds
	s_add_u32 m0, s75, 5200
	s_add_u32 s71, s71, 3840
	buffer_load_dwordx4 v51, s[12:15], s71 offen lds
	s_add_u32 m0, s75, 6240
	s_add_u32 s71, s71, 3840
	buffer_load_dwordx4 v51, s[12:15], s71 offen lds
	s_add_u32 m0, s75, 7280
	s_add_u32 s71, s71, 3840
	buffer_load_dwordx4 v51, s[12:15], s71 offen lds
	s_mov_b32 s36, s20
	s_and_b32 s37, s21, 0xffff
	s_mov_b32 s38, 25600
	s_mov_b32 s39, 0x20000
	s_lshl_b32 s83, s81, 12
	s_lshl_b32 s81, s81, 2
	s_add_u32 s81, s81, s44
	s_lshl_b32 s72, s44, 11
	s_add_u32 m0, s72, 57344
	s_mul_i32 s72, s81, 1600
	buffer_load_dwordx4 v1, s[36:39], s72 offen lds
	buffer_load_dwordx4 v1, s[36:39], s72 offen offset:1024 lds
	s_lshl_b32 s71, s82, 2
	s_add_u32 s83, s83, s71
	s_add_u32 s83, s83, 4096
	s_branch L_j1
L_g1:
	s_mov_b32 s12, s26
	s_and_b32 s13, s27, 0xffff
	s_mov_b32 s14, 1966080
	s_mov_b32 s15, 0x20000
	s_mov_b32 s36, s28
	s_and_b32 s37, s29, 0xffff
	s_mov_b32 s38, 1966080
	s_mov_b32 s39, 0x20000
	s_sub_u32 s74, s2, 80
	s_lshr_b32 s82, s74, 2
	s_and_b32 s81, s74, 3
	s_lshl_b32 s71, s82, 2
	s_add_u32 s71, s71, s44
	s_mul_i32 s71, s71, 24576
	s_mul_i32 s72, s81, 768
	s_add_u32 s71, s71, s72
	s_mul_i32 s75, s44, 6400
	s_mov_b32 exec_hi, 0xffff
	s_add_u32 m0, s75, 0
	s_nop 0
	buffer_load_dwordx4 v1, s[12:15], s71 offen lds
	s_add_u32 m0, s75, 25728
	s_nop 0
	buffer_load_dwordx4 v1, s[36:39], s71 offen lds
	s_add_u32 m0, s75, 800
	s_add_u32 s71, s71, 3072
	buffer_load_dwordx4 v1, s[12:15], s71 offen lds
	s_add_u32 m0, s75, 26528
	s_nop 0
	buffer_load_dwordx4 v1, s[36:39], s71 offen lds
	s_add_u32 m0, s75, 1600
	s_add_u32 s71, s71, 3072
	buffer_load_dwordx4 v1, s[12:15], s71 offen lds
	s_add_u32 m0, s75, 27328
	s_nop 0
	buffer_load_dwordx4 v1, s[36:39], s71 offen lds
	s_add_u32 m0, s75, 2400
	s_add_u32 s71, s71, 3072
	buffer_load_dwordx4 v1, s[12:15], s71 offen lds
	s_add_u32 m0, s75, 28128
	s_nop 0
	buffer_load_dwordx4 v1, s[36:39], s71 offen lds
	s_add_u32 m0, s75, 3200
	s_add_u32 s71, s71, 3072
	buffer_load_dwordx4 v1, s[12:15], s71 offen lds
	s_add_u32 m0, s75, 28928
	s_nop 0
	buffer_load_dwordx4 v1, s[36:39], s71 offen lds
	s_add_u32 m0, s75, 4000
	s_add_u32 s71, s71, 3072
	buffer_load_dwordx4 v1, s[12:15], s71 offen lds
	s_add_u32 m0, s75, 29728
	s_nop 0
	buffer_load_dwordx4 v1, s[36:39], s71 offen lds
	s_add_u32 m0, s75, 4800
	s_add_u32 s71, s71, 3072
	buffer_load_dwordx4 v1, s[12:15], s71 offen lds
	s_add_u32 m0, s75, 30528
	s_nop 0
	buffer_load_dwordx4 v1, s[36:39], s71 offen lds
	s_add_u32 m0, s75, 5600
	s_add_u32 s71, s71, 3072
	buffer_load_dwordx4 v1, s[12:15], s71 offen lds
	s_add_u32 m0, s75, 31328
	s_nop 0
	buffer_load_dwordx4 v1, s[36:39], s71 offen lds
	s_mov_b32 exec_hi, -1
	s_lshl_b32 s83, s81, 12
	s_lshl_b32 s81, s81, 2
	s_add_u32 s81, s81, s44
	s_lshl_b32 s71, s82, 2
	s_add_u32 s83, s83, s71
	s_add_u32 s83, s83, 20480
	s_branch L_j1
L_c1:
	s_sub_u32 s82, s2, 160
	s_lshl_b32 s83, s82, 2
	s_add_u32 s83, s83, 36864
	s_cmp_lt_u32 s82, 20
	s_cselect_b32 s12, s22, s30
	s_cselect_b32 s13, s23, s31
	s_mov_b32 s14, 1966080
	s_cselect_b32 s14, 819200, s14
	s_and_b32 s13, s13, 0xffff
	s_mov_b32 s15, 0x20000
	s_lshl_b32 s71, s82, 2
	s_add_u32 s71, s71, s44
	s_mul_i32 s72, s71, 205
	s_lshr_b32 s72, s72, 10
	s_mul_i32 s73, s72, 5
	s_sub_u32 s73, s71, s73
	s_mul_i32 s72, s72, 40
	s_bitcmp1_b32 s73, 0
	s_cselect_b32 s74, 20, 0
	s_add_u32 s72, s72, s74
	s_lshr_b32 s74, s73, 1
	s_lshl_b32 s74, s74, 3
	s_add_u32 s72, s72, s74
	s_cmp_eq_u32 s73, 4
	s_cselect_b32 s73, 20480, 0
	s_lshl_b32 s71, s71, 3
	s_sub_u32 s71, s71, 640
	s_cmp_lt_u32 s82, 20
	s_cselect_b32 s71, s72, s71
	s_cselect_b32 s72, s73, 0
	s_mul_i32 s71, s71, 1280
	s_mul_i32 s75, s44, 10368
	s_add_u32 m0, s75, 0
	s_nop 0
	buffer_load_dwordx4 v1, s[12:15], s71 offen offset:0 lds
	buffer_load_dwordx4 v1, s[12:15], s71 offen offset:1024 lds
	buffer_load_dwordx4 v1, s[12:15], s71 offen offset:2048 lds
	buffer_load_dwordx4 v1, s[12:15], s71 offen offset:3072 lds
	s_add_u32 m0, s75, 4096
	s_add_u32 s71, s71, 4096
	buffer_load_dwordx4 v1, s[12:15], s71 offen offset:0 lds
	s_add_u32 s71, s71, s72
	s_add_u32 s71, s71, 1024
	s_add_u32 m0, s75, 5120
	s_nop 0
	buffer_load_dwordx4 v1, s[12:15], s71 offen offset:0 lds
	buffer_load_dwordx4 v1, s[12:15], s71 offen offset:1024 lds
	buffer_load_dwordx4 v1, s[12:15], s71 offen offset:2048 lds
	buffer_load_dwordx4 v1, s[12:15], s71 offen offset:3072 lds
	s_add_u32 m0, s75, 9216
	s_add_u32 s71, s71, 4096
	buffer_load_dwordx4 v1, s[12:15], s71 offen offset:0 lds
L_j1:
	buffer_load_dwordx4 v[224:227], v10, s[40:43], 0 offen
	buffer_load_dwordx4 v[228:231], v10, s[40:43], 0 offen offset:64
	buffer_load_dwordx2 v[222:223], v11, s[40:43], 0 offen
	buffer_load_dword v244, off, s[4:7], 0 sc1
	v_add_u32 v46, 0, v0
	v_mul_u32_u24 v47, 205, v46
	v_lshrrev_b32 v47, 13, v47
	v_mul_u32_u24 v48, 40, v47
	v_sub_u32 v46, v46, v48
	v_xor_b32 v46, v46, v47
	v_mul_u32_u24 v47, 1280, v47
	v_lshl_add_u32 v3, v46, 4, v47
	v_add_u32 v46, 64, v0
	v_mul_u32_u24 v47, 205, v46
	v_lshrrev_b32 v47, 13, v47
	v_mul_u32_u24 v48, 40, v47
	v_sub_u32 v46, v46, v48
	v_xor_b32 v46, v46, v47
	v_mul_u32_u24 v47, 1280, v47
	v_lshl_add_u32 v4, v46, 4, v47
	v_add_u32 v46, 128, v0
	v_mul_u32_u24 v47, 205, v46
	v_lshrrev_b32 v47, 13, v47
	v_mul_u32_u24 v48, 40, v47
	v_sub_u32 v46, v46, v48
	v_xor_b32 v46, v46, v47
	v_mul_u32_u24 v47, 1280, v47
	v_lshl_add_u32 v6, v46, 4, v47
	v_add_u32 v46, 192, v0
	v_mul_u32_u24 v47, 205, v46
	v_lshrrev_b32 v47, 13, v47
	v_mul_u32_u24 v48, 40, v47
	v_sub_u32 v46, v46, v48
	v_xor_b32 v46, v46, v47
	v_mul_u32_u24 v47, 1280, v47
	v_lshl_add_u32 v248, v46, 4, v47
	v_add_u32 v46, 256, v0
	v_mul_u32_u24 v47, 205, v46
	v_lshrrev_b32 v47, 13, v47
	v_mul_u32_u24 v48, 40, v47
	v_sub_u32 v46, v46, v48
	v_xor_b32 v46, v46, v47
	v_mul_u32_u24 v47, 1280, v47
	v_lshl_add_u32 v249, v46, 4, v47
	v_add_u32 v3, 4096, v3
	v_add_u32 v4, 3072, v4
	v_add_u32 v6, 2048, v6
	v_add_u32 v248, 1024, v248
	v_add_u32 v249, 4096, v249
	s_sub_u32 s40, s40, 4096
	s_subb_u32 s41, s41, 0
	s_add_u32 s42, s42, 4096
	s_lshl_b32 s97, s45, 2
	s_add_u32 s97, s97, s44
	s_mul_i32 s97, s97, 40960
	s_mul_i32 s86, s44, 20480
	s_add_u32 s86, s86, 81920
	s_add_u32 s73, s46, 0
	s_and_b32 s73, s73, 3
	s_mul_i32 s74, s73, 5120
	s_add_u32 s16, s74, s86
	s_add_u32 s20, s16, 4096
	s_lshl_b32 s74, s74, 1
	s_add_u32 s24, s74, s97
	s_add_u32 s73, s46, 1
	s_and_b32 s73, s73, 3
	s_mul_i32 s74, s73, 5120
	s_add_u32 s17, s74, s86
	s_add_u32 s21, s17, 4096
	s_lshl_b32 s74, s74, 1
	s_add_u32 s25, s74, s97
	s_add_u32 s73, s46, 2
	s_and_b32 s73, s73, 3
	s_mul_i32 s74, s73, 5120
	s_add_u32 s18, s74, s86
	s_add_u32 s22, s18, 4096
	s_lshl_b32 s74, s74, 1
	s_add_u32 s26, s74, s97
	s_add_u32 s73, s46, 3
	s_and_b32 s73, s73, 3
	s_mul_i32 s74, s73, 5120
	s_add_u32 s19, s74, s86
	s_add_u32 s23, s19, 4096
	s_lshl_b32 s74, s74, 1
	s_add_u32 s27, s74, s97
	s_mov_b32 m0, s16
	s_nop 0
	buffer_load_dwordx4 v3, s[40:43], s24 offen offset:0 lds
	buffer_load_dwordx4 v4, s[40:43], s24 offen offset:1024 lds
	buffer_load_dwordx4 v6, s[40:43], s24 offen offset:2048 lds
	buffer_load_dwordx4 v248, s[40:43], s24 offen offset:3072 lds
	v_and_b32 v46, 7, v56
	v_xor_b32 v46, v46, v57
	v_mul_u32_u24 v47, 640, v56
	v_add_u32 v47, s86, v47
	v_xor_b32 v48, 0, v46
	v_lshl_add_u32 v208, v48, 4, v47
	v_xor_b32 v48, 4, v46
	v_lshl_add_u32 v209, v48, 4, v47
	v_lshlrev_b32 v247, 2, v0
	s_cmp_ge_u32 s2, 80
	s_cbranch_scc1 L_j1b
	v_lshrrev_b32 v52, 3, v58
	v_bfe_u32 v53, v58, 2, 1
	v_and_b32 v54, 3, v58
	v_mul_u32_u24 v51, 20, v53
	v_add_u32 v51, v51, v54
	v_lshlrev_b32 v50, 3, v59
	v_sub_u32 v51, v51, v50
	v_lshl_add_u32 v50, v52, 2, v51
	v_add_u32 v51, 16, v51
	v_cmp_eq_u32 vcc, 1, v52
	v_mov_b32 v49, 0x1000
	s_nop 0
	v_cndmask_b32 v51, v49, v51, vcc
	v_and_b32 v46, 1, v50
	v_lshlrev_b32 v46, 4, v46
	v_mov_b32 v47, 0x3f80
	v_lshlrev_b32 v46, v46, v47
	v_ashrrev_i32 v47, 1, v50
	v_cmp_eq_u32 vcc, 0, v47
	s_nop 1
	v_cndmask_b32 v172, 0, v46, vcc
	v_cmp_eq_u32 vcc, 1, v47
	s_nop 1
	v_cndmask_b32 v173, 0, v46, vcc
	v_cmp_eq_u32 vcc, 2, v47
	s_nop 1
	v_cndmask_b32 v174, 0, v46, vcc
	v_cmp_eq_u32 vcc, 3, v47
	s_nop 1
	v_cndmask_b32 v175, 0, v46, vcc
	v_and_b32 v46, 1, v51
	v_lshlrev_b32 v46, 4, v46
	v_mov_b32 v47, 0x3f80
	v_lshlrev_b32 v46, v46, v47
	v_ashrrev_i32 v47, 1, v51
	v_cmp_eq_u32 vcc, 0, v47
	s_nop 1
	v_cndmask_b32 v196, 0, v46, vcc
	v_cmp_eq_u32 vcc, 1, v47
	s_nop 1
	v_cndmask_b32 v197, 0, v46, vcc
	v_cmp_eq_u32 vcc, 2, v47
	s_nop 1
	v_cndmask_b32 v198, 0, v46, vcc
	v_cmp_eq_u32 vcc, 3, v47
	s_nop 1
	v_cndmask_b32 v199, 0, v46, vcc
	v_add_u32 v50, -16, v50
	v_add_u32 v51, -16, v51
	v_and_b32 v46, 1, v50
	v_lshlrev_b32 v46, 4, v46
	v_mov_b32 v47, 0x3f80
	v_lshlrev_b32 v46, v46, v47
	v_ashrrev_i32 v47, 1, v50
	v_cmp_eq_u32 vcc, 0, v47
	s_nop 1
	v_cndmask_b32 v176, 0, v46, vcc
	v_cmp_eq_u32 vcc, 1, v47
	s_nop 1
	v_cndmask_b32 v177, 0, v46, vcc
	v_cmp_eq_u32 vcc, 2, v47
	s_nop 1
	v_cndmask_b32 v178, 0, v46, vcc
	v_cmp_eq_u32 vcc, 3, v47
	s_nop 1
	v_cndmask_b32 v179, 0, v46, vcc
	v_and_b32 v46, 1, v51
	v_lshlrev_b32 v46, 4, v46
	v_mov_b32 v47, 0x3f80
	v_lshlrev_b32 v46, v46, v47
	v_ashrrev_i32 v47, 1, v51
	v_cmp_eq_u32 vcc, 0, v47
	s_nop 1
	v_cndmask_b32 v200, 0, v46, vcc
	v_cmp_eq_u32 vcc, 1, v47
	s_nop 1
	v_cndmask_b32 v201, 0, v46, vcc
	v_cmp_eq_u32 vcc, 2, v47
	s_nop 1
	v_cndmask_b32 v202, 0, v46, vcc
	v_cmp_eq_u32 vcc, 3, v47
	s_nop 1
	v_cndmask_b32 v203, 0, v46, vcc
	v_add_u32 v50, -16, v50
	v_add_u32 v51, -16, v51
	v_and_b32 v46, 1, v50
	v_lshlrev_b32 v46, 4, v46
	v_mov_b32 v47, 0x3f80
	v_lshlrev_b32 v46, v46, v47
	v_ashrrev_i32 v47, 1, v50
	v_cmp_eq_u32 vcc, 0, v47
	s_nop 1
	v_cndmask_b32 v180, 0, v46, vcc
	v_cmp_eq_u32 vcc, 1, v47
	s_nop 1
	v_cndmask_b32 v181, 0, v46, vcc
	v_cmp_eq_u32 vcc, 2, v47
	s_nop 1
	v_cndmask_b32 v182, 0, v46, vcc
	v_cmp_eq_u32 vcc, 3, v47
	s_nop 1
	v_cndmask_b32 v183, 0, v46, vcc
	v_and_b32 v46, 1, v51
	v_lshlrev_b32 v46, 4, v46
	v_mov_b32 v47, 0x3f80
	v_lshlrev_b32 v46, v46, v47
	v_ashrrev_i32 v47, 1, v51
	v_cmp_eq_u32 vcc, 0, v47
	s_nop 1
	v_cndmask_b32 v204, 0, v46, vcc
	v_cmp_eq_u32 vcc, 1, v47
	s_nop 1
	v_cndmask_b32 v205, 0, v46, vcc
	v_cmp_eq_u32 vcc, 2, v47
	s_nop 1
	v_cndmask_b32 v206, 0, v46, vcc
	v_cmp_eq_u32 vcc, 3, v47
	s_nop 1
	v_cndmask_b32 v207, 0, v46, vcc
	v_lshrrev_b32 v60, 4, v58
	v_lshlrev_b32 v60, 4, v60
	v_bfe_u32 v61, v58, 2, 1
	v_lshl_add_u32 v60, v61, 3, v60
	v_bfe_u32 v61, v58, 3, 1
	v_lshl_add_u32 v60, v61, 2, v60
	v_and_b32 v61, 3, v58
	v_add_u32 v60, v60, v61
L_j1b:
	s_waitcnt vmcnt(8)
	s_barrier
	s_cmp_lt_u32 s2, 80
	s_cbranch_scc1 L_q2
	s_cmp_lt_u32 s2, 160
	s_cbranch_scc1 L_g2
	s_cmp_lt_u32 s2, 228
	s_cbranch_scc1 L_c2
	s_branch L_j2
L_q2:
	v_lshrrev_b32 v51, 2, v56
	v_lshl_add_u32 v51, v59, 3, v51
	v_mul_u32_u24 v51, 40, v51
	s_lshl_b32 s71, s44, 11
	s_add_u32 s71, s71, 57344
	v_add_u32 v51, s71, v51
	v_bfe_u32 v50, v56, 1, 1
	s_mov_b32 m0, s20
	s_nop 0
	buffer_load_dwordx4 v249, s[40:43], s24 offen offset:0 lds
	v_and_b32 v49, 1, v57
	v_lshl_add_u32 v50, v49, 1, v50
	v_lshl_add_u32 v50, v50, 3, v51
	ds_read_b64_tr_b16 v[148:149], v50 offset:0
	ds_read_b64_tr_b16 v[150:151], v50 offset:160
	ds_read_b64_tr_b16 v[152:153], v50 offset:640
	ds_read_b64_tr_b16 v[154:155], v50 offset:800
	s_mov_b32 m0, s17
	s_nop 0
	buffer_load_dwordx4 v3, s[40:43], s25 offen offset:0 lds
	ds_read_b64_tr_b16 v[156:157], v50 offset:1280
	ds_read_b64_tr_b16 v[158:159], v50 offset:1440
	ds_read_b64_tr_b16 v[160:161], v51 offset:32
	ds_read_b64_tr_b16 v[162:163], v51 offset:192
	ds_read_b64_tr_b16 v[164:165], v51 offset:672
	ds_read_b64_tr_b16 v[166:167], v51 offset:832
	ds_read_b64_tr_b16 v[168:169], v51 offset:1312
	buffer_load_dwordx4 v4, s[40:43], s25 offen offset:1024 lds
	ds_read_b64_tr_b16 v[170:171], v51 offset:1472
	s_mul_i32 s71, s44, 80
	v_mul_u32_u24 v46, 1040, v60
	v_lshl_add_u32 v46, v59, 4, v46
	v_add_u32 v46, s71, v46
	ds_read_b128 a[24:27], v46 offset:640
	ds_read_b128 a[28:31], v46 offset:672
	buffer_load_dwordx4 v6, s[40:43], s25 offen offset:2048 lds
	ds_read_b128 a[32:35], v46 offset:704
	ds_read_b128 a[12:15], v46 offset:320
	ds_read_b128 a[16:19], v46 offset:352
	ds_read_b128 a[20:23], v46 offset:384
	ds_read_b128 a[0:3], v46 offset:0
	ds_read_b128 a[4:7], v46 offset:32
	ds_read_b128 a[8:11], v46 offset:64
	buffer_load_dwordx4 v248, s[40:43], s25 offen offset:3072 lds
	s_waitcnt lgkmcnt(15)
	s_mov_b32 s78, 0xf0f0f0f
	s_mov_b32 s79, 0xf0f0f0f
	v_cndmask_b32 v148, 0, v148, s[78:79]
	v_cndmask_b32 v149, 0, v149, s[78:79]
	s_mov_b32 s78, 0xf0f0f0f
	s_mov_b32 s79, 0xf0f0f0f
	v_cndmask_b32 v150, 0, v150, s[78:79]
	s_mov_b32 m0, s21
	s_nop 0
	buffer_load_dwordx4 v249, s[40:43], s25 offen offset:0 lds
	v_cndmask_b32 v151, 0, v151, s[78:79]
	s_mov_b32 s78, 0xf0f0f0f
	s_mov_b32 s79, 0xf0f0f0f0
	v_cndmask_b32 v152, 0, v152, s[78:79]
	v_cndmask_b32 v153, 0, v153, s[78:79]
	s_mov_b32 s78, 0xf0f0f0f0
	s_mov_b32 s79, 0xf0f0f0f0
	v_cndmask_b32 v154, 0, v154, s[78:79]
	s_mov_b32 m0, s18
	s_nop 0
	buffer_load_dwordx4 v3, s[40:43], s26 offen offset:0 lds
	v_cndmask_b32 v155, 0, v155, s[78:79]
	s_mov_b32 s78, 0xf0f0f0f0
	s_mov_b32 s79, 0x0
	v_cndmask_b32 v156, 0, v156, s[78:79]
	v_cndmask_b32 v157, 0, v157, s[78:79]
	s_mov_b32 s78, 0xf0f0f0f0
	s_mov_b32 s79, 0x0
	v_cndmask_b32 v158, 0, v158, s[78:79]
	buffer_load_dwordx4 v4, s[40:43], s26 offen offset:1024 lds
	v_cndmask_b32 v159, 0, v159, s[78:79]
	s_waitcnt lgkmcnt(6)
	v_mfma_f32_32x32x16_bf16 v[80:95], a[24:27], v[172:175], 0
	v_mfma_f32_32x32x16_bf16 v[80:95], a[28:31], v[176:179], v[80:95]
	v_mfma_f32_32x32x16_bf16 v[80:95], a[32:35], v[180:183], v[80:95]
	v_mfma_f32_32x32x16_bf16 v[96:111], a[24:27], v[196:199], 0
	v_mfma_f32_32x32x16_bf16 v[96:111], a[28:31], v[200:203], v[96:111]
	v_mfma_f32_32x32x16_bf16 v[96:111], a[32:35], v[204:207], v[96:111]
	buffer_load_dwordx4 v6, s[40:43], s26 offen offset:2048 lds
	s_mov_b32 s78, 0xf0000
	s_mov_b32 s79, 0xf0000
	v_cndmask_b32 v184, 0, v160, s[78:79]
	v_cndmask_b32 v185, 0, v161, s[78:79]
	s_mov_b32 s78, 0xf0000
	s_mov_b32 s79, 0xf0000
	v_cndmask_b32 v186, 0, v162, s[78:79]
	buffer_load_dwordx4 v248, s[40:43], s26 offen offset:3072 lds
	v_cndmask_b32 v187, 0, v163, s[78:79]
	s_mov_b32 s78, 0xf0000
	s_mov_b32 s79, 0xf00000
	v_cndmask_b32 v188, 0, v164, s[78:79]
	v_cndmask_b32 v189, 0, v165, s[78:79]
	s_mov_b32 s78, 0xf00000
	s_mov_b32 s79, 0xf00000
	v_cndmask_b32 v190, 0, v166, s[78:79]
	s_mov_b32 m0, s22
	s_nop 0
	buffer_load_dwordx4 v249, s[40:43], s26 offen offset:0 lds
	v_cndmask_b32 v191, 0, v167, s[78:79]
	s_mov_b32 s78, 0xf00000
	s_mov_b32 s79, 0x0
	v_cndmask_b32 v192, 0, v168, s[78:79]
	v_cndmask_b32 v193, 0, v169, s[78:79]
	s_mov_b32 s78, 0xf00000
	s_mov_b32 s79, 0x0
	v_cndmask_b32 v194, 0, v170, s[78:79]
	s_mov_b32 m0, s19
	s_nop 0
	buffer_load_dwordx4 v3, s[40:43], s27 offen offset:0 lds
	v_cndmask_b32 v195, 0, v171, s[78:79]
	s_waitcnt lgkmcnt(0)
	v_mfma_f32_32x32x16_bf16 v[64:79], a[12:15], v[148:151], 0
	v_mfma_f32_32x32x16_bf16 v[64:79], a[16:19], v[152:155], v[64:79]
	v_mfma_f32_32x32x16_bf16 v[64:79], a[20:23], v[156:159], v[64:79]
	v_mfma_f32_32x32x16_bf16 v[112:127], a[0:3], v[148:151], 0
	v_mfma_f32_32x32x16_bf16 v[112:127], a[4:7], v[152:155], v[112:127]
	v_mfma_f32_32x32x16_bf16 v[112:127], a[8:11], v[156:159], v[112:127]
	buffer_load_dwordx4 v4, s[40:43], s27 offen offset:1024 lds
	s_mov_b32 s78, 0xf
	s_mov_b32 s79, 0xf
	v_cndmask_b32 v160, 0, v160, s[78:79]
	v_cndmask_b32 v161, 0, v161, s[78:79]
	s_mov_b32 s78, 0xf
	s_mov_b32 s79, 0xf
	v_cndmask_b32 v162, 0, v162, s[78:79]
	buffer_load_dwordx4 v6, s[40:43], s27 offen offset:2048 lds
	v_cndmask_b32 v163, 0, v163, s[78:79]
	s_mov_b32 s78, 0xf
	s_mov_b32 s79, 0xf0
	v_cndmask_b32 v164, 0, v164, s[78:79]
	v_cndmask_b32 v165, 0, v165, s[78:79]
	s_mov_b32 s78, 0xf0
	s_mov_b32 s79, 0xf0
	v_cndmask_b32 v166, 0, v166, s[78:79]
	buffer_load_dwordx4 v248, s[40:43], s27 offen offset:3072 lds
	v_cndmask_b32 v167, 0, v167, s[78:79]
	s_mov_b32 s78, 0xf0
	s_mov_b32 s79, 0x0
	v_cndmask_b32 v168, 0, v168, s[78:79]
	v_cndmask_b32 v169, 0, v169, s[78:79]
	s_mov_b32 s78, 0xf0
	s_mov_b32 s79, 0x0
	v_cndmask_b32 v170, 0, v170, s[78:79]
	s_mov_b32 m0, s23
	s_nop 0
	buffer_load_dwordx4 v249, s[40:43], s27 offen offset:0 lds
	v_cndmask_b32 v171, 0, v171, s[78:79]
	v_mfma_f32_32x32x16_bf16 v[96:111], a[0:3], v[184:187], v[96:111]
	v_mfma_f32_32x32x16_bf16 v[96:111], a[4:7], v[188:191], v[96:111]
	v_mfma_f32_32x32x16_bf16 v[96:111], a[8:11], v[192:195], v[96:111]
	v_mfma_f32_32x32x16_bf16 v[96:111], a[12:15], v[160:163], v[96:111]
	v_mfma_f32_32x32x16_bf16 v[96:111], a[16:19], v[164:167], v[96:111]
	v_mfma_f32_32x32x16_bf16 v[96:111], a[20:23], v[168:171], v[96:111]
	s_mul_i32 s71, s81, 163840
	s_add_u32 s71, s71, 475136
	s_mul_i32 s72, s82, 6144
	s_add_u32 s72, s72, s71
	s_add_u32 s73, s72, 4096
	s_lshl_b32 s74, s82, 11
	s_add_u32 s71, s71, s74
	s_add_u32 s71, s71, 122880
	v_lshrrev_b32 v46, 4, v58
	v_lshlrev_b32 v46, 10, v46
	v_lshl_add_u32 v46, v59, 8, v46
	v_bfe_u32 v47, v58, 2, 1
	v_lshl_add_u32 v46, v47, 7, v46
	v_bfe_u32 v47, v58, 3, 1
	v_lshl_add_u32 v46, v47, 6, v46
	v_and_b32 v47, 3, v58
	v_lshl_add_u32 v210, v47, 4, v46
	v_cvt_pk_bf16_f32 v40, v80, v81
	v_cvt_pk_bf16_f32 v41, v82, v83
	v_cvt_pk_bf16_f32 v42, v84, v85
	v_cvt_pk_bf16_f32 v43, v86, v87
	buffer_store_dwordx4 v[40:43], v210, s[4:7], s72 offen offset:2048 sc1
	v_cvt_pk_bf16_f32 v44, v88, v89
	v_cvt_pk_bf16_f32 v45, v90, v91
	v_cvt_pk_bf16_f32 v46, v92, v93
	v_cvt_pk_bf16_f32 v47, v94, v95
	buffer_store_dwordx4 v[44:47], v210, s[4:7], s72 offen offset:2560 sc1
	v_cvt_pk_bf16_f32 v32, v64, v65
	v_cvt_pk_bf16_f32 v33, v66, v67
	v_cvt_pk_bf16_f32 v34, v68, v69
	v_cvt_pk_bf16_f32 v35, v70, v71
	buffer_store_dwordx4 v[32:35], v210, s[4:7], s72 offen offset:0 sc1
	v_cvt_pk_bf16_f32 v36, v72, v73
	v_cvt_pk_bf16_f32 v37, v74, v75
	v_cvt_pk_bf16_f32 v38, v76, v77
	v_cvt_pk_bf16_f32 v39, v78, v79
	buffer_store_dwordx4 v[36:39], v210, s[4:7], s72 offen offset:512 sc1
	v_cvt_pk_bf16_f32 v56, v112, v113
	v_cvt_pk_bf16_f32 v57, v114, v115
	v_cvt_pk_bf16_f32 v58, v116, v117
	v_cvt_pk_bf16_f32 v59, v118, v119
	buffer_store_dwordx4 v[56:59], v210, s[4:7], s71 offen offset:0 sc1
	v_cvt_pk_bf16_f32 v60, v120, v121
	v_cvt_pk_bf16_f32 v61, v122, v123
	v_cvt_pk_bf16_f32 v62, v124, v125
	v_cvt_pk_bf16_f32 v63, v126, v127
	buffer_store_dwordx4 v[60:63], v210, s[4:7], s71 offen offset:512 sc1
	v_cvt_pk_bf16_f32 v48, v96, v97
	v_cvt_pk_bf16_f32 v49, v98, v99
	v_cvt_pk_bf16_f32 v50, v100, v101
	v_cvt_pk_bf16_f32 v51, v102, v103
	buffer_store_dwordx4 v[48:51], v210, s[4:7], s73 offen offset:0 sc1
	v_cvt_pk_bf16_f32 v52, v104, v105
	v_cvt_pk_bf16_f32 v53, v106, v107
	v_cvt_pk_bf16_f32 v54, v108, v109
	v_cvt_pk_bf16_f32 v55, v110, v111
	buffer_store_dwordx4 v[52:55], v210, s[4:7], s73 offen offset:512 sc1
	v_mov_b32 v140, 0x3f803f80
	v_dot2_f32_bf16 v128, v32, v140, 0
	v_dot2_f32_bf16 v129, v40, v140, 0
	v_dot2_f32_bf16 v130, v48, v140, 0
	v_dot2_f32_bf16 v131, v56, v140, 0
	v_dot2_f32_bf16 v132, v36, v140, 0
	v_dot2_f32_bf16 v133, v44, v140, 0
	v_dot2_f32_bf16 v134, v52, v140, 0
	v_dot2_f32_bf16 v135, v60, v140, 0
	v_dot2_f32_bf16 v128, v33, v140, v128
	v_dot2_f32_bf16 v129, v41, v140, v129
	v_dot2_f32_bf16 v130, v49, v140, v130
	v_dot2_f32_bf16 v131, v57, v140, v131
	v_dot2_f32_bf16 v132, v37, v140, v132
	v_dot2_f32_bf16 v133, v45, v140, v133
	v_dot2_f32_bf16 v134, v53, v140, v134
	v_dot2_f32_bf16 v135, v61, v140, v135
	v_dot2_f32_bf16 v128, v34, v140, v128
	v_dot2_f32_bf16 v129, v42, v140, v129
	v_dot2_f32_bf16 v130, v50, v140, v130
	v_dot2_f32_bf16 v131, v58, v140, v131
	v_dot2_f32_bf16 v132, v38, v140, v132
	v_dot2_f32_bf16 v133, v46, v140, v133
	v_dot2_f32_bf16 v134, v54, v140, v134
	v_dot2_f32_bf16 v135, v62, v140, v135
	v_dot2_f32_bf16 v128, v35, v140, v128
	v_dot2_f32_bf16 v129, v43, v140, v129
	v_dot2_f32_bf16 v130, v51, v140, v130
	v_dot2_f32_bf16 v131, v59, v140, v131
	v_dot2_f32_bf16 v132, v39, v140, v132
	v_dot2_f32_bf16 v133, v47, v140, v133
	v_dot2_f32_bf16 v134, v55, v140, v134
	v_dot2_f32_bf16 v135, v63, v140, v135
	s_nop 0
	v_pk_add_f32 v[128:129], v[128:129], v[132:133]
	s_nop 0
	v_pk_add_f32 v[130:131], v[130:131], v[134:135]
	s_mul_i32 s72, s81, 25600
	s_mul_i32 s73, s82, 1280
	s_add_u32 s72, s72, s73
	s_add_u32 s72, s72, 49152
	v_permlane32_swap_b32 v128, v129
	v_permlane32_swap_b32 v130, v131
	v_add_f32 v128, v128, v129
	buffer_store_dword v128, v247, s[4:7], s72 offen offset:0 sc1
	v_add_f32 v130, v130, v131
	buffer_store_dword v130, v247, s[4:7], s72 offen offset:256 sc1
	s_waitcnt vmcnt(10)
	s_branch L_j3
L_g2:
	v_lshrrev_b32 v46, 2, v56
	v_lshl_add_u32 v46, v57, 3, v46
	v_mul_u32_u24 v46, 800, v46
	v_and_b32 v47, 3, v56
	v_lshl_add_u32 v46, v47, 4, v46
	s_mul_i32 s71, s44, 192
	v_add_u32 v46, s71, v46
	s_mov_b32 m0, s20
	s_nop 0
	buffer_load_dwordx4 v249, s[40:43], s24 offen offset:0 lds
	ds_read_b64_tr_b16 v[64:65], v46 offset:0
	ds_read_b64_tr_b16 v[66:67], v46 offset:3200
	ds_read_b64_tr_b16 v[68:69], v46 offset:25728
	ds_read_b64_tr_b16 v[70:71], v46 offset:28928
	ds_read_b64_tr_b16 v[72:73], v46 offset:8
	ds_read_b64_tr_b16 v[74:75], v46 offset:3208
	s_mov_b32 m0, s17
	s_nop 0
	buffer_load_dwordx4 v3, s[40:43], s25 offen offset:0 lds
	ds_read_b64_tr_b16 v[76:77], v46 offset:25736
	ds_read_b64_tr_b16 v[78:79], v46 offset:28936
	ds_read_b64_tr_b16 v[80:81], v46 offset:64
	ds_read_b64_tr_b16 v[82:83], v46 offset:3264
	ds_read_b64_tr_b16 v[84:85], v46 offset:25792
	ds_read_b64_tr_b16 v[86:87], v46 offset:28992
	buffer_load_dwordx4 v4, s[40:43], s25 offen offset:1024 lds
	ds_read_b64_tr_b16 v[88:89], v46 offset:72
	ds_read_b64_tr_b16 v[90:91], v46 offset:3272
	ds_read_b64_tr_b16 v[92:93], v46 offset:25800
	ds_read_b64_tr_b16 v[94:95], v46 offset:29000
	ds_read_b64_tr_b16 v[96:97], v46 offset:128
	ds_read_b64_tr_b16 v[98:99], v46 offset:3328
	buffer_load_dwordx4 v6, s[40:43], s25 offen offset:2048 lds
	ds_read_b64_tr_b16 v[100:101], v46 offset:25856
	ds_read_b64_tr_b16 v[102:103], v46 offset:29056
	ds_read_b64_tr_b16 v[104:105], v46 offset:136
	ds_read_b64_tr_b16 v[106:107], v46 offset:3336
	ds_read_b64_tr_b16 v[108:109], v46 offset:25864
	ds_read_b64_tr_b16 v[110:111], v46 offset:29064
	buffer_load_dwordx4 v248, s[40:43], s25 offen offset:3072 lds
	s_mul_i32 s71, s81, 245760
	s_add_u32 s71, s71, 3915776
	s_mul_i32 s72, s82, 6144
	s_add_u32 s72, s72, s71
	s_add_u32 s73, s72, 4096
	s_lshl_b32 s74, s82, 12
	s_add_u32 s74, s74, s71
	s_add_u32 s74, s74, 122880
	s_lshl_b32 s75, s82, 11
	s_add_u32 s71, s71, s75
	s_add_u32 s71, s71, 204800
	v_mov_b32 v47, 0x3f803f80
	s_mov_b32 m0, s21
	s_nop 0
	buffer_load_dwordx4 v249, s[40:43], s25 offen offset:0 lds
	s_mov_b32 m0, s18
	s_nop 0
	buffer_load_dwordx4 v3, s[40:43], s26 offen offset:0 lds
	buffer_load_dwordx4 v4, s[40:43], s26 offen offset:1024 lds
	buffer_load_dwordx4 v6, s[40:43], s26 offen offset:2048 lds
	buffer_load_dwordx4 v248, s[40:43], s26 offen offset:3072 lds
	s_mov_b32 m0, s22
	s_nop 0
	buffer_load_dwordx4 v249, s[40:43], s26 offen offset:0 lds
	s_mov_b32 m0, s19
	s_nop 0
	buffer_load_dwordx4 v3, s[40:43], s27 offen offset:0 lds
	buffer_load_dwordx4 v4, s[40:43], s27 offen offset:1024 lds
	buffer_load_dwordx4 v6, s[40:43], s27 offen offset:2048 lds
	buffer_load_dwordx4 v248, s[40:43], s27 offen offset:3072 lds
	s_mov_b32 m0, s23
	s_nop 0
	buffer_load_dwordx4 v249, s[40:43], s27 offen offset:0 lds
	s_waitcnt lgkmcnt(15)
	buffer_store_dwordx4 v[64:67], v1, s[4:7], s72 offen offset:0 sc1
	buffer_store_dwordx4 v[68:71], v1, s[4:7], s72 offen offset:1024 sc1
	buffer_store_dwordx4 v[72:75], v1, s[4:7], s72 offen offset:2048 sc1
	buffer_store_dwordx4 v[76:79], v1, s[4:7], s72 offen offset:3072 sc1
	s_waitcnt lgkmcnt(14)
	buffer_store_dwordx4 v[80:83], v1, s[4:7], s73 offen offset:0 sc1
	s_waitcnt lgkmcnt(12)
	buffer_store_dwordx4 v[84:87], v1, s[4:7], s73 offen offset:1024 sc1
	s_waitcnt lgkmcnt(10)
	buffer_store_dwordx4 v[88:91], v1, s[4:7], s74 offen offset:0 sc1
	s_waitcnt lgkmcnt(8)
	buffer_store_dwordx4 v[92:95], v1, s[4:7], s74 offen offset:1024 sc1
	s_waitcnt lgkmcnt(6)
	buffer_store_dwordx4 v[96:99], v1, s[4:7], s74 offen offset:2048 sc1
	s_waitcnt lgkmcnt(4)
	buffer_store_dwordx4 v[100:103], v1, s[4:7], s74 offen offset:3072 sc1
	s_waitcnt lgkmcnt(2)
	buffer_store_dwordx4 v[104:107], v1, s[4:7], s71 offen offset:0 sc1
	s_waitcnt lgkmcnt(0)
	buffer_store_dwordx4 v[108:111], v1, s[4:7], s71 offen offset:1024 sc1
	v_dot2_f32_bf16 v128, v64, v47, 0
	v_dot2_f32_bf16 v129, v68, v47, 0
	v_dot2_f32_bf16 v130, v72, v47, 0
	v_dot2_f32_bf16 v131, v76, v47, 0
	v_dot2_f32_bf16 v132, v80, v47, 0
	v_dot2_f32_bf16 v133, v84, v47, 0
	v_dot2_f32_bf16 v134, v88, v47, 0
	v_dot2_f32_bf16 v135, v92, v47, 0
	v_dot2_f32_bf16 v136, v96, v47, 0
	v_dot2_f32_bf16 v137, v100, v47, 0
	v_dot2_f32_bf16 v138, v104, v47, 0
	v_dot2_f32_bf16 v139, v108, v47, 0
	v_dot2_f32_bf16 v128, v65, v47, v128
	v_dot2_f32_bf16 v129, v69, v47, v129
	v_dot2_f32_bf16 v130, v73, v47, v130
	v_dot2_f32_bf16 v131, v77, v47, v131
	v_dot2_f32_bf16 v132, v81, v47, v132
	v_dot2_f32_bf16 v133, v85, v47, v133
	v_dot2_f32_bf16 v134, v89, v47, v134
	v_dot2_f32_bf16 v135, v93, v47, v135
	v_dot2_f32_bf16 v136, v97, v47, v136
	v_dot2_f32_bf16 v137, v101, v47, v137
	v_dot2_f32_bf16 v138, v105, v47, v138
	v_dot2_f32_bf16 v139, v109, v47, v139
	v_dot2_f32_bf16 v128, v66, v47, v128
	v_dot2_f32_bf16 v129, v70, v47, v129
	v_dot2_f32_bf16 v130, v74, v47, v130
	v_dot2_f32_bf16 v131, v78, v47, v131
	v_dot2_f32_bf16 v132, v82, v47, v132
	v_dot2_f32_bf16 v133, v86, v47, v133
	v_dot2_f32_bf16 v134, v90, v47, v134
	v_dot2_f32_bf16 v135, v94, v47, v135
	v_dot2_f32_bf16 v136, v98, v47, v136
	v_dot2_f32_bf16 v137, v102, v47, v137
	v_dot2_f32_bf16 v138, v106, v47, v138
	v_dot2_f32_bf16 v139, v110, v47, v139
	v_dot2_f32_bf16 v128, v67, v47, v128
	v_dot2_f32_bf16 v129, v71, v47, v129
	v_dot2_f32_bf16 v130, v75, v47, v130
	v_dot2_f32_bf16 v131, v79, v47, v131
	v_dot2_f32_bf16 v132, v83, v47, v132
	v_dot2_f32_bf16 v133, v87, v47, v133
	v_dot2_f32_bf16 v134, v91, v47, v134
	v_dot2_f32_bf16 v135, v95, v47, v135
	v_dot2_f32_bf16 v136, v99, v47, v136
	v_dot2_f32_bf16 v137, v103, v47, v137
	v_dot2_f32_bf16 v138, v107, v47, v138
	v_dot2_f32_bf16 v139, v111, v47, v139
	v_permlane32_swap_b32 v128, v130
	v_permlane32_swap_b32 v129, v131
	v_permlane32_swap_b32 v132, v134
	v_permlane32_swap_b32 v133, v135
	v_permlane32_swap_b32 v136, v138
	v_permlane32_swap_b32 v137, v139
	v_add_f32 v128, v128, v130
	v_add_f32 v129, v129, v131
	v_add_f32 v132, v132, v134
	v_add_f32 v133, v133, v135
	v_add_f32 v136, v136, v138
	v_add_f32 v137, v137, v139
	s_mul_i32 s72, s81, 25600
	s_mul_i32 s73, s82, 1280
	s_add_u32 s72, s72, s73
	s_add_u32 s72, s72, 49664
	v_permlane16_swap_b32 v128, v129
	v_permlane16_swap_b32 v132, v133
	v_permlane16_swap_b32 v136, v137
	v_add_f32 v128, v128, v129
	buffer_store_dword v128, v247, s[4:7], s72 offen offset:0 sc1
	v_add_f32 v132, v132, v133
	buffer_store_dword v132, v247, s[4:7], s72 offen offset:256 sc1
	v_add_f32 v136, v136, v137
	buffer_store_dword v136, v247, s[4:7], s72 offen offset:512 sc1
	s_waitcnt vmcnt(15)
	s_branch L_j3
L_c2:
	v_lshrrev_b32 v46, 2, v56
	v_mul_u32_u24 v46, 1280, v46
	v_mul_u32_u24 v47, 10368, v57
	v_add_u32 v46, v46, v47
	s_mul_i32 s71, s44, 320
	v_add_u32 v46, s71, v46
	s_mov_b32 m0, s20
	s_nop 0
	buffer_load_dwordx4 v249, s[40:43], s24 offen offset:0 lds
	v_and_b32 v47, 3, v56
	v_lshl_add_u32 v50, v47, 4, v46
	v_lshl_add_u32 v51, v47, 3, v46
	ds_read_b64_tr_b16 v[64:65], v50 offset:0
	ds_read_b64_tr_b16 v[66:67], v50 offset:5120
	ds_read_b64_tr_b16 v[68:69], v50 offset:8
	s_mov_b32 m0, s17
	s_nop 0
	buffer_load_dwordx4 v3, s[40:43], s25 offen offset:0 lds
	ds_read_b64_tr_b16 v[70:71], v50 offset:5128
	ds_read_b64_tr_b16 v[72:73], v50 offset:64
	ds_read_b64_tr_b16 v[74:75], v50 offset:5184
	ds_read_b64_tr_b16 v[76:77], v50 offset:72
	ds_read_b64_tr_b16 v[78:79], v50 offset:5192
	ds_read_b64_tr_b16 v[80:81], v51 offset:128
	buffer_load_dwordx4 v4, s[40:43], s25 offen offset:1024 lds
	ds_read_b64_tr_b16 v[82:83], v51 offset:5248
	ds_read_b64_tr_b16 v[84:85], v50 offset:160
	ds_read_b64_tr_b16 v[86:87], v50 offset:5280
	ds_read_b64_tr_b16 v[88:89], v50 offset:168
	ds_read_b64_tr_b16 v[90:91], v50 offset:5288
	ds_read_b64_tr_b16 v[92:93], v50 offset:224
	buffer_load_dwordx4 v6, s[40:43], s25 offen offset:2048 lds
	ds_read_b64_tr_b16 v[94:95], v50 offset:5344
	ds_read_b64_tr_b16 v[96:97], v50 offset:232
	ds_read_b64_tr_b16 v[98:99], v50 offset:5352
	ds_read_b64_tr_b16 v[100:101], v51 offset:288
	ds_read_b64_tr_b16 v[102:103], v51 offset:5408
	s_sub_u32 s71, s82, 20
	s_cselect_b32 s71, s82, s71
	s_mov_b32 s73, 245760
	s_cselect_b32 s73, 102400, s73
	s_mov_b32 s74, 7847936
	s_cselect_b32 s74, 3096576, s74
	s_cbranch_scc1 L_c2o
	s_mul_i32 s72, s71, 171
	s_lshr_b32 s72, s72, 9
	s_sub_u32 s71, s71, s72
	s_add_u32 s71, s71, 15
	s_lshl_b32 s85, s72, 1
	s_add_u32 s85, s85, 15
	s_cmp_eq_u32 s71, s85
	s_cselect_b32 s71, s72, s71
L_c2o:
	s_lshl_b32 s75, s44, 1
	s_mul_i32 s75, s75, s73
	s_add_u32 s75, s75, s74
	s_mul_i32 s71, s71, 5120
	s_add_u32 s71, s71, s75
	buffer_load_dwordx4 v248, s[40:43], s25 offen offset:3072 lds
	s_mov_b32 m0, s21
	s_nop 0
	buffer_load_dwordx4 v249, s[40:43], s25 offen offset:0 lds
	s_mov_b32 m0, s18
	s_nop 0
	buffer_load_dwordx4 v3, s[40:43], s26 offen offset:0 lds
	buffer_load_dwordx4 v4, s[40:43], s26 offen offset:1024 lds
	buffer_load_dwordx4 v6, s[40:43], s26 offen offset:2048 lds
	buffer_load_dwordx4 v248, s[40:43], s26 offen offset:3072 lds
	s_mov_b32 m0, s22
	s_nop 0
	buffer_load_dwordx4 v249, s[40:43], s26 offen offset:0 lds
	s_mov_b32 m0, s19
	s_nop 0
	buffer_load_dwordx4 v3, s[40:43], s27 offen offset:0 lds
	buffer_load_dwordx4 v4, s[40:43], s27 offen offset:1024 lds
	buffer_load_dwordx4 v6, s[40:43], s27 offen offset:2048 lds
	buffer_load_dwordx4 v248, s[40:43], s27 offen offset:3072 lds
	s_mov_b32 m0, s23
	s_nop 0
	buffer_load_dwordx4 v249, s[40:43], s27 offen offset:0 lds
	s_waitcnt lgkmcnt(10)
	buffer_store_dwordx4 v[64:67], v1, s[4:7], s71 offen offset:0 sc1
	buffer_store_dwordx4 v[68:71], v1, s[4:7], s71 offen offset:1024 sc1
	buffer_store_dwordx4 v[72:75], v1, s[4:7], s71 offen offset:2048 sc1
	buffer_store_dwordx4 v[76:79], v1, s[4:7], s71 offen offset:3072 sc1
	s_add_u32 s72, s71, 4096
	buffer_store_dwordx4 v[80:83], v1, s[4:7], s72 offen offset:0 sc1
	s_add_u32 s71, s71, s73
	s_waitcnt lgkmcnt(0)
	buffer_store_dwordx4 v[84:87], v1, s[4:7], s71 offen offset:0 sc1
	buffer_store_dwordx4 v[88:91], v1, s[4:7], s71 offen offset:1024 sc1
	buffer_store_dwordx4 v[92:95], v1, s[4:7], s71 offen offset:2048 sc1
	buffer_store_dwordx4 v[96:99], v1, s[4:7], s71 offen offset:3072 sc1
	s_add_u32 s72, s71, 4096
	buffer_store_dwordx4 v[100:103], v1, s[4:7], s72 offen offset:0 sc1
	s_waitcnt vmcnt(10)
	s_branch L_j3
L_j2:
	s_mov_b32 m0, s20
	s_nop 0
	buffer_load_dwordx4 v249, s[40:43], s24 offen offset:0 lds
	s_mov_b32 m0, s17
	s_nop 0
	buffer_load_dwordx4 v3, s[40:43], s25 offen offset:0 lds
	buffer_load_dwordx4 v4, s[40:43], s25 offen offset:1024 lds
	buffer_load_dwordx4 v6, s[40:43], s25 offen offset:2048 lds
	buffer_load_dwordx4 v248, s[40:43], s25 offen offset:3072 lds
	s_mov_b32 m0, s21
	s_nop 0
	buffer_load_dwordx4 v249, s[40:43], s25 offen offset:0 lds
	s_mov_b32 m0, s18
	s_nop 0
	buffer_load_dwordx4 v3, s[40:43], s26 offen offset:0 lds
	buffer_load_dwordx4 v4, s[40:43], s26 offen offset:1024 lds
	buffer_load_dwordx4 v6, s[40:43], s26 offen offset:2048 lds
	buffer_load_dwordx4 v248, s[40:43], s26 offen offset:3072 lds
	s_mov_b32 m0, s22
	s_nop 0
	buffer_load_dwordx4 v249, s[40:43], s26 offen offset:0 lds
	s_mov_b32 m0, s19
	s_nop 0
	buffer_load_dwordx4 v3, s[40:43], s27 offen offset:0 lds
	buffer_load_dwordx4 v4, s[40:43], s27 offen offset:1024 lds
	buffer_load_dwordx4 v6, s[40:43], s27 offen offset:2048 lds
	buffer_load_dwordx4 v248, s[40:43], s27 offen offset:3072 lds
	s_mov_b32 m0, s23
	s_nop 0
	buffer_load_dwordx4 v249, s[40:43], s27 offen offset:0 lds
	s_waitcnt vmcnt(0)
L_j3:
	s_barrier
	ds_read_b128 a[0:3], v208 offset:0
	ds_read_b128 a[4:7], v208 offset:10240
	ds_read_b128 a[8:11], v209 offset:0
	ds_read_b128 a[12:15], v209 offset:10240
	ds_read_b128 a[16:19], v208 offset:128
	ds_read_b128 a[20:23], v208 offset:10368
	ds_read_b128 a[24:27], v209 offset:128
	ds_read_b128 a[28:31], v209 offset:10368
	ds_read_b128 a[32:35], v208 offset:256
	ds_read_b128 a[36:39], v208 offset:10496
	ds_read_b128 a[40:43], v209 offset:256
	ds_read_b128 a[44:47], v209 offset:10496
	ds_read_b128 a[48:51], v208 offset:384
	ds_read_b128 a[52:55], v208 offset:10624
	ds_read_b128 a[56:59], v209 offset:384
	ds_read_b128 a[60:63], v209 offset:10624
	ds_read_b128 a[64:67], v208 offset:512
	ds_read_b128 a[68:71], v208 offset:10752
	ds_read_b128 a[72:75], v209 offset:512
	ds_read_b128 a[76:79], v209 offset:10752
	s_sub_u32 s16, s16, 81920
	s_sub_u32 s20, s20, 81920
	s_add_u32 s24, s24, 640
	s_sub_u32 s17, s17, 81920
	s_sub_u32 s21, s21, 81920
	s_add_u32 s25, s25, 640
	s_sub_u32 s18, s18, 81920
	s_sub_u32 s22, s22, 81920
	s_add_u32 s26, s26, 640
	s_sub_u32 s19, s19, 81920
	s_sub_u32 s23, s23, 81920
	s_add_u32 s27, s27, 640
	v_and_b32 v56, 15, v0
	v_lshrrev_b32 v57, 4, v0
	v_and_b32 v58, 31, v0
	v_lshrrev_b32 v59, 5, v0
	s_mov_b32 s8, s32
	s_and_b32 s9, s33, 0xffff
	s_mov_b32 s10, 2621440
	s_mov_b32 s11, 0x20000
	s_mul_i32 s71, s46, 163840
	s_mov_b32 m0, s16
	s_nop 0
	buffer_load_dwordx4 v3, s[40:43], s24 offen offset:0 lds
	s_add_u32 s71, s71, s51
	s_add_u32 s52, s71, 475136
	s_mul_i32 s71, s47, 102400
	s_add_u32 s71, s71, s51
	s_add_u32 s53, s71, 3096576
	s_mul_i32 s71, s46, 245760
	s_add_u32 s71, s71, s51
	s_add_u32 s54, s71, 3915776
	buffer_load_dwordx4 v4, s[40:43], s24 offen offset:1024 lds
	s_mul_i32 s71, s47, 245760
	s_add_u32 s71, s71, s51
	s_add_u32 s55, s71, 7847936
	s_lshl_b32 s74, s45, 2
	s_add_u32 s74, s74, s44
	s_mul_i32 s71, s74, 40960
	s_add_u32 s56, s71, 9814016
	s_mul_i32 s72, s46, 2560
	buffer_load_dwordx4 v6, s[40:43], s24 offen offset:2048 lds
	s_add_u32 s60, s71, s72
	s_add_u32 s60, s60, 15056896
	s_lshl_b32 s71, s74, 11
	s_add_u32 s57, s71, 9814016
	s_mul_i32 s71, s74, 98304
	s_lshl_b32 s72, s46, 11
	s_add_u32 s71, s71, s72
	s_add_u32 s62, s71, 17678336
	buffer_load_dwordx4 v248, s[40:43], s24 offen offset:3072 lds
	s_add_u32 s77, s62, s72
	s_add_u32 s77, s77, 32768
	s_mul_i32 s71, s76, 40960
	s_mul_i32 s72, s47, 5120
	s_add_u32 s58, s71, s72
	s_add_u32 s58, s58, 9814016
	s_add_u32 s61, s71, 15056896
	s_lshl_b32 s71, s76, 11
	s_mov_b32 m0, s20
	s_nop 0
	buffer_load_dwordx4 v249, s[40:43], s24 offen offset:0 lds
	s_add_u32 s96, s71, 25149440
	s_lshl_b32 s72, s47, 8
	s_add_u32 s59, s71, s72
	s_add_u32 s59, s59, 9814016
	s_mul_i32 s71, s76, 98304
	s_add_u32 s63, s71, 17678336
	s_lshl_b32 s71, s46, 16
	s_add_u32 s65, s71, s87
	s_mov_b32 m0, s17
	s_nop 0
	buffer_load_dwordx4 v3, s[40:43], s25 offen offset:0 lds
	s_add_u32 s65, s65, 23969792
	s_lshl_b32 s72, s45, 12
	s_add_u32 s71, s71, s72
	s_mul_i32 s72, s50, 1920
	s_add_u32 s71, s71, s72
	s_add_u32 s64, s71, 23969792
	s_lshl_b32 s71, s45, 7
	s_add_u32 s66, s71, 25280512
	buffer_load_dwordx4 v4, s[40:43], s25 offen offset:1024 lds
	s_lshl_b32 s71, s46, 10
	s_add_u32 s67, s71, 25280512
	v_lshlrev_b32 v61, 4, v56
	v_lshl_add_u32 v55, v57, 9, v61
	s_lshl_b32 s71, s50, 8
	v_add_u32 v5, s71, v55
	v_lshrrev_b32 v54, 1, v57
	v_and_b32 v53, 1, v57
	buffer_load_dwordx4 v6, s[40:43], s25 offen offset:2048 lds
	v_lshl_add_u32 v52, v54, 9, v61
	v_lshl_add_u32 v52, v53, 3, v52
	s_add_u32 s71, s71, 4096
	v_add_u32 v7, s71, v52
	v_lshlrev_b32 v52, 3, v56
	v_lshl_add_u32 v52, v54, 2, v52
	s_lshl_b32 s71, s50, 7
	v_add_u32 v8, s71, v52
	buffer_load_dwordx4 v248, s[40:43], s25 offen offset:3072 lds
	v_lshlrev_b32 v47, 4, v58
	v_lshl_add_u32 v243, v59, 3, v47
	v_lshlrev_b32 v12, 16, v224
	v_and_b32 v13, 0xffff0000, v224
	v_lshlrev_b32 v14, 16, v225
	v_and_b32 v15, 0xffff0000, v225
	v_lshlrev_b32 v16, 16, v226
	v_and_b32 v17, 0xffff0000, v226
	s_mov_b32 m0, s21
	s_nop 0
	buffer_load_dwordx4 v249, s[40:43], s25 offen offset:0 lds
	v_lshlrev_b32 v18, 16, v227
	v_and_b32 v19, 0xffff0000, v227
	v_lshlrev_b32 v20, 16, v228
	v_and_b32 v21, 0xffff0000, v228
	v_lshlrev_b32 v22, 16, v229
	v_and_b32 v23, 0xffff0000, v229
	v_lshlrev_b32 v24, 16, v230
	v_and_b32 v25, 0xffff0000, v230
	s_mov_b32 m0, s18
	s_nop 0
	buffer_load_dwordx4 v3, s[40:43], s26 offen offset:0 lds
	v_lshlrev_b32 v26, 16, v231
	v_and_b32 v27, 0xffff0000, v231
	v_lshlrev_b32 v28, 16, v222
	v_and_b32 v29, 0xffff0000, v222
	v_lshlrev_b32 v30, 16, v223
	v_and_b32 v31, 0xffff0000, v223
	s_add_u32 s71, s58, 0
	s_add_u32 s72, s59, 15204352
	buffer_load_dwordx4 v4, s[40:43], s26 offen offset:1024 lds
	v_pk_mul_f32 v[144:145], v[12:13], v[12:13]
	v_pk_mul_f32 v[146:147], v[14:15], v[14:15]
	v_pk_fma_f32 v[144:145], v[16:17], v[16:17], v[144:145]
	v_pk_fma_f32 v[146:147], v[18:19], v[18:19], v[146:147]
	v_pk_fma_f32 v[144:145], v[20:21], v[20:21], v[144:145]
	v_pk_fma_f32 v[146:147], v[22:23], v[22:23], v[146:147]
	v_pk_fma_f32 v[144:145], v[24:25], v[24:25], v[144:145]
	v_pk_fma_f32 v[146:147], v[26:27], v[26:27], v[146:147]
	buffer_load_dwordx4 v6, s[40:43], s26 offen offset:2048 lds
	v_pk_fma_f32 v[144:145], v[28:29], v[28:29], v[144:145]
	v_pk_fma_f32 v[146:147], v[30:31], v[30:31], v[146:147]
	v_pk_add_f32 v[140:141], v[12:13], v[14:15]
	v_pk_add_f32 v[142:143], v[16:17], v[18:19]
	v_pk_add_f32 v[140:141], v[140:141], v[20:21]
	v_pk_add_f32 v[142:143], v[142:143], v[22:23]
	v_pk_add_f32 v[140:141], v[140:141], v[24:25]
	v_pk_add_f32 v[142:143], v[142:143], v[26:27]
	buffer_load_dwordx4 v248, s[40:43], s26 offen offset:3072 lds
	v_pk_add_f32 v[140:141], v[140:141], v[28:29]
	v_pk_add_f32 v[142:143], v[142:143], v[30:31]
	v_pk_add_f32 v[140:141], v[140:141], v[142:143]
	v_add_f32 v140, v140, v141
	v_pk_add_f32 v[144:145], v[144:145], v[146:147]
	v_add_f32 v141, v144, v145
	s_nop 1
	v_permlane32_swap_b32 v140, v141
	v_add_f32 v140, v140, v141
	s_mov_b32 m0, s22
	s_nop 0
	buffer_load_dwordx4 v249, s[40:43], s26 offen offset:0 lds
	v_mov_b32 v141, v140
	s_nop 1
	v_permlane16_swap_b32 v140, v141
	v_add_f32 v140, v140, v141
	buffer_store_dword v140, v8, s[4:7], s72 offen sc1
	v_readfirstlane_b32 s70, v244
	s_getreg_b32 s98, hwreg(HW_REG_XCC_ID, 0, 4)
	s_mul_i32 s70, s70, 0x9E3779B1
	s_add_u32 s70, s70, 0x7F4A7C15
	s_mov_b32 m0, s19
	s_nop 0
	buffer_load_dwordx4 v3, s[40:43], s27 offen offset:0 lds
	v_mov_b32 v244, s70
	s_lshl_b32 s98, s98, 28
	s_xor_b32 s73, s98, s70
	v_mov_b32 v213, s73
	s_add_u32 s71, s66, 0
	v_add_u32 v214, s71, v247
	s_lshl_b32 s72, s46, 2
	s_add_u32 s72, s72, s71
	buffer_load_dwordx4 v4, s[40:43], s27 offen offset:1024 lds
	s_waitcnt vmcnt(2)
	s_barrier
	s_cmp_lg_u32 s44, 0
	s_cbranch_scc1 Lw0_1
	v_lshlrev_b32 v250, 7, v247
	s_mov_b64 exec, 0xff
	buffer_atomic_swap v244, v250, s[4:7], s83 offen sc1
	s_mov_b64 exec, -1
	s_mov_b64 exec, 1
	buffer_atomic_swap v213, off, s[4:7], s72 sc1
	s_mov_b64 exec, -1
Lw0_1:
	v_subrev_u32 v208, 81920, v208
	v_subrev_u32 v209, 81920, v209
	v_and_b32 v53, 1, v57
	v_lshlrev_b32 v61, 4, v56
	v_add_u32 v2, 0x10000, v1
	v_add_u32 v245, 0x20000, v1
	v_lshlrev_b32 v52, 3, v58
	v_lshl_add_u32 v9, v59, 10, v52
	buffer_load_dwordx4 v6, s[40:43], s27 offen offset:2048 lds
	s_add_u32 s71, s51, 131072
	v_lshlrev_b32 v52, 7, v58
	v_lshl_add_u32 v52, v59, 14, v52
	v_and_b32 v51, 7, v58
	v_lshl_add_u32 v52, v51, 4, v52
	v_add_u32 v232, s71, v52
	v_lshrrev_b32 v51, 2, v56
	v_and_b32 v50, 3, v56
	buffer_load_dwordx4 v248, s[40:43], s27 offen offset:3072 lds
	v_lshl_add_u32 v50, v53, 2, v50
	s_lshl_b32 s71, s50, 14
	s_add_u32 s71, s71, 131072
	s_mul_i32 s72, s49, 5
	v_lshl_add_u32 v49, v59, 3, v51
	v_lshlrev_b32 v49, 7, v49
	v_add_u32 v49, s71, v49
	v_add_u32 v48, s72, v50
	s_mov_b32 m0, s23
	s_nop 0
	buffer_load_dwordx4 v249, s[40:43], s27 offen offset:0 lds
	v_cmp_eq_u32 vcc, 4, v50
	s_nop 1
	v_cndmask_b32 v48, v48, v50, vcc
	v_cmp_lt_u32 vcc, 4, v50
	s_nop 1
	v_cndmask_b32 v48, v48, 9, vcc
	v_min_u32 v50, 5, v50
	v_add_u32 v50, 10, v50
	v_lshrrev_b32 v47, 1, v48
	v_xor_b32 v47, v47, v51
	v_and_b32 v46, 1, v48
	v_lshlrev_b32 v46, 3, v46
	v_lshl_add_u32 v46, v47, 4, v46
	v_add_u32 v233, v49, v46
	v_xor_b32 v46, 64, v46
	v_add_u32 v46, 512, v46
	v_add_u32 v234, v49, v46
	v_lshrrev_b32 v47, 1, v50
	v_xor_b32 v47, v47, v51
	v_and_b32 v46, 1, v50
	v_lshlrev_b32 v46, 3, v46
	v_lshl_add_u32 v46, v47, 4, v46
	v_add_u32 v235, v49, v46
	v_xor_b32 v46, 64, v46
	v_add_u32 v46, 512, v46
	v_add_u32 v236, v49, v46
	v_mov_b32 v46, 1073741824
	v_lshlrev_b32 v47, 4, v58
	v_cmp_gt_u32 vcc, 24, v58
	s_nop 1
	v_cndmask_b32 v47, v46, v47, vcc
	v_lshl_add_u32 v237, v59, 3, v47
	s_lshl_b32 s71, s49, 29
	s_add_u32 s71, s71, 1536
	v_add_u32 v238, s71, v237
	s_mul_i32 s71, s49, 768
	v_add_u32 v237, s71, v237
	v_lshl_add_u32 v239, v57, 12, v61
	s_add_u32 s71, s87, 131072
	v_lshl_add_u32 v47, v57, 3, v61
	v_add_u32 v240, s71, v47
	v_lshrrev_b32 v47, 3, v58
	v_and_b32 v46, 3, v58
	v_lshl_add_u32 v47, v47, 2, v46
	v_mul_u32_u24 v46, 120, v59
	v_add_u32 v45, v46, v47
	v_lshlrev_b32 v45, 4, v45
	v_add_u32 v241, 131072, v45
	v_add_u32 v47, 16, v47
	v_min_u32 v47, 23, v47
	v_add_u32 v45, v46, v47
	v_lshlrev_b32 v45, 4, v45
	v_add_u32 v242, 131072, v45
	v_and_b32 v46, 1, v56
	v_lshlrev_b32 v46, 4, v46
	v_mov_b32 v47, 0x3f80
	v_lshlrev_b32 v46, v46, v47
	v_ashrrev_i32 v47, 1, v56
	v_cmp_eq_u32 vcc, 0, v47
	s_nop 1
	v_cndmask_b32 v252, 0, v46, vcc
	v_cmp_eq_u32 vcc, 1, v47
	s_nop 1
	v_cndmask_b32 v253, 0, v46, vcc
	v_cmp_eq_u32 vcc, 2, v47
	s_nop 1
	v_cndmask_b32 v254, 0, v46, vcc
	v_cmp_eq_u32 vcc, 3, v47
	s_nop 1
	v_cndmask_b32 v255, 0, v46, vcc
	v_accvgpr_write_b32 a216, 0
	v_accvgpr_write_b32 a217, 0
	v_accvgpr_write_b32 a218, 0
	v_accvgpr_write_b32 a219, 0
	v_accvgpr_write_b32 a220, 0
	v_accvgpr_write_b32 a221, 0
	v_accvgpr_write_b32 a222, 0
	v_accvgpr_write_b32 a223, 0
	v_accvgpr_write_b32 a224, 0
	v_accvgpr_write_b32 a225, 0
	v_accvgpr_write_b32 a226, 0
	v_accvgpr_write_b32 a227, 0
	v_accvgpr_write_b32 a228, 0
	v_accvgpr_write_b32 a229, 0
	v_accvgpr_write_b32 a230, 0
	v_accvgpr_write_b32 a231, 0
	v_accvgpr_write_b32 a232, 0
	v_accvgpr_write_b32 a233, 0
	v_accvgpr_write_b32 a234, 0
	v_accvgpr_write_b32 a235, 0
	v_accvgpr_write_b32 a236, 0
	v_accvgpr_write_b32 a237, 0
	v_accvgpr_write_b32 a238, 0
	v_accvgpr_write_b32 a239, 0
	v_accvgpr_write_b32 a240, 0
	v_accvgpr_write_b32 a241, 0
	v_accvgpr_write_b32 a242, 0
	v_accvgpr_write_b32 a243, 0
	v_accvgpr_write_b32 a244, 0
	v_accvgpr_write_b32 a245, 0
	v_accvgpr_write_b32 a246, 0
	v_accvgpr_write_b32 a247, 0
	v_accvgpr_write_b32 a248, 0
	v_accvgpr_write_b32 a249, 0
	v_accvgpr_write_b32 a250, 0
	v_accvgpr_write_b32 a251, 0
	v_accvgpr_write_b32 a252, 0
	v_accvgpr_write_b32 a253, 0
	v_accvgpr_write_b32 a254, 0
	v_accvgpr_write_b32 a255, 0
	s_lshl_b32 s72, s84, 9
	s_lshr_b32 s71, s46, 2
	s_lshl_b32 s71, s71, 12
	s_add_u32 s73, s71, s72
	s_add_u32 s71, s73, 20480
	v_add_u32 v220, s71, v247
	s_add_u32 s71, s72, 36784
	v_add_u32 v46, s71, v247
	v_cmp_lt_u32 vcc, 19, v0
	s_nop 1
	v_cndmask_b32 v220, v220, v46, vcc
	v_add_u32 v222, 256, v46
	s_add_u32 s86, s73, 4096
	v_lshlrev_b32 v207, 3, v56
	v_and_b32 v216, 3, v56
	v_bfe_u32 v46, v56, 2, 1
	v_lshl_add_u32 v216, v46, 3, v216
	v_lshrrev_b32 v46, 3, v56
	v_lshl_add_u32 v216, v46, 2, v216
	v_lshlrev_b32 v216, 3, v216
	v_lshlrev_b32 v217, 5, v56
	s_lshl_b32 s71, s44, 9
	v_add_u32 v218, s71, v217
	v_add_u32 v217, 2048, v217
	v_mul_u32_u24 v219, 6400, v57
	v_lshl_add_u32 v219, v56, 4, v219
	v_lshlrev_b32 v61, 3, v56
	v_lshl_add_u32 v61, v57, 9, v61
	s_lshl_b32 s71, s50, 7
	v_add_u32 v0, s71, v61
	v_lshlrev_b32 v46, 4, v56
	v_lshl_add_u32 v4, v57, 9, v46
	s_mul_i32 s83, s46, 25600
	s_lshl_b32 s71, s44, 8
	s_add_u32 s83, s83, s71
	s_add_u32 s83, s83, 49152
	s_waitcnt vmcnt(0)
	ds_read_b128 a[80:83], v208 offset:0
	ds_read_b128 a[84:87], v208 offset:10240
	ds_read_b128 a[88:91], v209 offset:0
	ds_read_b128 a[92:95], v209 offset:10240
	ds_read_b128 a[96:99], v208 offset:128
	ds_read_b128 a[100:103], v208 offset:10368
	ds_read_b128 a[104:107], v209 offset:128
	ds_read_b128 a[108:111], v209 offset:10368
	ds_read_b128 a[112:115], v208 offset:256
	ds_read_b128 a[116:119], v208 offset:10496
	ds_read_b128 a[120:123], v209 offset:256
	ds_read_b128 a[124:127], v209 offset:10496
	ds_read_b128 a[128:131], v208 offset:384
	ds_read_b128 a[132:135], v208 offset:10624
	ds_read_b128 a[136:139], v209 offset:384
	ds_read_b128 a[140:143], v209 offset:10624
	ds_read_b128 a[144:147], v208 offset:512
	ds_read_b128 a[148:151], v208 offset:10752
	ds_read_b128 a[152:155], v209 offset:512
	ds_read_b128 a[156:159], v209 offset:10752
	s_cmp_lg_u32 s44, 0
	s_cbranch_scc1 Lw0_2
	s_mov_b64 exec, 0xfffff
Lpoll_3:
	buffer_load_dword v250, v247, s[4:7], s86 offen sc1
	s_sub_u32 s69, s69, 1
	s_cselect_b32 s69, 0, s69
	s_cbranch_scc1 Lpolle_4
	s_waitcnt vmcnt(0)
	v_cmp_ne_u32 vcc, s70, v250
	s_cbranch_vccnz Lpoll_3
Lpolle_4:
	s_waitcnt vmcnt(0)
	s_mov_b64 exec, -1
Lw0_2:
	s_waitcnt lgkmcnt(0)
	s_barrier
	s_add_u32 m0, s51, 0
	s_add_u32 s85, s52, 0
	buffer_load_dwordx4 v1, s[4:7], s85 offen offset:0 sc1 lds
	buffer_load_dwordx4 v1, s[4:7], s85 offen offset:1024 sc1 lds
	buffer_load_dwordx4 v1, s[4:7], s85 offen offset:2048 sc1 lds
	buffer_load_dwordx4 v1, s[4:7], s85 offen offset:3072 sc1 lds
	s_add_u32 m0, s51, 16384
	s_add_u32 s85, s52, 16384
	buffer_load_dwordx4 v1, s[4:7], s85 offen offset:0 sc1 lds
	buffer_load_dwordx4 v1, s[4:7], s85 offen offset:1024 sc1 lds
	buffer_load_dwordx4 v1, s[4:7], s85 offen offset:2048 sc1 lds
	buffer_load_dwordx4 v1, s[4:7], s85 offen offset:3072 sc1 lds
	s_add_u32 m0, s51, 32768
	s_add_u32 s85, s52, 32768
	buffer_load_dwordx4 v1, s[4:7], s85 offen offset:0 sc1 lds
	buffer_load_dwordx4 v1, s[4:7], s85 offen offset:1024 sc1 lds
	buffer_load_dwordx4 v1, s[4:7], s85 offen offset:2048 sc1 lds
	buffer_load_dwordx4 v1, s[4:7], s85 offen offset:3072 sc1 lds
	s_waitcnt vmcnt(8)
	s_barrier
	ds_read_b128 v[32:35], v1 offset:0
	ds_read_b128 v[36:39], v1 offset:1024
	ds_read_b128 v[40:43], v1 offset:2048
	ds_read_b128 v[44:47], v1 offset:3072
	ds_read_b128 v[48:51], v1 offset:4096
	ds_read_b128 v[52:55], v1 offset:5120
	ds_read_b128 v[56:59], v1 offset:6144
	s_waitcnt lgkmcnt(3)
	v_mfma_f32_16x16x32_bf16 v[64:67], v[32:35], a[0:3], 0
	ds_read_b128 v[60:63], v1 offset:7168
	v_mfma_f32_16x16x32_bf16 v[68:71], v[32:35], a[4:7], 0
	v_mfma_f32_16x16x32_bf16 v[72:75], v[36:39], a[0:3], 0
	ds_read_b128 v[32:35], v1 offset:8192
	v_mfma_f32_16x16x32_bf16 v[76:79], v[36:39], a[4:7], 0
	s_add_u32 m0, s51, 49152
	s_add_u32 s85, s52, 49152
	v_mfma_f32_16x16x32_bf16 v[80:83], v[40:43], a[0:3], 0
	ds_read_b128 v[36:39], v1 offset:9216
	v_mfma_f32_16x16x32_bf16 v[84:87], v[40:43], a[4:7], 0
	buffer_load_dwordx4 v1, s[4:7], s85 offen offset:0 sc1 lds
	v_mfma_f32_16x16x32_bf16 v[88:91], v[44:47], a[0:3], 0
	ds_read_b128 v[40:43], v1 offset:10240
	v_mfma_f32_16x16x32_bf16 v[92:95], v[44:47], a[4:7], 0
	s_waitcnt lgkmcnt(3)
	v_mfma_f32_16x16x32_bf16 v[96:99], v[48:51], a[0:3], 0
	ds_read_b128 v[44:47], v1 offset:11264
	v_mfma_f32_16x16x32_bf16 v[100:103], v[48:51], a[4:7], 0
	buffer_load_dword v221, v220, s[4:7], 0 offen sc1
	v_mfma_f32_16x16x32_bf16 v[104:107], v[52:55], a[0:3], 0
	ds_read_b128 v[48:51], v1 offset:12288
	v_mfma_f32_16x16x32_bf16 v[108:111], v[52:55], a[4:7], 0
	buffer_load_dword v223, v222, s[4:7], 0 offen sc1
	v_mfma_f32_16x16x32_bf16 v[64:67], v[56:59], a[8:11], v[64:67]
	ds_read_b128 v[52:55], v1 offset:13312
	v_mfma_f32_16x16x32_bf16 v[68:71], v[56:59], a[12:15], v[68:71]
	buffer_load_dword v215, v214, s[4:7], 0 offen sc1
	v_mfma_f32_16x16x32_bf16 v[72:75], v[60:63], a[8:11], v[72:75]
	ds_read_b128 v[56:59], v1 offset:14336
	s_waitcnt lgkmcnt(3)
	v_mfma_f32_16x16x32_bf16 v[76:79], v[60:63], a[12:15], v[76:79]
	buffer_load_dwordx4 v1, s[4:7], s85 offen offset:1024 sc1 lds
	v_mfma_f32_16x16x32_bf16 v[80:83], v[32:35], a[8:11], v[80:83]
	ds_read_b128 v[60:63], v1 offset:15360
	v_mfma_f32_16x16x32_bf16 v[84:87], v[32:35], a[12:15], v[84:87]
	v_mfma_f32_16x16x32_bf16 v[88:91], v[36:39], a[8:11], v[88:91]
	s_waitcnt vmcnt(9)
	s_barrier
	ds_read_b128 v[32:35], v1 offset:16384
	v_mfma_f32_16x16x32_bf16 v[92:95], v[36:39], a[12:15], v[92:95]
	v_mfma_f32_16x16x32_bf16 v[96:99], v[40:43], a[8:11], v[96:99]
	ds_read_b128 v[36:39], v1 offset:17408
	v_mfma_f32_16x16x32_bf16 v[100:103], v[40:43], a[12:15], v[100:103]
	v_mfma_f32_16x16x32_bf16 v[104:107], v[44:47], a[8:11], v[104:107]
	ds_read_b128 v[40:43], v1 offset:18432
	s_waitcnt lgkmcnt(3)
	v_mfma_f32_16x16x32_bf16 v[108:111], v[44:47], a[12:15], v[108:111]
	buffer_load_dwordx4 v1, s[4:7], s85 offen offset:2048 sc1 lds
	v_mfma_f32_16x16x32_bf16 v[64:67], v[48:51], a[16:19], v[64:67]
	ds_read_b128 v[44:47], v1 offset:19456
	v_mfma_f32_16x16x32_bf16 v[68:71], v[48:51], a[20:23], v[68:71]
	v_mfma_f32_16x16x32_bf16 v[72:75], v[52:55], a[16:19], v[72:75]
	ds_read_b128 v[48:51], v1 offset:20480
	v_mfma_f32_16x16x32_bf16 v[76:79], v[52:55], a[20:23], v[76:79]
	v_mfma_f32_16x16x32_bf16 v[80:83], v[56:59], a[16:19], v[80:83]
	ds_read_b128 v[52:55], v1 offset:21504
	v_mfma_f32_16x16x32_bf16 v[84:87], v[56:59], a[20:23], v[84:87]
	v_mfma_f32_16x16x32_bf16 v[88:91], v[60:63], a[16:19], v[88:91]
	ds_read_b128 v[56:59], v1 offset:22528
	s_waitcnt lgkmcnt(3)
	v_mfma_f32_16x16x32_bf16 v[92:95], v[60:63], a[20:23], v[92:95]
	buffer_load_dwordx4 v1, s[4:7], s85 offen offset:3072 sc1 lds
	v_mfma_f32_16x16x32_bf16 v[96:99], v[32:35], a[16:19], v[96:99]
	ds_read_b128 v[60:63], v1 offset:23552
	v_mfma_f32_16x16x32_bf16 v[100:103], v[32:35], a[20:23], v[100:103]
	v_mfma_f32_16x16x32_bf16 v[104:107], v[36:39], a[16:19], v[104:107]
	ds_read_b128 v[32:35], v1 offset:24576
	v_mfma_f32_16x16x32_bf16 v[108:111], v[36:39], a[20:23], v[108:111]
	v_mfma_f32_16x16x32_bf16 v[64:67], v[40:43], a[24:27], v[64:67]
	ds_read_b128 v[36:39], v1 offset:25600
	v_mfma_f32_16x16x32_bf16 v[68:71], v[40:43], a[28:31], v[68:71]
	v_mfma_f32_16x16x32_bf16 v[72:75], v[44:47], a[24:27], v[72:75]
	ds_read_b128 v[40:43], v1 offset:26624
	v_mfma_f32_16x16x32_bf16 v[76:79], v[44:47], a[28:31], v[76:79]
	s_add_u32 m0, s51, 65536
	s_add_u32 s85, s52, 65536
	s_waitcnt lgkmcnt(3)
	v_mfma_f32_16x16x32_bf16 v[80:83], v[48:51], a[24:27], v[80:83]
	ds_read_b128 v[44:47], v1 offset:27648
	v_mfma_f32_16x16x32_bf16 v[84:87], v[48:51], a[28:31], v[84:87]
	buffer_load_dwordx4 v1, s[4:7], s85 offen offset:0 sc1 lds
	v_mfma_f32_16x16x32_bf16 v[88:91], v[52:55], a[24:27], v[88:91]
	ds_read_b128 v[48:51], v1 offset:28672
	v_mfma_f32_16x16x32_bf16 v[92:95], v[52:55], a[28:31], v[92:95]
	v_mfma_f32_16x16x32_bf16 v[96:99], v[56:59], a[24:27], v[96:99]
	ds_read_b128 v[52:55], v1 offset:29696
	v_mfma_f32_16x16x32_bf16 v[100:103], v[56:59], a[28:31], v[100:103]
	v_mfma_f32_16x16x32_bf16 v[104:107], v[60:63], a[24:27], v[104:107]
	ds_read_b128 v[56:59], v1 offset:30720
	v_mfma_f32_16x16x32_bf16 v[108:111], v[60:63], a[28:31], v[108:111]
	s_waitcnt vmcnt(4)
	v_xor_b32 v250, s70, v215
	v_lshlrev_b32 v215, 4, v250
	v_cmp_ne_u32 vcc, 0, v215
	s_nop 0
	s_and_b32 s71, vcc_lo, 0xffff
	s_cbranch_scc1 Lslow_6
Lslow_6r:
	v_cmp_ne_u32 vcc, s98, v250
	s_nop 0
	s_and_b32 s99, vcc_lo, 0xffff
	v_cmp_ne_u32 vcc, s70, v221
	s_cbranch_vccnz Lslow_7
Lslow_7r:
	v_cmp_ne_u32 vcc, s70, v223
	s_nop 0
	s_and_b32 s71, vcc_lo, 0xffffff
	s_cbranch_scc1 Lslow_8
Lslow_8r:
	s_waitcnt lgkmcnt(3)
	v_mfma_f32_16x16x32_bf16 v[64:67], v[32:35], a[32:35], v[64:67]
	ds_read_b128 v[60:63], v1 offset:31744
	v_mfma_f32_16x16x32_bf16 v[68:71], v[32:35], a[36:39], v[68:71]
	buffer_load_dwordx4 v1, s[4:7], s85 offen offset:1024 sc1 lds
	v_mfma_f32_16x16x32_bf16 v[72:75], v[36:39], a[32:35], v[72:75]
	s_barrier
	ds_read_b128 v[32:35], v1 offset:32768
	v_mfma_f32_16x16x32_bf16 v[76:79], v[36:39], a[36:39], v[76:79]
	v_mfma_f32_16x16x32_bf16 v[80:83], v[40:43], a[32:35], v[80:83]
	ds_read_b128 v[36:39], v1 offset:33792
	s_mov_b32 s72, s83
	v_mfma_f32_16x16x32_bf16 v[84:87], v[40:43], a[36:39], v[84:87]
	buffer_load_dwordx4 v[128:131], v219, s[4:7], s72 offen offset:0 sc1
	v_mfma_f32_16x16x32_bf16 v[88:91], v[44:47], a[32:35], v[88:91]
	ds_read_b128 v[40:43], v1 offset:34816
	v_mfma_f32_16x16x32_bf16 v[92:95], v[44:47], a[36:39], v[92:95]
	s_waitcnt lgkmcnt(3)
	v_mfma_f32_16x16x32_bf16 v[96:99], v[48:51], a[32:35], v[96:99]
	ds_read_b128 v[44:47], v1 offset:35840
	v_mfma_f32_16x16x32_bf16 v[100:103], v[48:51], a[36:39], v[100:103]
	buffer_load_dwordx4 v1, s[4:7], s85 offen offset:2048 sc1 lds
	v_mfma_f32_16x16x32_bf16 v[104:107], v[52:55], a[32:35], v[104:107]
	ds_read_b128 v[48:51], v1 offset:36864
	v_mfma_f32_16x16x32_bf16 v[108:111], v[52:55], a[36:39], v[108:111]
	buffer_load_dwordx4 v[132:135], v219, s[4:7], s72 offen offset:1280 sc1
	v_mfma_f32_16x16x32_bf16 v[64:67], v[56:59], a[40:43], v[64:67]
	ds_read_b128 v[52:55], v1 offset:37888
	v_mfma_f32_16x16x32_bf16 v[68:71], v[56:59], a[44:47], v[68:71]
	v_mfma_f32_16x16x32_bf16 v[72:75], v[60:63], a[40:43], v[72:75]
	ds_read_b128 v[56:59], v1 offset:38912
	v_mfma_f32_16x16x32_bf16 v[76:79], v[60:63], a[44:47], v[76:79]
	s_waitcnt lgkmcnt(3)
	v_mfma_f32_16x16x32_bf16 v[80:83], v[32:35], a[40:43], v[80:83]
	ds_read_b128 v[60:63], v1 offset:39936
	v_mfma_f32_16x16x32_bf16 v[84:87], v[32:35], a[44:47], v[84:87]
	buffer_load_dwordx4 v[136:139], v219, s[4:7], s72 offen offset:2560 sc1
	v_mfma_f32_16x16x32_bf16 v[88:91], v[36:39], a[40:43], v[88:91]
	ds_read_b128 v[32:35], v1 offset:40960
	v_mfma_f32_16x16x32_bf16 v[92:95], v[36:39], a[44:47], v[92:95]
	buffer_load_dwordx4 v1, s[4:7], s85 offen offset:3072 sc1 lds
	v_mfma_f32_16x16x32_bf16 v[96:99], v[40:43], a[40:43], v[96:99]
	ds_read_b128 v[36:39], v1 offset:41984
	v_mfma_f32_16x16x32_bf16 v[100:103], v[40:43], a[44:47], v[100:103]
	v_mfma_f32_16x16x32_bf16 v[104:107], v[44:47], a[40:43], v[104:107]
	ds_read_b128 v[40:43], v1 offset:43008
	s_add_u32 s72, s72, 3840
	v_mfma_f32_16x16x32_bf16 v[108:111], v[44:47], a[44:47], v[108:111]
	buffer_load_dwordx4 v[140:143], v219, s[4:7], s72 offen offset:0 sc1
	s_waitcnt lgkmcnt(3)
	v_mfma_f32_16x16x32_bf16 v[64:67], v[48:51], a[48:51], v[64:67]
	ds_read_b128 v[44:47], v1 offset:44032
	v_mfma_f32_16x16x32_bf16 v[68:71], v[48:51], a[52:55], v[68:71]
	v_mfma_f32_16x16x32_bf16 v[72:75], v[52:55], a[48:51], v[72:75]
	ds_read_b128 v[48:51], v1 offset:45056
	v_mfma_f32_16x16x32_bf16 v[76:79], v[52:55], a[52:55], v[76:79]
	s_add_u32 m0, s51, 131072
	s_add_u32 s85, s52, 81920
	v_mfma_f32_16x16x32_bf16 v[80:83], v[56:59], a[48:51], v[80:83]
	ds_read_b128 v[52:55], v1 offset:46080
	v_mfma_f32_16x16x32_bf16 v[84:87], v[56:59], a[52:55], v[84:87]
	buffer_load_dwordx4 v[144:147], v219, s[4:7], s72 offen offset:1280 sc1
	v_mfma_f32_16x16x32_bf16 v[88:91], v[60:63], a[48:51], v[88:91]
	ds_read_b128 v[56:59], v1 offset:47104
	s_waitcnt lgkmcnt(3)
	v_mfma_f32_16x16x32_bf16 v[92:95], v[60:63], a[52:55], v[92:95]
	buffer_load_dwordx4 v1, s[4:7], s85 offen offset:0 sc1 lds
	v_mfma_f32_16x16x32_bf16 v[96:99], v[32:35], a[48:51], v[96:99]
	ds_read_b128 v[60:63], v1 offset:48128
	v_mfma_f32_16x16x32_bf16 v[100:103], v[32:35], a[52:55], v[100:103]
	v_mfma_f32_16x16x32_bf16 v[104:107], v[36:39], a[48:51], v[104:107]
	s_waitcnt vmcnt(10)
	s_barrier
	ds_read_b128 v[32:35], v1 offset:49152
	s_lshl_b32 s72, s44, 8
	v_mfma_f32_16x16x32_bf16 v[108:111], v[36:39], a[52:55], v[108:111]
	s_sub_u32 s72, s83, s72
	s_add_u32 s72, s72, 1024
	buffer_load_dwordx4 v[148:151], v219, s[4:7], s72 offen offset:0 sc1
	v_mfma_f32_16x16x32_bf16 v[64:67], v[40:43], a[56:59], v[64:67]
	ds_read_b128 v[36:39], v1 offset:50176
	v_mfma_f32_16x16x32_bf16 v[68:71], v[40:43], a[60:63], v[68:71]
	v_mfma_f32_16x16x32_bf16 v[72:75], v[44:47], a[56:59], v[72:75]
	ds_read_b128 v[40:43], v1 offset:51200
	s_waitcnt lgkmcnt(3)
	v_mfma_f32_16x16x32_bf16 v[76:79], v[44:47], a[60:63], v[76:79]
	buffer_load_dwordx4 v1, s[4:7], s85 offen offset:1024 sc1 lds
	v_mfma_f32_16x16x32_bf16 v[80:83], v[48:51], a[56:59], v[80:83]
	ds_read_b128 v[44:47], v1 offset:52224
	v_mfma_f32_16x16x32_bf16 v[84:87], v[48:51], a[60:63], v[84:87]
	buffer_load_dwordx4 v[152:155], v219, s[4:7], s72 offen offset:1280 sc1
	v_mfma_f32_16x16x32_bf16 v[88:91], v[52:55], a[56:59], v[88:91]
	ds_read_b128 v[48:51], v1 offset:53248
	v_mfma_f32_16x16x32_bf16 v[92:95], v[52:55], a[60:63], v[92:95]
	v_mfma_f32_16x16x32_bf16 v[96:99], v[56:59], a[56:59], v[96:99]
	ds_read_b128 v[52:55], v1 offset:54272
	v_mfma_f32_16x16x32_bf16 v[100:103], v[56:59], a[60:63], v[100:103]
	v_mfma_f32_16x16x32_bf16 v[104:107], v[60:63], a[56:59], v[104:107]
	ds_read_b128 v[56:59], v1 offset:55296
	s_waitcnt lgkmcnt(3)
	v_mfma_f32_16x16x32_bf16 v[108:111], v[60:63], a[60:63], v[108:111]
	buffer_load_dwordx4 v[156:159], v219, s[4:7], s72 offen offset:2560 sc1
	v_mfma_f32_16x16x32_bf16 v[64:67], v[32:35], a[64:67], v[64:67]
	ds_read_b128 v[60:63], v1 offset:56320
	v_mfma_f32_16x16x32_bf16 v[68:71], v[32:35], a[68:71], v[68:71]
	buffer_load_dwordx4 v1, s[4:7], s85 offen offset:2048 sc1 lds
	v_mfma_f32_16x16x32_bf16 v[72:75], v[36:39], a[64:67], v[72:75]
	ds_read_b128 v[32:35], v1 offset:57344
	v_mfma_f32_16x16x32_bf16 v[76:79], v[36:39], a[68:71], v[76:79]
	v_mfma_f32_16x16x32_bf16 v[80:83], v[40:43], a[64:67], v[80:83]
	ds_read_b128 v[36:39], v1 offset:58368
	s_add_u32 s72, s72, 3840
	v_mfma_f32_16x16x32_bf16 v[84:87], v[40:43], a[68:71], v[84:87]
	buffer_load_dwordx4 v[160:163], v219, s[4:7], s72 offen offset:0 sc1
	v_mfma_f32_16x16x32_bf16 v[88:91], v[44:47], a[64:67], v[88:91]
	ds_read_b128 v[40:43], v1 offset:59392
	s_add_u32 s76, s57, 15204352
	v_mfma_f32_16x16x32_bf16 v[92:95], v[44:47], a[68:71], v[92:95]
	buffer_load_dwordx2 v[184:185], v9, s[4:7], s76 offen offset:0 sc1
	s_waitcnt lgkmcnt(3)
	v_mfma_f32_16x16x32_bf16 v[96:99], v[48:51], a[64:67], v[96:99]
	ds_read_b128 v[44:47], v1 offset:60416
	v_mfma_f32_16x16x32_bf16 v[100:103], v[48:51], a[68:71], v[100:103]
	buffer_load_dwordx4 v1, s[4:7], s85 offen offset:3072 sc1 lds
	v_mfma_f32_16x16x32_bf16 v[104:107], v[52:55], a[64:67], v[104:107]
	ds_read_b128 v[48:51], v1 offset:61440
	v_mfma_f32_16x16x32_bf16 v[108:111], v[52:55], a[68:71], v[108:111]
	buffer_load_dwordx4 v[164:167], v219, s[4:7], s72 offen offset:1280 sc1
	v_mfma_f32_16x16x32_bf16 v[64:67], v[56:59], a[72:75], v[64:67]
	ds_read_b128 v[52:55], v1 offset:62464
	v_mfma_f32_16x16x32_bf16 v[68:71], v[56:59], a[76:79], v[68:71]
	buffer_load_dwordx2 v[186:187], v9, s[4:7], s76 offen offset:256 sc1
	v_mfma_f32_16x16x32_bf16 v[72:75], v[60:63], a[72:75], v[72:75]
	ds_read_b128 v[56:59], v1 offset:63488
	v_mfma_f32_16x16x32_bf16 v[76:79], v[60:63], a[76:79], v[76:79]
	s_waitcnt lgkmcnt(3)
	v_mfma_f32_16x16x32_bf16 v[80:83], v[32:35], a[72:75], v[80:83]
	ds_read_b128 v[60:63], v1 offset:64512
	v_mfma_f32_16x16x32_bf16 v[84:87], v[32:35], a[76:79], v[84:87]
	s_add_u32 m0, s51, 147456
	s_add_u32 s85, s52, 98304
	v_mfma_f32_16x16x32_bf16 v[88:91], v[36:39], a[72:75], v[88:91]
	s_waitcnt vmcnt(13)
	s_barrier
	ds_read_b128 v[32:35], v2 offset:0
	v_mfma_f32_16x16x32_bf16 v[92:95], v[36:39], a[76:79], v[92:95]
	buffer_load_dwordx2 v[188:189], v9, s[4:7], s76 offen offset:512 sc1
	v_mfma_f32_16x16x32_bf16 v[96:99], v[40:43], a[72:75], v[96:99]
	ds_read_b128 v[36:39], v2 offset:1024
	v_mfma_f32_16x16x32_bf16 v[100:103], v[40:43], a[76:79], v[100:103]
	buffer_load_dwordx4 v1, s[4:7], s85 offen offset:0 sc1 lds
	v_mfma_f32_16x16x32_bf16 v[104:107], v[44:47], a[72:75], v[104:107]
	ds_read_b128 v[40:43], v2 offset:2048
	v_mfma_f32_16x16x32_bf16 v[108:111], v[44:47], a[76:79], v[108:111]
	s_waitcnt lgkmcnt(3)
	v_mfma_f32_16x16x32_bf16 v[64:67], v[48:51], a[80:83], v[64:67]
	ds_read_b128 v[44:47], v2 offset:3072
	v_mfma_f32_16x16x32_bf16 v[68:71], v[48:51], a[84:87], v[68:71]
	buffer_load_dwordx2 v[190:191], v9, s[4:7], s76 offen offset:768 sc1
	v_mfma_f32_16x16x32_bf16 v[72:75], v[52:55], a[80:83], v[72:75]
	ds_read_b128 v[48:51], v2 offset:4096
	v_mfma_f32_16x16x32_bf16 v[76:79], v[52:55], a[84:87], v[76:79]
	v_mfma_f32_16x16x32_bf16 v[80:83], v[56:59], a[80:83], v[80:83]
	ds_read_b128 v[52:55], v2 offset:5120
	s_waitcnt vmcnt(4)
	v_mfma_f32_16x16x32_bf16 v[84:87], v[56:59], a[84:87], v[84:87]
	buffer_load_dwordx4 v1, s[4:7], s85 offen offset:1024 sc1 lds
	v_mfma_f32_16x16x32_bf16 v[88:91], v[60:63], a[80:83], v[88:91]
	ds_read_b128 v[56:59], v2 offset:6144
	v_add_f32 v128, v128, v132
	v_mfma_f32_16x16x32_bf16 v[92:95], v[60:63], a[84:87], v[92:95]
	v_add_f32 v129, v129, v133
	s_waitcnt lgkmcnt(3)
	v_mfma_f32_16x16x32_bf16 v[96:99], v[32:35], a[80:83], v[96:99]
	ds_read_b128 v[60:63], v2 offset:7168
	v_add_f32 v130, v130, v134
	v_mfma_f32_16x16x32_bf16 v[100:103], v[32:35], a[84:87], v[100:103]
	v_add_f32 v131, v131, v135
	v_add_f32 v148, v148, v152
	v_mfma_f32_16x16x32_bf16 v[104:107], v[36:39], a[80:83], v[104:107]
	ds_read_b128 v[32:35], v2 offset:8192
	v_add_f32 v149, v149, v153
	v_mfma_f32_16x16x32_bf16 v[108:111], v[36:39], a[84:87], v[108:111]
	v_add_f32 v150, v150, v154
	v_add_f32 v151, v151, v155
	v_mfma_f32_16x16x32_bf16 v[64:67], v[40:43], a[88:91], v[64:67]
	ds_read_b128 v[36:39], v2 offset:9216
	v_add_f32 v128, v128, v136
	v_mfma_f32_16x16x32_bf16 v[68:71], v[40:43], a[92:95], v[68:71]
	buffer_load_dwordx4 v1, s[4:7], s85 offen offset:2048 sc1 lds
	v_mfma_f32_16x16x32_bf16 v[72:75], v[44:47], a[88:91], v[72:75]
	ds_read_b128 v[40:43], v2 offset:10240
	v_add_f32 v129, v129, v137
	v_mfma_f32_16x16x32_bf16 v[76:79], v[44:47], a[92:95], v[76:79]
	v_add_f32 v130, v130, v138
	s_waitcnt lgkmcnt(3)
	v_mfma_f32_16x16x32_bf16 v[80:83], v[48:51], a[88:91], v[80:83]
	ds_read_b128 v[44:47], v2 offset:11264
	v_add_f32 v131, v131, v139
	v_mfma_f32_16x16x32_bf16 v[84:87], v[48:51], a[92:95], v[84:87]
	v_add_f32 v148, v148, v156
	v_add_f32 v149, v149, v157
	v_mfma_f32_16x16x32_bf16 v[88:91], v[52:55], a[88:91], v[88:91]
	ds_read_b128 v[48:51], v2 offset:12288
	v_add_f32 v150, v150, v158
	v_mfma_f32_16x16x32_bf16 v[92:95], v[52:55], a[92:95], v[92:95]
	v_add_f32 v151, v151, v159
	v_add_f32 v128, v128, v140
	v_mfma_f32_16x16x32_bf16 v[96:99], v[56:59], a[88:91], v[96:99]
	ds_read_b128 v[52:55], v2 offset:13312
	v_add_f32 v129, v129, v141
	v_mfma_f32_16x16x32_bf16 v[100:103], v[56:59], a[92:95], v[100:103]
	buffer_load_dwordx4 v1, s[4:7], s85 offen offset:3072 sc1 lds
	v_mfma_f32_16x16x32_bf16 v[104:107], v[60:63], a[88:91], v[104:107]
	ds_read_b128 v[56:59], v2 offset:14336
	v_add_f32 v130, v130, v142
	v_mfma_f32_16x16x32_bf16 v[108:111], v[60:63], a[92:95], v[108:111]
	v_add_f32 v131, v131, v143
	s_waitcnt lgkmcnt(3)
	v_mfma_f32_16x16x32_bf16 v[64:67], v[32:35], a[96:99], v[64:67]
	ds_read_b128 v[60:63], v2 offset:15360
	v_add_f32 v148, v148, v160
	v_mfma_f32_16x16x32_bf16 v[68:71], v[32:35], a[100:103], v[68:71]
	v_add_f32 v149, v149, v161
	v_add_f32 v150, v150, v162
	v_mfma_f32_16x16x32_bf16 v[72:75], v[36:39], a[96:99], v[72:75]
	s_barrier
	ds_read_b128 v[32:35], v245 offset:0
	v_mfma_f32_16x16x32_bf16 v[76:79], v[36:39], a[100:103], v[76:79]
	v_add_f32 v151, v151, v163
	v_add_f32 v128, v128, v144
	v_mfma_f32_16x16x32_bf16 v[80:83], v[40:43], a[96:99], v[80:83]
	ds_read_b128 v[36:39], v245 offset:1024
	v_add_f32 v129, v129, v145
	v_mfma_f32_16x16x32_bf16 v[84:87], v[40:43], a[100:103], v[84:87]
	s_add_u32 m0, s51, 81920
	s_add_u32 s85, s52, 114688
	v_mfma_f32_16x16x32_bf16 v[88:91], v[44:47], a[96:99], v[88:91]
	ds_read_b128 v[40:43], v245 offset:2048
	s_waitcnt lgkmcnt(3)
	v_mfma_f32_16x16x32_bf16 v[92:95], v[44:47], a[100:103], v[92:95]
	buffer_load_dwordx4 v1, s[4:7], s85 offen offset:0 sc1 lds
	v_mfma_f32_16x16x32_bf16 v[96:99], v[48:51], a[96:99], v[96:99]
	ds_read_b128 v[44:47], v245 offset:3072
	v_add_f32 v130, v130, v146
	v_mfma_f32_16x16x32_bf16 v[100:103], v[48:51], a[100:103], v[100:103]
	v_add_f32 v131, v131, v147
	v_add_f32 v148, v148, v164
	v_mfma_f32_16x16x32_bf16 v[104:107], v[52:55], a[96:99], v[104:107]
	ds_read_b128 v[48:51], v245 offset:4096
	v_add_f32 v149, v149, v165
	v_mfma_f32_16x16x32_bf16 v[108:111], v[52:55], a[100:103], v[108:111]
	v_add_f32 v150, v150, v166
	v_add_f32 v151, v151, v167
	v_mfma_f32_16x16x32_bf16 v[64:67], v[56:59], a[104:107], v[64:67]
	ds_read_b128 v[52:55], v245 offset:5120
	v_mov_b32 v132, v128
	v_mfma_f32_16x16x32_bf16 v[68:71], v[56:59], a[108:111], v[68:71]
	v_mov_b32 v133, v129
	v_mov_b32 v134, v130
	v_mfma_f32_16x16x32_bf16 v[72:75], v[60:63], a[104:107], v[72:75]
	ds_read_b128 v[56:59], v245 offset:6144
	s_waitcnt lgkmcnt(3)
	v_mfma_f32_16x16x32_bf16 v[76:79], v[60:63], a[108:111], v[76:79]
	buffer_load_dwordx4 v1, s[4:7], s85 offen offset:1024 sc1 lds
	v_mfma_f32_16x16x32_bf16 v[80:83], v[32:35], a[104:107], v[80:83]
	ds_read_b128 v[60:63], v245 offset:7168
	v_mov_b32 v135, v131
	v_mfma_f32_16x16x32_bf16 v[84:87], v[32:35], a[108:111], v[84:87]
	v_mov_b32 v152, v148
	v_mov_b32 v153, v149
	v_mfma_f32_16x16x32_bf16 v[88:91], v[36:39], a[104:107], v[88:91]
	ds_read_b128 v[32:35], v245 offset:8192
	v_mov_b32 v154, v150
	v_mfma_f32_16x16x32_bf16 v[92:95], v[36:39], a[108:111], v[92:95]
	v_mov_b32 v155, v151
	v_permlane32_swap_b32 v128, v132
	v_mfma_f32_16x16x32_bf16 v[96:99], v[40:43], a[104:107], v[96:99]
	ds_read_b128 v[36:39], v245 offset:9216
	v_permlane32_swap_b32 v129, v133
	v_mfma_f32_16x16x32_bf16 v[100:103], v[40:43], a[108:111], v[100:103]
	v_permlane32_swap_b32 v130, v134
	v_permlane32_swap_b32 v131, v135
	v_mfma_f32_16x16x32_bf16 v[104:107], v[44:47], a[104:107], v[104:107]
	ds_read_b128 v[40:43], v245 offset:10240
	s_waitcnt lgkmcnt(3)
	v_mfma_f32_16x16x32_bf16 v[108:111], v[44:47], a[108:111], v[108:111]
	buffer_load_dwordx4 v1, s[4:7], s85 offen offset:2048 sc1 lds
	v_mfma_f32_16x16x32_bf16 v[64:67], v[48:51], a[112:115], v[64:67]
	ds_read_b128 v[44:47], v245 offset:11264
	v_permlane32_swap_b32 v148, v152
	v_mfma_f32_16x16x32_bf16 v[68:71], v[48:51], a[116:119], v[68:71]
	v_permlane32_swap_b32 v149, v153
	v_permlane32_swap_b32 v150, v154
	v_mfma_f32_16x16x32_bf16 v[72:75], v[52:55], a[112:115], v[72:75]
	ds_read_b128 v[48:51], v245 offset:12288
	v_permlane32_swap_b32 v151, v155
	v_mfma_f32_16x16x32_bf16 v[76:79], v[52:55], a[116:119], v[76:79]
	v_add_f32 v128, v128, v132
	v_add_f32 v129, v129, v133
	v_mfma_f32_16x16x32_bf16 v[80:83], v[56:59], a[112:115], v[80:83]
	ds_read_b128 v[52:55], v245 offset:13312
	v_add_f32 v130, v130, v134
	v_mfma_f32_16x16x32_bf16 v[84:87], v[56:59], a[116:119], v[84:87]
	v_add_f32 v131, v131, v135
	v_add_f32 v148, v148, v152
	v_mfma_f32_16x16x32_bf16 v[88:91], v[60:63], a[112:115], v[88:91]
	ds_read_b128 v[56:59], v245 offset:14336
	s_waitcnt lgkmcnt(3)
	v_mfma_f32_16x16x32_bf16 v[92:95], v[60:63], a[116:119], v[92:95]
	buffer_load_dwordx4 v1, s[4:7], s85 offen offset:3072 sc1 lds
	v_mfma_f32_16x16x32_bf16 v[96:99], v[32:35], a[112:115], v[96:99]
	ds_read_b128 v[60:63], v245 offset:15360
	v_add_f32 v149, v149, v153
	v_mfma_f32_16x16x32_bf16 v[100:103], v[32:35], a[116:119], v[100:103]
	v_add_f32 v150, v150, v154
	v_add_f32 v151, v151, v155
	v_mfma_f32_16x16x32_bf16 v[104:107], v[36:39], a[112:115], v[104:107]
	s_waitcnt vmcnt(4)
	s_barrier
	ds_read_b128 v[32:35], v245 offset:16384
	v_mfma_f32_16x16x32_bf16 v[108:111], v[36:39], a[116:119], v[108:111]
	v_mov_b32 v132, v128
	v_mov_b32 v133, v129
	v_mfma_f32_16x16x32_bf16 v[64:67], v[40:43], a[120:123], v[64:67]
	ds_read_b128 v[36:39], v245 offset:17408
	v_mov_b32 v134, v130
	v_mfma_f32_16x16x32_bf16 v[68:71], v[40:43], a[124:127], v[68:71]
	v_mov_b32 v135, v131
	v_mov_b32 v152, v148
	v_mfma_f32_16x16x32_bf16 v[72:75], v[44:47], a[120:123], v[72:75]
	ds_read_b128 v[40:43], v245 offset:18432
	v_mov_b32 v153, v149
	v_mfma_f32_16x16x32_bf16 v[76:79], v[44:47], a[124:127], v[76:79]
	v_mov_b32 v154, v150
	s_waitcnt lgkmcnt(3)
	v_mfma_f32_16x16x32_bf16 v[80:83], v[48:51], a[120:123], v[80:83]
	ds_read_b128 v[44:47], v245 offset:19456
	v_mov_b32 v155, v151
	v_mfma_f32_16x16x32_bf16 v[84:87], v[48:51], a[124:127], v[84:87]
	v_permlane16_swap_b32 v128, v132
	v_permlane16_swap_b32 v129, v133
	v_mfma_f32_16x16x32_bf16 v[88:91], v[52:55], a[120:123], v[88:91]
	ds_read_b128 v[48:51], v245 offset:20480
	v_permlane16_swap_b32 v130, v134
	v_mfma_f32_16x16x32_bf16 v[92:95], v[52:55], a[124:127], v[92:95]
	v_permlane16_swap_b32 v131, v135
	v_permlane16_swap_b32 v148, v152
	v_mfma_f32_16x16x32_bf16 v[96:99], v[56:59], a[120:123], v[96:99]
	ds_read_b128 v[52:55], v245 offset:21504
	v_permlane16_swap_b32 v149, v153
	v_mfma_f32_16x16x32_bf16 v[100:103], v[56:59], a[124:127], v[100:103]
	v_permlane16_swap_b32 v150, v154
	v_permlane16_swap_b32 v151, v155
	v_mfma_f32_16x16x32_bf16 v[104:107], v[60:63], a[120:123], v[104:107]
	ds_read_b128 v[56:59], v245 offset:22528
	v_add_f32 v128, v128, v132
	v_mfma_f32_16x16x32_bf16 v[108:111], v[60:63], a[124:127], v[108:111]
	v_add_f32 v129, v129, v133
	s_waitcnt lgkmcnt(3)
	v_mfma_f32_16x16x32_bf16 v[64:67], v[32:35], a[128:131], v[64:67]
	ds_read_b128 v[60:63], v245 offset:23552
	v_add_f32 v130, v130, v134
	v_mfma_f32_16x16x32_bf16 v[68:71], v[32:35], a[132:135], v[68:71]
	v_add_f32 v131, v131, v135
	v_add_f32 v148, v148, v152
	v_mfma_f32_16x16x32_bf16 v[72:75], v[36:39], a[128:131], v[72:75]
	ds_read_b128 v[32:35], v245 offset:24576
	v_add_f32 v149, v149, v153
	v_mfma_f32_16x16x32_bf16 v[76:79], v[36:39], a[132:135], v[76:79]
	v_add_f32 v150, v150, v154
	v_add_f32 v151, v151, v155
	v_mfma_f32_16x16x32_bf16 v[80:83], v[40:43], a[128:131], v[80:83]
	ds_read_b128 v[36:39], v245 offset:25600
	v_cvt_pk_bf16_f32 v137, v128, v128
	v_mfma_f32_16x16x32_bf16 v[84:87], v[40:43], a[132:135], v[84:87]
	v_lshlrev_b32 v136, 16, v137
	v_sub_f32 v136, v128, v136
	v_mfma_f32_16x16x32_bf16 v[88:91], v[44:47], a[128:131], v[88:91]
	ds_read_b128 v[40:43], v245 offset:26624
	v_and_b32 v137, 0xffff, v137
	v_mfma_f32_16x16x32_bf16 v[92:95], v[44:47], a[132:135], v[92:95]
	v_cvt_pk_bf16_f32 v136, v128, v136
	s_waitcnt lgkmcnt(3)
	v_mfma_f32_16x16x32_bf16 v[96:99], v[48:51], a[128:131], v[96:99]
	ds_read_b128 v[44:47], v245 offset:27648
	v_cvt_pk_bf16_f32 v139, v129, v129
	v_mfma_f32_16x16x32_bf16 v[100:103], v[48:51], a[132:135], v[100:103]
	v_lshlrev_b32 v138, 16, v139
	v_sub_f32 v138, v129, v138
	v_mfma_f32_16x16x32_bf16 v[104:107], v[52:55], a[128:131], v[104:107]
	ds_read_b128 v[48:51], v245 offset:28672
	v_and_b32 v139, 0xffff, v139
	v_mfma_f32_16x16x32_bf16 v[108:111], v[52:55], a[132:135], v[108:111]
	v_cvt_pk_bf16_f32 v138, v129, v138
	v_cvt_pk_bf16_f32 v141, v130, v130
	v_mfma_f32_16x16x32_bf16 v[64:67], v[56:59], a[136:139], v[64:67]
	ds_read_b128 v[52:55], v245 offset:29696
	v_lshlrev_b32 v140, 16, v141
	v_mfma_f32_16x16x32_bf16 v[68:71], v[56:59], a[140:143], v[68:71]
	v_sub_f32 v140, v130, v140
	v_and_b32 v141, 0xffff, v141
	v_mfma_f32_16x16x32_bf16 v[72:75], v[60:63], a[136:139], v[72:75]
	ds_read_b128 v[56:59], v245 offset:30720
	v_cvt_pk_bf16_f32 v140, v130, v140
	v_mfma_f32_16x16x32_bf16 v[76:79], v[60:63], a[140:143], v[76:79]
	v_cvt_pk_bf16_f32 v143, v131, v131
	s_waitcnt lgkmcnt(3)
	v_mfma_f32_16x16x32_bf16 v[80:83], v[32:35], a[136:139], v[80:83]
	ds_read_b128 v[60:63], v245 offset:31744
	v_lshlrev_b32 v142, 16, v143
	v_mfma_f32_16x16x32_bf16 v[84:87], v[32:35], a[140:143], v[84:87]
	v_sub_f32 v142, v131, v142
	v_and_b32 v143, 0xffff, v143
	v_mfma_f32_16x16x32_bf16 v[88:91], v[36:39], a[136:139], v[88:91]
	s_waitcnt vmcnt(0)
	s_barrier
	ds_read_b128 v[32:35], v2 offset:16384
	v_mfma_f32_16x16x32_bf16 v[92:95], v[36:39], a[140:143], v[92:95]
	v_cvt_pk_bf16_f32 v142, v131, v142
	v_cvt_pk_bf16_f32 v157, v148, v148
	v_mfma_f32_16x16x32_bf16 v[96:99], v[40:43], a[136:139], v[96:99]
	ds_read_b128 v[36:39], v2 offset:17408
	v_lshlrev_b32 v156, 16, v157
	v_mfma_f32_16x16x32_bf16 v[100:103], v[40:43], a[140:143], v[100:103]
	v_sub_f32 v156, v148, v156
	v_and_b32 v157, 0xffff, v157
	v_mfma_f32_16x16x32_bf16 v[104:107], v[44:47], a[136:139], v[104:107]
	ds_read_b128 v[40:43], v2 offset:18432
	v_cvt_pk_bf16_f32 v156, v148, v156
	v_mfma_f32_16x16x32_bf16 v[108:111], v[44:47], a[140:143], v[108:111]
	v_cvt_pk_bf16_f32 v159, v149, v149
	s_waitcnt lgkmcnt(3)
	v_mfma_f32_16x16x32_bf16 v[64:67], v[48:51], a[144:147], v[64:67]
	ds_read_b128 v[44:47], v2 offset:19456
	v_lshlrev_b32 v158, 16, v159
	v_mfma_f32_16x16x32_bf16 v[68:71], v[48:51], a[148:151], v[68:71]
	v_sub_f32 v158, v149, v158
	v_and_b32 v159, 0xffff, v159
	v_mfma_f32_16x16x32_bf16 v[72:75], v[52:55], a[144:147], v[72:75]
	ds_read_b128 v[48:51], v2 offset:20480
	v_cvt_pk_bf16_f32 v158, v149, v158
	v_mfma_f32_16x16x32_bf16 v[76:79], v[52:55], a[148:151], v[76:79]
	v_cvt_pk_bf16_f32 v161, v150, v150
	v_lshlrev_b32 v160, 16, v161
	v_mfma_f32_16x16x32_bf16 v[80:83], v[56:59], a[144:147], v[80:83]
	ds_read_b128 v[52:55], v2 offset:21504
	v_sub_f32 v160, v150, v160
	v_mfma_f32_16x16x32_bf16 v[84:87], v[56:59], a[148:151], v[84:87]
	v_and_b32 v161, 0xffff, v161
	v_cvt_pk_bf16_f32 v160, v150, v160
	v_mfma_f32_16x16x32_bf16 v[88:91], v[60:63], a[144:147], v[88:91]
	ds_read_b128 v[56:59], v2 offset:22528
	v_cvt_pk_bf16_f32 v163, v151, v151
	v_mfma_f32_16x16x32_bf16 v[92:95], v[60:63], a[148:151], v[92:95]
	v_lshlrev_b32 v162, 16, v163
	s_waitcnt lgkmcnt(3)
	v_mfma_f32_16x16x32_bf16 v[96:99], v[32:35], a[144:147], v[96:99]
	ds_read_b128 v[60:63], v2 offset:23552
	v_sub_f32 v162, v151, v162
	v_mfma_f32_16x16x32_bf16 v[100:103], v[32:35], a[148:151], v[100:103]
	v_and_b32 v163, 0xffff, v163
	v_cvt_pk_bf16_f32 v162, v151, v162
	v_mfma_f32_16x16x32_bf16 v[104:107], v[36:39], a[144:147], v[104:107]
	ds_read_b128 v[32:35], v2 offset:24576
	ds_write_b128 v218, v[136:139]
	ds_write_b128 v218, v[140:143] offset:16
	ds_write_b128 v217, v[156:159]
	ds_write_b128 v217, v[160:163] offset:16
	s_waitcnt lgkmcnt(0)
	s_barrier
	ds_read_b64 a[176:177], v216 offset:0
	ds_read_b64 a[178:179], v216 offset:128
	ds_read_b64 a[180:181], v216 offset:256
	ds_read_b64 a[182:183], v216 offset:384
	ds_read_b64 a[184:185], v216 offset:512
	ds_read_b64 a[186:187], v216 offset:640
	ds_read_b64 a[188:189], v216 offset:768
	ds_read_b64 a[190:191], v216 offset:896
	ds_read_b64 a[192:193], v207 offset:1024
	ds_read_b64 a[194:195], v207 offset:1152
	ds_read_b64 a[196:197], v207 offset:1280
	ds_read_b64 a[198:199], v207 offset:1408
	ds_read_b64 a[200:201], v207 offset:1536
	ds_read_b64 a[202:203], v207 offset:1664
	ds_read_b64 a[204:205], v207 offset:1792
	ds_read_b64 a[206:207], v207 offset:1920
	ds_read_b64 a[208:209], v207 offset:2048
	ds_read_b64 a[210:211], v207 offset:2176
	ds_read_b64 a[212:213], v207 offset:2304
	ds_read_b64 a[214:215], v207 offset:2432
	v_mfma_f32_16x16x32_bf16 v[108:111], v[36:39], a[148:151], v[108:111]
	v_add_f32 v168, v184, v188
	v_add_f32 v169, v185, v189
	v_mfma_f32_16x16x32_bf16 v[64:67], v[40:43], a[152:155], v[64:67]
	ds_read_b128 v[36:39], v2 offset:25600
	v_add_f32 v170, v186, v190
	v_mfma_f32_16x16x32_bf16 v[68:71], v[40:43], a[156:159], v[68:71]
	v_add_f32 v171, v187, v191
	v_add_f32 v168, v168, v170
	v_mfma_f32_16x16x32_bf16 v[72:75], v[44:47], a[152:155], v[72:75]
	ds_read_b128 v[40:43], v2 offset:26624
	v_add_f32 v169, v169, v171
	v_mfma_f32_16x16x32_bf16 v[76:79], v[44:47], a[156:159], v[76:79]
	v_mov_b32 v186, 0
	v_mov_b32 v187, 0
	v_mfma_f32_16x16x32_bf16 v[80:83], v[48:51], a[152:155], v[80:83]
	ds_read_b128 v[44:47], v2 offset:27648
	v_permlane32_swap_b32 v168, v169
	v_mfma_f32_16x16x32_bf16 v[84:87], v[48:51], a[156:159], v[84:87]
	v_add_f32 v168, v168, v169
	v_mov_b32 v169, v168
	v_mfma_f32_16x16x32_bf16 v[88:91], v[52:55], a[152:155], v[88:91]
	ds_read_b128 v[48:51], v2 offset:28672
	v_mov_b32 v190, 0
	v_mfma_f32_16x16x32_bf16 v[92:95], v[52:55], a[156:159], v[92:95]
	v_mov_b32 v191, 0
	v_permlane32_swap_b32 v168, v169
	v_mfma_f32_16x16x32_bf16 v[96:99], v[56:59], a[152:155], v[96:99]
	ds_read_b128 v[52:55], v2 offset:29696
	v_mul_f32 v170, 0xbacccccd, v168
	v_mfma_f32_16x16x32_bf16 v[100:103], v[56:59], a[156:159], v[100:103]
	v_mul_f32 v171, 0xbacccccd, v168
	s_mov_b32 s78, 0xffff
	v_mfma_f32_16x16x32_bf16 v[104:107], v[60:63], a[152:155], v[104:107]
	ds_read_b128 v[56:59], v2 offset:30720
	s_mov_b32 s79, 0
	v_mfma_f32_16x16x32_bf16 v[108:111], v[60:63], a[156:159], v[108:111]
	v_permlane16_swap_b32 v170, v171
	v_cndmask_b32 v170, 0, v170, s[78:79]
	v_cvt_pk_bf16_f32 v184, v170, v170
	v_lshlrev_b32 v185, 16, v184
	v_sub_f32 v170, v170, v185
	v_cvt_pk_bf16_f32 v185, v170, 0
	v_cndmask_b32 v171, 0, v171, s[78:79]
	v_cvt_pk_bf16_f32 v188, v171, v171
	v_lshlrev_b32 v189, 16, v188
	v_sub_f32 v171, v171, v189
	v_cvt_pk_bf16_f32 v189, v171, 0
	v_mul_f32 v168, 0x3acccccd, v168
	v_mul_f32 v169, 0x3acccccd, v169
	v_fma_f32 v169, -v168, v168, v169
	v_max_f32 v169, 0, v169
	v_add_f32 v169, 0x3727c5ac, v169
	v_rsq_f32 v228, v169
	v_mov_b32 v170, 0
	v_mul_f32 v224, 0x3fb8aa3b, v228
	v_mul_f32 v225, 0xbfb8aa3b, v228
	s_waitcnt lgkmcnt(6)
	v_mfma_f32_16x16x32_bf16 v[64:67], a[176:179], v[184:187], v[64:67]
	v_mfma_f32_16x16x32_bf16 v[68:71], a[176:179], v[188:191], v[68:71]
	v_mfma_f32_16x16x32_bf16 v[72:75], a[178:181], v[184:187], v[72:75]
	v_mfma_f32_16x16x32_bf16 v[76:79], a[178:181], v[188:191], v[76:79]
	v_mfma_f32_16x16x32_bf16 v[80:83], a[180:183], v[184:187], v[80:83]
	v_mfma_f32_16x16x32_bf16 v[84:87], a[180:183], v[188:191], v[84:87]
	v_mfma_f32_16x16x32_bf16 v[88:91], a[182:185], v[184:187], v[88:91]
	v_mfma_f32_16x16x32_bf16 v[92:95], a[182:185], v[188:191], v[92:95]
	v_mfma_f32_16x16x32_bf16 v[96:99], a[184:187], v[184:187], v[96:99]
	v_mfma_f32_16x16x32_bf16 v[100:103], a[184:187], v[188:191], v[100:103]
	v_mfma_f32_16x16x32_bf16 v[104:107], a[186:189], v[184:187], v[104:107]
	v_mfma_f32_16x16x32_bf16 v[108:111], a[186:189], v[188:191], v[108:111]
	s_waitcnt vmcnt(0) lgkmcnt(0)
L_join:
	s_barrier
	s_add_u32 m0, s51, 98304
	s_add_u32 s85, s52, 131072
	buffer_load_dwordx4 v1, s[4:7], s85 offen offset:0 sc1 lds
	v_xor_b32 v177, 16, v232
	v_xor_b32 v178, 32, v232
	v_xor_b32 v179, 48, v232
	v_xor_b32 v180, 64, v232
	v_xor_b32 v181, 80, v232
	v_xor_b32 v182, 96, v232
	v_xor_b32 v183, 112, v232
	v_mov_b32 v222, 0x3f80
	v_mov_b32 v223, 0
	v_permlane16_swap_b32 v80, v84
	v_permlane16_swap_b32 v81, v85
	v_permlane16_swap_b32 v82, v86
	v_permlane16_swap_b32 v83, v87
	v_permlane16_swap_b32 v88, v92
	v_permlane16_swap_b32 v89, v93
	v_permlane16_swap_b32 v90, v94
	v_permlane16_swap_b32 v91, v95
	v_permlane16_swap_b32 v96, v100
	v_permlane16_swap_b32 v97, v101
	buffer_load_dwordx4 v1, s[4:7], s85 offen offset:1024 sc1 lds
	v_permlane16_swap_b32 v98, v102
	v_permlane16_swap_b32 v99, v103
	v_permlane16_swap_b32 v64, v68
	v_permlane16_swap_b32 v65, v69
	v_permlane16_swap_b32 v66, v70
	v_permlane16_swap_b32 v67, v71
	v_permlane16_swap_b32 v72, v76
	v_permlane16_swap_b32 v73, v77
	v_permlane16_swap_b32 v74, v78
	v_permlane16_swap_b32 v75, v79
	v_permlane16_swap_b32 v104, v108
	v_permlane16_swap_b32 v105, v109
	v_permlane16_swap_b32 v106, v110
	v_permlane16_swap_b32 v107, v111
	v_pk_mul_f32 v[80:81], v[80:81], v[228:229] op_sel_hi:[1,0]
	v_pk_mul_f32 v[82:83], v[82:83], v[228:229] op_sel_hi:[1,0]
	v_pk_mul_f32 v[84:85], v[84:85], v[228:229] op_sel_hi:[1,0]
	v_pk_mul_f32 v[86:87], v[86:87], v[228:229] op_sel_hi:[1,0]
	v_pk_mul_f32 v[88:89], v[88:89], v[228:229] op_sel_hi:[1,0]
	buffer_load_dwordx4 v1, s[4:7], s85 offen offset:2048 sc1 lds
	v_pk_mul_f32 v[90:91], v[90:91], v[228:229] op_sel_hi:[1,0]
	v_pk_mul_f32 v[92:93], v[92:93], v[228:229] op_sel_hi:[1,0]
	v_pk_mul_f32 v[94:95], v[94:95], v[228:229] op_sel_hi:[1,0]
	v_pk_mul_f32 v[100:101], v[100:101], v[228:229] op_sel_hi:[1,0]
	v_pk_mul_f32 v[102:103], v[102:103], v[228:229] op_sel_hi:[1,0]
	v_cvt_pk_bf16_f32 v212, v80, v81
	v_cvt_pk_bf16_f32 v213, v82, v83
	v_cvt_pk_bf16_f32 v214, v84, v85
	v_cvt_pk_bf16_f32 v215, v86, v87
	v_cvt_pk_bf16_f32 v216, v88, v89
	v_cvt_pk_bf16_f32 v217, v90, v91
	v_cvt_pk_bf16_f32 v218, v92, v93
	v_cvt_pk_bf16_f32 v219, v94, v95
	v_cvt_pk_bf16_f32 v220, v100, v101
	v_cvt_pk_bf16_f32 v221, v102, v103
	ds_write_b128 v181, v[212:215]
	v_max3_f32 v168, v64, v65, v66
	v_min3_f32 v169, v64, v65, v66
	v_max3_f32 v170, v67, v68, v69
	buffer_load_dwordx4 v1, s[4:7], s85 offen offset:3072 sc1 lds
	v_min3_f32 v171, v67, v68, v69
	v_max3_f32 v168, v168, v70, v71
	v_min3_f32 v169, v169, v70, v71
	v_max3_f32 v170, v170, v72, v73
	v_min3_f32 v171, v171, v72, v73
	v_max3_f32 v168, v168, v74, v75
	v_min3_f32 v169, v169, v74, v75
	v_max3_f32 v170, v170, v76, v77
	v_min3_f32 v171, v171, v76, v77
	ds_write_b128 v182, v[216:219]
	v_max3_f32 v168, v168, v78, v79
	v_min3_f32 v169, v169, v78, v79
	v_max3_f32 v170, v170, v96, v97
	v_min3_f32 v171, v171, v96, v97
	v_max3_f32 v168, v168, v98, v99
	v_min3_f32 v169, v169, v98, v99
	v_max_f32 v168, v168, v170
	v_min_f32 v169, v169, v171
	v_mul_f32 v226, v168, v225
	s_add_u32 m0, s51, 114688
	s_add_u32 s85, s52, 147456
	buffer_load_dwordx4 v1, s[4:7], s85 offen offset:0 sc1 lds
	v_mul_f32 v227, v169, v224
	v_pk_fma_f32 v[128:129], v[64:65], v[224:225], v[226:227] op_sel_hi:[1,0,0]
	v_pk_fma_f32 v[148:149], v[64:65], v[224:225], v[226:227] op_sel:[0,1,1] op_sel_hi:[1,1,1]
	ds_write_b128 v183, v[220:223]
	v_pk_fma_f32 v[130:131], v[66:67], v[224:225], v[226:227] op_sel_hi:[1,0,0]
	v_pk_fma_f32 v[150:151], v[66:67], v[224:225], v[226:227] op_sel:[0,1,1] op_sel_hi:[1,1,1]
	v_pk_fma_f32 v[132:133], v[68:69], v[224:225], v[226:227] op_sel_hi:[1,0,0]
	v_pk_fma_f32 v[152:153], v[68:69], v[224:225], v[226:227] op_sel:[0,1,1] op_sel_hi:[1,1,1]
	v_pk_fma_f32 v[134:135], v[70:71], v[224:225], v[226:227] op_sel_hi:[1,0,0]
	v_pk_fma_f32 v[154:155], v[70:71], v[224:225], v[226:227] op_sel:[0,1,1] op_sel_hi:[1,1,1]
	v_pk_fma_f32 v[136:137], v[72:73], v[224:225], v[226:227] op_sel_hi:[1,0,0]
	v_pk_fma_f32 v[156:157], v[72:73], v[224:225], v[226:227] op_sel:[0,1,1] op_sel_hi:[1,1,1]
	v_pk_fma_f32 v[138:139], v[74:75], v[224:225], v[226:227] op_sel_hi:[1,0,0]
	v_pk_fma_f32 v[158:159], v[74:75], v[224:225], v[226:227] op_sel:[0,1,1] op_sel_hi:[1,1,1]
	v_pk_fma_f32 v[140:141], v[76:77], v[224:225], v[226:227] op_sel_hi:[1,0,0]
	v_pk_fma_f32 v[160:161], v[76:77], v[224:225], v[226:227] op_sel:[0,1,1] op_sel_hi:[1,1,1]
	v_pk_fma_f32 v[142:143], v[78:79], v[224:225], v[226:227] op_sel_hi:[1,0,0]
	v_pk_fma_f32 v[162:163], v[78:79], v[224:225], v[226:227] op_sel:[0,1,1] op_sel_hi:[1,1,1]
	v_pk_fma_f32 v[144:145], v[96:97], v[224:225], v[226:227] op_sel_hi:[1,0,0]
	buffer_load_dwordx4 v1, s[4:7], s85 offen offset:1024 sc1 lds
	v_pk_fma_f32 v[164:165], v[96:97], v[224:225], v[226:227] op_sel:[0,1,1] op_sel_hi:[1,1,1]
	v_pk_fma_f32 v[146:147], v[98:99], v[224:225], v[226:227] op_sel_hi:[1,0,0]
	v_pk_fma_f32 v[166:167], v[98:99], v[224:225], v[226:227] op_sel:[0,1,1] op_sel_hi:[1,1,1]
	v_exp_f32 v128, v128
	v_exp_f32 v129, v129
	v_exp_f32 v130, v130
	v_exp_f32 v131, v131
	v_exp_f32 v132, v132
	v_exp_f32 v133, v133
	v_exp_f32 v134, v134
	v_exp_f32 v135, v135
	v_exp_f32 v136, v136
	v_exp_f32 v137, v137
	v_exp_f32 v138, v138
	v_exp_f32 v139, v139
	v_exp_f32 v140, v140
	v_exp_f32 v141, v141
	v_exp_f32 v142, v142
	v_exp_f32 v143, v143
	buffer_load_dwordx4 v1, s[4:7], s85 offen offset:2048 sc1 lds
	v_exp_f32 v144, v144
	v_exp_f32 v145, v145
	v_exp_f32 v146, v146
	v_exp_f32 v147, v147
	v_exp_f32 v148, v148
	v_exp_f32 v149, v149
	v_exp_f32 v150, v150
	v_exp_f32 v151, v151
	v_exp_f32 v152, v152
	v_exp_f32 v153, v153
	v_exp_f32 v154, v154
	v_exp_f32 v155, v155
	v_exp_f32 v156, v156
	v_exp_f32 v157, v157
	v_exp_f32 v158, v158
	v_exp_f32 v159, v159
	v_exp_f32 v160, v160
	v_exp_f32 v161, v161
	v_exp_f32 v162, v162
	buffer_load_dwordx4 v1, s[4:7], s85 offen offset:3072 sc1 lds
	v_exp_f32 v163, v163
	v_exp_f32 v164, v164
	v_exp_f32 v165, v165
	v_exp_f32 v166, v166
	v_exp_f32 v167, v167
	v_pk_add_f32 v[168:169], v[128:129], v[130:131]
	v_pk_add_f32 v[170:171], v[132:133], v[134:135]
	v_pk_add_f32 v[172:173], v[148:149], v[150:151]
	v_pk_add_f32 v[174:175], v[152:153], v[154:155]
	v_pk_add_f32 v[168:169], v[168:169], v[136:137]
	v_pk_add_f32 v[172:173], v[172:173], v[156:157]
	v_pk_add_f32 v[170:171], v[170:171], v[138:139]
	v_pk_add_f32 v[174:175], v[174:175], v[158:159]
	v_pk_add_f32 v[168:169], v[168:169], v[140:141]
	v_pk_add_f32 v[172:173], v[172:173], v[160:161]
	v_pk_add_f32 v[170:171], v[170:171], v[142:143]
	v_pk_add_f32 v[174:175], v[174:175], v[162:163]
	v_pk_add_f32 v[168:169], v[168:169], v[144:145]
	v_pk_add_f32 v[172:173], v[172:173], v[164:165]
	s_add_u32 m0, s51, 0
	s_add_u32 s85, s53, 0
	buffer_load_dwordx4 v1, s[4:7], s85 offen offset:0 sc1 lds
	v_pk_add_f32 v[170:171], v[170:171], v[146:147]
	v_pk_add_f32 v[174:175], v[174:175], v[166:167]
	v_pk_add_f32 v[168:169], v[168:169], v[170:171]
	v_pk_add_f32 v[172:173], v[172:173], v[174:175]
	v_add_f32 v168, v168, v169
	v_add_f32 v172, v172, v173
	v_rcp_f32 v230, v168
	v_rcp_f32 v231, v172
	s_nop 0
	v_pk_mul_f32 v[128:129], v[128:129], v[230:231] op_sel_hi:[1,0]
	v_pk_mul_f32 v[130:131], v[130:131], v[230:231] op_sel_hi:[1,0]
	v_pk_mul_f32 v[132:133], v[132:133], v[230:231] op_sel_hi:[1,0]
	v_pk_mul_f32 v[134:135], v[134:135], v[230:231] op_sel_hi:[1,0]
	v_pk_mul_f32 v[136:137], v[136:137], v[230:231] op_sel_hi:[1,0]
	v_pk_mul_f32 v[138:139], v[138:139], v[230:231] op_sel_hi:[1,0]
	v_pk_mul_f32 v[140:141], v[140:141], v[230:231] op_sel_hi:[1,0]
	v_pk_mul_f32 v[142:143], v[142:143], v[230:231] op_sel_hi:[1,0]
	v_pk_mul_f32 v[144:145], v[144:145], v[230:231] op_sel_hi:[1,0]
	v_pk_mul_f32 v[146:147], v[146:147], v[230:231] op_sel_hi:[1,0]
	v_pk_mul_f32 v[148:149], v[148:149], v[230:231] op_sel:[0,1] op_sel_hi:[1,1]
	buffer_load_dwordx4 v1, s[4:7], s85 offen offset:1024 sc1 lds
	v_pk_mul_f32 v[150:151], v[150:151], v[230:231] op_sel:[0,1] op_sel_hi:[1,1]
	v_pk_mul_f32 v[152:153], v[152:153], v[230:231] op_sel:[0,1] op_sel_hi:[1,1]
	v_pk_mul_f32 v[154:155], v[154:155], v[230:231] op_sel:[0,1] op_sel_hi:[1,1]
	v_pk_mul_f32 v[156:157], v[156:157], v[230:231] op_sel:[0,1] op_sel_hi:[1,1]
	v_pk_mul_f32 v[158:159], v[158:159], v[230:231] op_sel:[0,1] op_sel_hi:[1,1]
	v_pk_mul_f32 v[160:161], v[160:161], v[230:231] op_sel:[0,1] op_sel_hi:[1,1]
	v_pk_mul_f32 v[162:163], v[162:163], v[230:231] op_sel:[0,1] op_sel_hi:[1,1]
	v_pk_mul_f32 v[164:165], v[164:165], v[230:231] op_sel:[0,1] op_sel_hi:[1,1]
	v_pk_mul_f32 v[166:167], v[166:167], v[230:231] op_sel:[0,1] op_sel_hi:[1,1]
	v_cvt_pk_bf16_f32 v192, v128, v129
	v_cvt_pk_bf16_f32 v193, v130, v131
	v_cvt_pk_bf16_f32 v194, v132, v133
	v_cvt_pk_bf16_f32 v195, v134, v135
	ds_write_b128 v232, v[192:195]
	v_cvt_pk_bf16_f32 v196, v136, v137
	v_cvt_pk_bf16_f32 v197, v138, v139
	v_cvt_pk_bf16_f32 v198, v140, v141
	v_cvt_pk_bf16_f32 v199, v142, v143
	ds_write_b128 v177, v[196:199]
	v_cvt_pk_bf16_f32 v200, v144, v145
	v_cvt_pk_bf16_f32 v201, v146, v147
	v_cvt_pk_bf16_f32 v202, v148, v149
	v_cvt_pk_bf16_f32 v203, v150, v151
	ds_write_b128 v178, v[200:203]
	v_cvt_pk_bf16_f32 v204, v152, v153
	v_cvt_pk_bf16_f32 v205, v154, v155
	v_cvt_pk_bf16_f32 v206, v156, v157
	v_cvt_pk_bf16_f32 v207, v158, v159
	ds_write_b128 v179, v[204:207]
	v_cvt_pk_bf16_f32 v208, v160, v161
	v_cvt_pk_bf16_f32 v209, v162, v163
	v_cvt_pk_bf16_f32 v210, v164, v165
	v_cvt_pk_bf16_f32 v211, v166, v167
	ds_write_b128 v180, v[208:211]
	s_waitcnt lgkmcnt(0)
	s_barrier
	ds_read_b64_tr_b16 v[128:129], v233 offset:0
	ds_read_b64_tr_b16 v[130:131], v234 offset:0
	ds_read_b64_tr_b16 v[192:193], v235 offset:0
	ds_read_b64_tr_b16 v[194:195], v236 offset:0
	ds_read_b64_tr_b16 v[132:133], v233 offset:2048
	ds_read_b64_tr_b16 v[134:135], v234 offset:2048
	ds_read_b64_tr_b16 v[196:197], v235 offset:2048
	ds_read_b64_tr_b16 v[198:199], v236 offset:2048
	ds_read_b64_tr_b16 v[136:137], v233 offset:4096
	ds_read_b64_tr_b16 v[138:139], v234 offset:4096
	ds_read_b64_tr_b16 v[200:201], v235 offset:4096
	ds_read_b64_tr_b16 v[202:203], v236 offset:4096
	s_waitcnt lgkmcnt(8)
	v_mfma_f32_32x32x16_bf16 v[160:175], v[128:131], v[192:195], 0
	buffer_load_dwordx4 v1, s[4:7], s85 offen offset:2048 sc1 lds
	ds_read_b64_tr_b16 v[140:141], v233 offset:6144
	ds_read_b64_tr_b16 v[142:143], v234 offset:6144
	ds_read_b64_tr_b16 v[204:205], v235 offset:6144
	ds_read_b64_tr_b16 v[206:207], v236 offset:6144
	s_waitcnt lgkmcnt(8)
	v_mfma_f32_32x32x16_bf16 v[160:175], v[132:135], v[196:199], v[160:175]
	buffer_load_dwordx4 v1, s[4:7], s85 offen offset:3072 sc1 lds
	ds_read_b64_tr_b16 v[144:145], v233 offset:8192
	ds_read_b64_tr_b16 v[146:147], v234 offset:8192
	ds_read_b64_tr_b16 v[208:209], v235 offset:8192
	ds_read_b64_tr_b16 v[210:211], v236 offset:8192
	s_waitcnt lgkmcnt(8)
	v_mfma_f32_32x32x16_bf16 v[160:175], v[136:139], v[200:203], v[160:175]
	s_add_u32 m0, s51, 16384
	s_add_u32 s85, s53, 16384
	buffer_load_dwordx4 v1, s[4:7], s85 offen offset:0 sc1 lds
	ds_read_b64_tr_b16 v[148:149], v233 offset:10240
	ds_read_b64_tr_b16 v[150:151], v234 offset:10240
	ds_read_b64_tr_b16 v[212:213], v235 offset:10240
	ds_read_b64_tr_b16 v[214:215], v236 offset:10240
	s_waitcnt lgkmcnt(8)
	v_mfma_f32_32x32x16_bf16 v[160:175], v[140:143], v[204:207], v[160:175]
	ds_read_b64_tr_b16 v[152:153], v233 offset:12288
	ds_read_b64_tr_b16 v[154:155], v234 offset:12288
	ds_read_b64_tr_b16 v[216:217], v235 offset:12288
	ds_read_b64_tr_b16 v[218:219], v236 offset:12288
	s_waitcnt lgkmcnt(8)
	v_mfma_f32_32x32x16_bf16 v[160:175], v[144:147], v[208:211], v[160:175]
	buffer_load_dwordx4 v1, s[4:7], s85 offen offset:1024 sc1 lds
	ds_read_b64_tr_b16 v[156:157], v233 offset:14336
	ds_read_b64_tr_b16 v[158:159], v234 offset:14336
	ds_read_b64_tr_b16 v[220:221], v235 offset:14336
	ds_read_b64_tr_b16 v[222:223], v236 offset:14336
	s_waitcnt lgkmcnt(8)
	v_mfma_f32_32x32x16_bf16 v[160:175], v[148:151], v[212:215], v[160:175]
	buffer_load_dwordx4 v1, s[4:7], s85 offen offset:2048 sc1 lds
	s_waitcnt lgkmcnt(4)
	v_mfma_f32_32x32x16_bf16 v[160:175], v[152:155], v[216:219], v[160:175]
	buffer_load_dwordx4 v1, s[4:7], s85 offen offset:3072 sc1 lds
	s_waitcnt lgkmcnt(0)
	v_mfma_f32_32x32x16_bf16 v[160:175], v[156:159], v[220:223], v[160:175]
	v_mfma_f32_16x16x32_bf16 v[112:115], v[32:35], a[0:3], 0
	ds_read_b128 v[60:63], v2 offset:31744
	v_mfma_f32_16x16x32_bf16 v[116:119], v[32:35], a[4:7], 0
	v_mfma_f32_16x16x32_bf16 v[120:123], v[36:39], a[0:3], 0
	s_waitcnt vmcnt(12)
	s_barrier
	ds_read_b128 v[32:35], v2 offset:32768
	v_mfma_f32_16x16x32_bf16 v[124:127], v[36:39], a[4:7], 0
	s_nop 3
	v_cvt_pk_bf16_f32 v176, v160, v161
	v_cvt_pk_bf16_f32 v177, v162, v163
	v_mfma_f32_16x16x32_bf16 v[112:115], v[40:43], a[8:11], v[112:115]
	ds_read_b128 v[36:39], v2 offset:33792
	v_cvt_pk_bf16_f32 v178, v164, v165
	v_mfma_f32_16x16x32_bf16 v[116:119], v[40:43], a[12:15], v[116:119]
	v_cvt_pk_bf16_f32 v179, v166, v167
	v_cvt_pk_bf16_f32 v180, v168, v169
	v_mfma_f32_16x16x32_bf16 v[120:123], v[44:47], a[8:11], v[120:123]
	ds_read_b128 v[40:43], v2 offset:34816
	v_cvt_pk_bf16_f32 v181, v170, v171
	v_mfma_f32_16x16x32_bf16 v[124:127], v[44:47], a[12:15], v[124:127]
	v_mfma_f32_16x16x32_bf16 v[112:115], v[48:51], a[16:19], v[112:115]
	ds_read_b128 v[44:47], v2 offset:35840
	v_mfma_f32_16x16x32_bf16 v[116:119], v[48:51], a[20:23], v[116:119]
	v_mfma_f32_16x16x32_bf16 v[120:123], v[52:55], a[16:19], v[120:123]
	ds_read_b128 v[48:51], v2 offset:36864
	v_mfma_f32_16x16x32_bf16 v[124:127], v[52:55], a[20:23], v[124:127]
	buffer_store_dwordx2 v[176:177], v237, s[4:7], s64 offen sc1
	v_mfma_f32_16x16x32_bf16 v[112:115], v[56:59], a[24:27], v[112:115]
	ds_read_b128 v[52:55], v2 offset:37888
	s_waitcnt lgkmcnt(3)
	v_mfma_f32_16x16x32_bf16 v[116:119], v[56:59], a[28:31], v[116:119]
	buffer_store_dwordx2 v[178:179], v237, s[4:7], s64 offen offset:384 sc1
	v_mfma_f32_16x16x32_bf16 v[120:123], v[60:63], a[24:27], v[120:123]
	ds_read_b128 v[56:59], v2 offset:38912
	v_mfma_f32_16x16x32_bf16 v[124:127], v[60:63], a[28:31], v[124:127]
	buffer_store_dwordx2 v[180:181], v238, s[4:7], s64 offen sc1
	v_mfma_f32_16x16x32_bf16 v[112:115], v[32:35], a[32:35], v[112:115]
	ds_read_b128 v[60:63], v2 offset:39936
	v_mfma_f32_16x16x32_bf16 v[116:119], v[32:35], a[36:39], v[116:119]
	s_add_u32 m0, s51, 32768
	s_add_u32 s85, s53, 32768
	v_mfma_f32_16x16x32_bf16 v[120:123], v[36:39], a[32:35], v[120:123]
	ds_read_b128 v[32:35], v2 offset:40960
	v_mfma_f32_16x16x32_bf16 v[124:127], v[36:39], a[36:39], v[124:127]
	buffer_load_dwordx4 v1, s[4:7], s85 offen offset:0 sc1 lds
	v_mfma_f32_16x16x32_bf16 v[112:115], v[40:43], a[40:43], v[112:115]
	ds_read_b128 v[36:39], v2 offset:41984
	v_mfma_f32_16x16x32_bf16 v[116:119], v[40:43], a[44:47], v[116:119]
	s_waitcnt lgkmcnt(3)
	v_mfma_f32_16x16x32_bf16 v[120:123], v[44:47], a[40:43], v[120:123]
	ds_read_b128 v[40:43], v2 offset:43008
	v_mfma_f32_16x16x32_bf16 v[124:127], v[44:47], a[44:47], v[124:127]
	buffer_load_dwordx4 v1, s[4:7], s85 offen offset:1024 sc1 lds
	v_mfma_f32_16x16x32_bf16 v[112:115], v[48:51], a[48:51], v[112:115]
	ds_read_b128 v[44:47], v2 offset:44032
	v_mfma_f32_16x16x32_bf16 v[116:119], v[48:51], a[52:55], v[116:119]
	v_mfma_f32_16x16x32_bf16 v[120:123], v[52:55], a[48:51], v[120:123]
	ds_read_b128 v[48:51], v2 offset:45056
	v_mfma_f32_16x16x32_bf16 v[124:127], v[52:55], a[52:55], v[124:127]
	buffer_load_dwordx4 v1, s[4:7], s85 offen offset:2048 sc1 lds
	v_mfma_f32_16x16x32_bf16 v[112:115], v[56:59], a[56:59], v[112:115]
	ds_read_b128 v[52:55], v2 offset:46080
	v_mfma_f32_16x16x32_bf16 v[116:119], v[56:59], a[60:63], v[116:119]
	s_waitcnt lgkmcnt(3)
	v_mfma_f32_16x16x32_bf16 v[120:123], v[60:63], a[56:59], v[120:123]
	ds_read_b128 v[56:59], v2 offset:47104
	v_mfma_f32_16x16x32_bf16 v[124:127], v[60:63], a[60:63], v[124:127]
	buffer_load_dwordx4 v1, s[4:7], s85 offen offset:3072 sc1 lds
	v_mfma_f32_16x16x32_bf16 v[112:115], v[32:35], a[64:67], v[112:115]
	ds_read_b128 v[60:63], v2 offset:48128
	v_mfma_f32_16x16x32_bf16 v[116:119], v[32:35], a[68:71], v[116:119]
	v_mfma_f32_16x16x32_bf16 v[120:123], v[36:39], a[64:67], v[120:123]
	s_waitcnt vmcnt(15)
	s_barrier
	ds_read_b128 v[32:35], v2 offset:49152
	v_mfma_f32_16x16x32_bf16 v[124:127], v[36:39], a[68:71], v[124:127]
	s_add_u32 m0, s51, 49152
	s_add_u32 s85, s53, 49152
	v_mfma_f32_16x16x32_bf16 v[112:115], v[40:43], a[72:75], v[112:115]
	ds_read_b128 v[36:39], v2 offset:50176
	s_waitcnt lgkmcnt(3)
	v_mfma_f32_16x16x32_bf16 v[116:119], v[40:43], a[76:79], v[116:119]
	buffer_load_dwordx4 v1, s[4:7], s85 offen offset:0 sc1 lds
	v_mfma_f32_16x16x32_bf16 v[120:123], v[44:47], a[72:75], v[120:123]
	ds_read_b128 v[40:43], v2 offset:51200
	v_mfma_f32_16x16x32_bf16 v[124:127], v[44:47], a[76:79], v[124:127]
	v_mfma_f32_16x16x32_bf16 v[112:115], v[48:51], a[80:83], v[112:115]
	ds_read_b128 v[44:47], v2 offset:52224
	v_mfma_f32_16x16x32_bf16 v[116:119], v[48:51], a[84:87], v[116:119]
	s_add_u32 s71, s67, 8192
	s_lshl_b32 s72, s45, 2
	s_add_u32 s72, s72, s71
	s_waitcnt vmcnt(5)
	s_barrier
	s_cmp_lg_u32 s44, 0
	s_cbranch_scc1 Lw0_9
	v_lshlrev_b32 v250, 5, v247
	s_mov_b64 exec, 0xff
	buffer_atomic_swap v244, v250, s[4:7], s72 offen sc1
	s_mov_b64 exec, -1
Lw0_9:
	s_lshl_b32 s72, s84, 7
	s_add_u32 s71, s71, s72
	v_mfma_f32_16x16x32_bf16 v[120:123], v[52:55], a[80:83], v[120:123]
	ds_read_b128 v[48:51], v2 offset:53248
	v_mfma_f32_16x16x32_bf16 v[124:127], v[52:55], a[84:87], v[124:127]
	buffer_load_dwordx4 v1, s[4:7], s85 offen offset:1024 sc1 lds
	v_mfma_f32_16x16x32_bf16 v[112:115], v[56:59], a[88:91], v[112:115]
	ds_read_b128 v[52:55], v2 offset:54272
	v_mfma_f32_16x16x32_bf16 v[116:119], v[56:59], a[92:95], v[116:119]
	s_waitcnt lgkmcnt(3)
	v_mfma_f32_16x16x32_bf16 v[120:123], v[60:63], a[88:91], v[120:123]
	ds_read_b128 v[56:59], v2 offset:55296
	v_mfma_f32_16x16x32_bf16 v[124:127], v[60:63], a[92:95], v[124:127]
	buffer_load_dwordx4 v1, s[4:7], s85 offen offset:2048 sc1 lds
	v_mfma_f32_16x16x32_bf16 v[112:115], v[32:35], a[96:99], v[112:115]
	ds_read_b128 v[60:63], v2 offset:56320
	v_mfma_f32_16x16x32_bf16 v[116:119], v[32:35], a[100:103], v[116:119]
	v_mfma_f32_16x16x32_bf16 v[120:123], v[36:39], a[96:99], v[120:123]
	ds_read_b128 v[32:35], v2 offset:57344
	v_mfma_f32_16x16x32_bf16 v[124:127], v[36:39], a[100:103], v[124:127]
	buffer_load_dwordx4 v1, s[4:7], s85 offen offset:3072 sc1 lds
	v_mfma_f32_16x16x32_bf16 v[112:115], v[40:43], a[104:107], v[112:115]
	ds_read_b128 v[36:39], v2 offset:58368
	v_mfma_f32_16x16x32_bf16 v[116:119], v[40:43], a[108:111], v[116:119]
	s_waitcnt lgkmcnt(3)
	v_mfma_f32_16x16x32_bf16 v[120:123], v[44:47], a[104:107], v[120:123]
	ds_read_b128 v[40:43], v2 offset:59392
	v_mfma_f32_16x16x32_bf16 v[124:127], v[44:47], a[108:111], v[124:127]
	s_add_u32 m0, s51, 65536
	s_add_u32 s85, s53, 65536
	v_mfma_f32_16x16x32_bf16 v[112:115], v[48:51], a[112:115], v[112:115]
	ds_read_b128 v[44:47], v2 offset:60416
	v_mfma_f32_16x16x32_bf16 v[116:119], v[48:51], a[116:119], v[116:119]
	buffer_load_dwordx4 v1, s[4:7], s85 offen offset:0 sc1 lds
	v_mfma_f32_16x16x32_bf16 v[120:123], v[52:55], a[112:115], v[120:123]
	ds_read_b128 v[48:51], v2 offset:61440
	v_mfma_f32_16x16x32_bf16 v[124:127], v[52:55], a[116:119], v[124:127]
	v_mfma_f32_16x16x32_bf16 v[112:115], v[56:59], a[120:123], v[112:115]
	ds_read_b128 v[52:55], v2 offset:62464
	s_waitcnt lgkmcnt(3)
	v_mfma_f32_16x16x32_bf16 v[116:119], v[56:59], a[124:127], v[116:119]
	buffer_load_dwordx4 v1, s[4:7], s85 offen offset:1024 sc1 lds
	v_mfma_f32_16x16x32_bf16 v[120:123], v[60:63], a[120:123], v[120:123]
	ds_read_b128 v[56:59], v2 offset:63488
	v_mfma_f32_16x16x32_bf16 v[124:127], v[60:63], a[124:127], v[124:127]
	v_mfma_f32_16x16x32_bf16 v[112:115], v[32:35], a[128:131], v[112:115]
	ds_read_b128 v[60:63], v2 offset:64512
	v_mfma_f32_16x16x32_bf16 v[116:119], v[32:35], a[132:135], v[116:119]
	buffer_load_dwordx4 v1, s[4:7], s85 offen offset:2048 sc1 lds
	v_mfma_f32_16x16x32_bf16 v[120:123], v[36:39], a[128:131], v[120:123]
	v_mfma_f32_16x16x32_bf16 v[124:127], v[36:39], a[132:135], v[124:127]
	v_mfma_f32_16x16x32_bf16 v[112:115], v[40:43], a[136:139], v[112:115]
	s_waitcnt lgkmcnt(1)
	v_mfma_f32_16x16x32_bf16 v[116:119], v[40:43], a[140:143], v[116:119]
	buffer_load_dwordx4 v1, s[4:7], s85 offen offset:3072 sc1 lds
	v_mfma_f32_16x16x32_bf16 v[120:123], v[44:47], a[136:139], v[120:123]
	v_mfma_f32_16x16x32_bf16 v[124:127], v[44:47], a[140:143], v[124:127]
	v_mfma_f32_16x16x32_bf16 v[112:115], v[48:51], a[144:147], v[112:115]
	v_mfma_f32_16x16x32_bf16 v[116:119], v[48:51], a[148:151], v[116:119]
	buffer_load_dword v250, v247, s[4:7], s71 offen sc1
	v_mfma_f32_16x16x32_bf16 v[120:123], v[52:55], a[144:147], v[120:123]
	v_mfma_f32_16x16x32_bf16 v[124:127], v[52:55], a[148:151], v[124:127]
	s_add_u32 m0, s51, 81920
	s_add_u32 s85, s54, 0
	v_mfma_f32_16x16x32_bf16 v[112:115], v[56:59], a[152:155], v[112:115]
	s_waitcnt lgkmcnt(0)
	v_mfma_f32_16x16x32_bf16 v[116:119], v[56:59], a[156:159], v[116:119]
	buffer_load_dwordx4 v1, s[4:7], s85 offen offset:0 sc1 lds
	v_mfma_f32_16x16x32_bf16 v[120:123], v[60:63], a[152:155], v[120:123]
	v_mfma_f32_16x16x32_bf16 v[124:127], v[60:63], a[156:159], v[124:127]
	v_mfma_f32_16x16x32_bf16 v[112:115], a[188:191], v[184:187], v[112:115]
	buffer_load_dwordx4 v1, s[4:7], s85 offen offset:1024 sc1 lds
	v_mfma_f32_16x16x32_bf16 v[116:119], a[188:191], v[188:191], v[116:119]
	buffer_load_dwordx4 v1, s[4:7], s85 offen offset:2048 sc1 lds
	v_mfma_f32_16x16x32_bf16 v[120:123], a[190:193], v[184:187], v[120:123]
	buffer_load_dwordx4 v1, s[4:7], s85 offen offset:3072 sc1 lds
	v_mfma_f32_16x16x32_bf16 v[124:127], a[190:193], v[188:191], v[124:127]
	s_cmp_eq_u32 s44, 3
	s_cselect_b32 s73, 1073741824, 0
	v_add_u32 v212, s73, v239
	s_waitcnt vmcnt(4)
	v_cmp_ne_u32 vcc, s70, v250
	s_nop 0
	s_and_b32 s72, vcc_lo, 0xffff
	s_cbranch_scc0 Lslow_10
	s_mov_b64 exec, 0xffff
Lpoll_11:
	buffer_load_dword v250, v247, s[4:7], s71 offen sc1
	s_sub_u32 s69, s69, 1
	s_cselect_b32 s69, 0, s69
	s_cbranch_scc1 Lpolle_12
	s_waitcnt vmcnt(0)
	v_cmp_ne_u32 vcc, s70, v250
	s_cbranch_vccnz Lpoll_11
Lpolle_12:
	s_waitcnt vmcnt(0)
	s_mov_b64 exec, -1
Lslow_10:
	s_mov_b32 s86, s65
	buffer_load_dwordx4 a[0:3], v239, s[4:7], s86 offen offset:0 sc1
	buffer_load_dwordx4 a[4:7], v239, s[4:7], s86 offen offset:256 sc1
	buffer_load_dwordx4 a[8:11], v239, s[4:7], s86 offen offset:512 sc1
	buffer_load_dwordx4 a[12:15], v212, s[4:7], s86 offen offset:768 sc1
	s_add_u32 s86, s86, 16384
	buffer_load_dwordx4 a[16:19], v239, s[4:7], s86 offen offset:0 sc1
	buffer_load_dwordx4 a[20:23], v239, s[4:7], s86 offen offset:256 sc1
	buffer_load_dwordx4 a[24:27], v239, s[4:7], s86 offen offset:512 sc1
	buffer_load_dwordx4 a[28:31], v212, s[4:7], s86 offen offset:768 sc1
	s_add_u32 s86, s86, 16384
	buffer_load_dwordx4 a[32:35], v239, s[4:7], s86 offen offset:0 sc1
	v_permlane16_swap_b32 v112, v116
	v_permlane16_swap_b32 v113, v117
	v_permlane16_swap_b32 v114, v118
	v_permlane16_swap_b32 v115, v119
	v_permlane16_swap_b32 v120, v124
	v_permlane16_swap_b32 v121, v125
	v_permlane16_swap_b32 v122, v126
	v_permlane16_swap_b32 v123, v127
	v_max3_f32 v168, v112, v113, v114
	v_min3_f32 v169, v112, v113, v114
	v_max3_f32 v170, v115, v116, v117
	v_min3_f32 v171, v115, v116, v117
	v_max3_f32 v168, v168, v118, v119
	v_min3_f32 v169, v169, v118, v119
	buffer_load_dwordx4 a[36:39], v239, s[4:7], s86 offen offset:256 sc1
	v_max3_f32 v170, v170, v120, v121
	v_min3_f32 v171, v171, v120, v121
	v_max3_f32 v168, v168, v122, v123
	v_min3_f32 v169, v169, v122, v123
	v_max3_f32 v170, v170, v124, v125
	v_min3_f32 v171, v171, v124, v125
	v_max3_f32 v168, v168, v126, v127
	v_min3_f32 v169, v169, v126, v127
	v_max3_f32 v170, v170, v104, v105
	v_min3_f32 v171, v171, v104, v105
	v_max3_f32 v168, v168, v106, v107
	v_min3_f32 v169, v169, v106, v107
	v_max_f32 v168, v168, v170
	v_min_f32 v169, v169, v171
	buffer_load_dwordx4 a[40:43], v239, s[4:7], s86 offen offset:512 sc1
	v_mul_f32 v226, v168, v225
	v_mul_f32 v227, v169, v224
	v_pk_fma_f32 v[128:129], v[112:113], v[224:225], v[226:227] op_sel_hi:[1,0,0]
	v_pk_fma_f32 v[148:149], v[112:113], v[224:225], v[226:227] op_sel:[0,1,1] op_sel_hi:[1,1,1]
	v_pk_fma_f32 v[130:131], v[114:115], v[224:225], v[226:227] op_sel_hi:[1,0,0]
	v_pk_fma_f32 v[150:151], v[114:115], v[224:225], v[226:227] op_sel:[0,1,1] op_sel_hi:[1,1,1]
	v_pk_fma_f32 v[132:133], v[116:117], v[224:225], v[226:227] op_sel_hi:[1,0,0]
	v_pk_fma_f32 v[152:153], v[116:117], v[224:225], v[226:227] op_sel:[0,1,1] op_sel_hi:[1,1,1]
	v_pk_fma_f32 v[134:135], v[118:119], v[224:225], v[226:227] op_sel_hi:[1,0,0]
	v_pk_fma_f32 v[154:155], v[118:119], v[224:225], v[226:227] op_sel:[0,1,1] op_sel_hi:[1,1,1]
	v_pk_fma_f32 v[136:137], v[120:121], v[224:225], v[226:227] op_sel_hi:[1,0,0]
	v_pk_fma_f32 v[156:157], v[120:121], v[224:225], v[226:227] op_sel:[0,1,1] op_sel_hi:[1,1,1]
	v_pk_fma_f32 v[138:139], v[122:123], v[224:225], v[226:227] op_sel_hi:[1,0,0]
	v_pk_fma_f32 v[158:159], v[122:123], v[224:225], v[226:227] op_sel:[0,1,1] op_sel_hi:[1,1,1]
	buffer_load_dwordx4 a[44:47], v212, s[4:7], s86 offen offset:768 sc1
	v_pk_fma_f32 v[140:141], v[124:125], v[224:225], v[226:227] op_sel_hi:[1,0,0]
	v_pk_fma_f32 v[160:161], v[124:125], v[224:225], v[226:227] op_sel:[0,1,1] op_sel_hi:[1,1,1]
	v_pk_fma_f32 v[142:143], v[126:127], v[224:225], v[226:227] op_sel_hi:[1,0,0]
	v_pk_fma_f32 v[162:163], v[126:127], v[224:225], v[226:227] op_sel:[0,1,1] op_sel_hi:[1,1,1]
	v_pk_fma_f32 v[144:145], v[104:105], v[224:225], v[226:227] op_sel_hi:[1,0,0]
	v_pk_fma_f32 v[164:165], v[104:105], v[224:225], v[226:227] op_sel:[0,1,1] op_sel_hi:[1,1,1]
	v_pk_fma_f32 v[146:147], v[106:107], v[224:225], v[226:227] op_sel_hi:[1,0,0]
	v_pk_fma_f32 v[166:167], v[106:107], v[224:225], v[226:227] op_sel:[0,1,1] op_sel_hi:[1,1,1]
	v_exp_f32 v128, v128
	v_exp_f32 v129, v129
	v_exp_f32 v130, v130
	v_exp_f32 v131, v131
	v_exp_f32 v132, v132
	v_exp_f32 v133, v133
	s_add_u32 s86, s86, 16384
	buffer_load_dwordx4 a[48:51], v239, s[4:7], s86 offen offset:0 sc1
	v_exp_f32 v134, v134
	v_exp_f32 v135, v135
	v_exp_f32 v136, v136
	v_exp_f32 v137, v137
	v_exp_f32 v138, v138
	v_exp_f32 v139, v139
	v_exp_f32 v140, v140
	v_exp_f32 v141, v141
	v_exp_f32 v142, v142
	v_exp_f32 v143, v143
	v_exp_f32 v144, v144
	v_exp_f32 v145, v145
	v_exp_f32 v146, v146
	v_exp_f32 v147, v147
	buffer_load_dwordx4 a[52:55], v239, s[4:7], s86 offen offset:256 sc1
	v_exp_f32 v148, v148
	v_exp_f32 v149, v149
	v_exp_f32 v150, v150
	v_exp_f32 v151, v151
	v_exp_f32 v152, v152
	v_exp_f32 v153, v153
	v_exp_f32 v154, v154
	v_exp_f32 v155, v155
	v_exp_f32 v156, v156
	v_exp_f32 v157, v157
	v_exp_f32 v158, v158
	v_exp_f32 v159, v159
	v_exp_f32 v160, v160
	v_exp_f32 v161, v161
	buffer_load_dwordx4 a[56:59], v239, s[4:7], s86 offen offset:512 sc1
	v_exp_f32 v162, v162
	v_exp_f32 v163, v163
	v_exp_f32 v164, v164
	v_exp_f32 v165, v165
	v_exp_f32 v166, v166
	v_exp_f32 v167, v167
	v_pk_add_f32 v[168:169], v[128:129], v[130:131]
	v_pk_add_f32 v[170:171], v[132:133], v[134:135]
	v_pk_add_f32 v[172:173], v[148:149], v[150:151]
	v_pk_add_f32 v[174:175], v[152:153], v[154:155]
	v_pk_add_f32 v[168:169], v[168:169], v[136:137]
	v_pk_add_f32 v[172:173], v[172:173], v[156:157]
	v_pk_add_f32 v[170:171], v[170:171], v[138:139]
	v_pk_add_f32 v[174:175], v[174:175], v[158:159]
	buffer_load_dwordx4 a[60:63], v212, s[4:7], s86 offen offset:768 sc1
	v_pk_add_f32 v[168:169], v[168:169], v[140:141]
	v_pk_add_f32 v[172:173], v[172:173], v[160:161]
	v_pk_add_f32 v[170:171], v[170:171], v[142:143]
	v_pk_add_f32 v[174:175], v[174:175], v[162:163]
	v_pk_add_f32 v[168:169], v[168:169], v[144:145]
	v_pk_add_f32 v[172:173], v[172:173], v[164:165]
	v_pk_add_f32 v[170:171], v[170:171], v[146:147]
	v_pk_add_f32 v[174:175], v[174:175], v[166:167]
	v_pk_add_f32 v[168:169], v[168:169], v[170:171]
	v_pk_add_f32 v[172:173], v[172:173], v[174:175]
	v_add_f32 v168, v168, v169
	v_add_f32 v172, v172, v173
	v_rcp_f32 v230, v168
	v_rcp_f32 v231, v172
	s_nop 0
	v_pk_mul_f32 v[128:129], v[128:129], v[230:231] op_sel_hi:[1,0]
	v_pk_mul_f32 v[130:131], v[130:131], v[230:231] op_sel_hi:[1,0]
	v_pk_mul_f32 v[132:133], v[132:133], v[230:231] op_sel_hi:[1,0]
	v_pk_mul_f32 v[134:135], v[134:135], v[230:231] op_sel_hi:[1,0]
	v_pk_mul_f32 v[136:137], v[136:137], v[230:231] op_sel_hi:[1,0]
	v_pk_mul_f32 v[138:139], v[138:139], v[230:231] op_sel_hi:[1,0]
	v_pk_mul_f32 v[140:141], v[140:141], v[230:231] op_sel_hi:[1,0]
	v_pk_mul_f32 v[142:143], v[142:143], v[230:231] op_sel_hi:[1,0]
	v_pk_mul_f32 v[144:145], v[144:145], v[230:231] op_sel_hi:[1,0]
	v_pk_mul_f32 v[146:147], v[146:147], v[230:231] op_sel_hi:[1,0]
	v_pk_mul_f32 v[148:149], v[148:149], v[230:231] op_sel:[0,1] op_sel_hi:[1,1]
	v_pk_mul_f32 v[150:151], v[150:151], v[230:231] op_sel:[0,1] op_sel_hi:[1,1]
	v_pk_mul_f32 v[152:153], v[152:153], v[230:231] op_sel:[0,1] op_sel_hi:[1,1]
	v_pk_mul_f32 v[154:155], v[154:155], v[230:231] op_sel:[0,1] op_sel_hi:[1,1]
	v_pk_mul_f32 v[156:157], v[156:157], v[230:231] op_sel:[0,1] op_sel_hi:[1,1]
	v_pk_mul_f32 v[158:159], v[158:159], v[230:231] op_sel:[0,1] op_sel_hi:[1,1]
	v_pk_mul_f32 v[160:161], v[160:161], v[230:231] op_sel:[0,1] op_sel_hi:[1,1]
	v_pk_mul_f32 v[162:163], v[162:163], v[230:231] op_sel:[0,1] op_sel_hi:[1,1]
	v_pk_mul_f32 v[164:165], v[164:165], v[230:231] op_sel:[0,1] op_sel_hi:[1,1]
	v_pk_mul_f32 v[166:167], v[166:167], v[230:231] op_sel:[0,1] op_sel_hi:[1,1]
	v_cvt_pk_bf16_f32 v192, v128, v129
	v_cvt_pk_bf16_f32 v193, v130, v131
	v_cvt_pk_bf16_f32 v194, v132, v133
	v_cvt_pk_bf16_f32 v195, v134, v135
	v_cvt_pk_bf16_f32 v196, v136, v137
	v_cvt_pk_bf16_f32 v197, v138, v139
	v_cvt_pk_bf16_f32 v198, v140, v141
	v_cvt_pk_bf16_f32 v199, v142, v143
	v_cvt_pk_bf16_f32 v208, v144, v145
	v_cvt_pk_bf16_f32 v209, v146, v147
	v_cvt_pk_bf16_f32 v200, v148, v149
	v_cvt_pk_bf16_f32 v201, v150, v151
	v_cvt_pk_bf16_f32 v202, v152, v153
	v_cvt_pk_bf16_f32 v203, v154, v155
	v_cvt_pk_bf16_f32 v204, v156, v157
	v_cvt_pk_bf16_f32 v205, v158, v159
	v_cvt_pk_bf16_f32 v206, v160, v161
	v_cvt_pk_bf16_f32 v207, v162, v163
	v_cvt_pk_bf16_f32 v210, v164, v165
	v_cvt_pk_bf16_f32 v211, v166, v167
	s_barrier
	s_waitcnt vmcnt(15)
	v_mfma_f32_16x16x32_bf16 v[128:131], v[252:255], a[0:3], 0
	s_waitcnt vmcnt(14)
	v_mfma_f32_16x16x32_bf16 v[132:135], v[252:255], a[4:7], 0
	s_waitcnt vmcnt(13)
	v_mfma_f32_16x16x32_bf16 v[136:139], v[252:255], a[8:11], 0
	s_waitcnt vmcnt(12)
	v_mfma_f32_16x16x32_bf16 v[140:143], v[252:255], a[12:15], 0
	s_add_u32 m0, s51, 98304
	s_add_u32 s85, s54, 16384
	buffer_load_dwordx4 v1, s[4:7], s85 offen offset:0 sc1 lds
	s_waitcnt vmcnt(12)
	v_mfma_f32_16x16x32_bf16 v[128:131], v[252:255], a[16:19], v[128:131]
	s_waitcnt vmcnt(11)
	v_mfma_f32_16x16x32_bf16 v[132:135], v[252:255], a[20:23], v[132:135]
	s_waitcnt vmcnt(10)
	v_mfma_f32_16x16x32_bf16 v[136:139], v[252:255], a[24:27], v[136:139]
	s_waitcnt vmcnt(9)
	v_mfma_f32_16x16x32_bf16 v[140:143], v[252:255], a[28:31], v[140:143]
	buffer_load_dwordx4 v1, s[4:7], s85 offen offset:1024 sc1 lds
	s_waitcnt vmcnt(9)
	v_mfma_f32_16x16x32_bf16 v[128:131], v[252:255], a[32:35], v[128:131]
	s_waitcnt vmcnt(8)
	v_mfma_f32_16x16x32_bf16 v[132:135], v[252:255], a[36:39], v[132:135]
	s_waitcnt vmcnt(7)
	v_mfma_f32_16x16x32_bf16 v[136:139], v[252:255], a[40:43], v[136:139]
	s_waitcnt vmcnt(6)
	v_mfma_f32_16x16x32_bf16 v[140:143], v[252:255], a[44:47], v[140:143]
	buffer_load_dwordx4 v1, s[4:7], s85 offen offset:2048 sc1 lds
	s_waitcnt vmcnt(6)
	v_mfma_f32_16x16x32_bf16 v[128:131], v[252:255], a[48:51], v[128:131]
	s_waitcnt vmcnt(5)
	v_mfma_f32_16x16x32_bf16 v[132:135], v[252:255], a[52:55], v[132:135]
	s_waitcnt vmcnt(4)
	v_mfma_f32_16x16x32_bf16 v[136:139], v[252:255], a[56:59], v[136:139]
	s_waitcnt vmcnt(3)
	v_mfma_f32_16x16x32_bf16 v[140:143], v[252:255], a[60:63], v[140:143]
	buffer_load_dwordx4 v1, s[4:7], s85 offen offset:3072 sc1 lds
	s_mov_b64 exec, 0xffffffff
	v_cvt_pk_bf16_f32 v144, v128, v129
	v_cvt_pk_bf16_f32 v145, v130, v131
	ds_write_b64 v240, v[144:145] offset:0
	v_cvt_pk_bf16_f32 v146, v132, v133
	v_cvt_pk_bf16_f32 v147, v134, v135
	ds_write_b64 v240, v[146:147] offset:256
	v_cvt_pk_bf16_f32 v148, v136, v137
	v_cvt_pk_bf16_f32 v149, v138, v139
	ds_write_b64 v240, v[148:149] offset:512
	v_cvt_pk_bf16_f32 v150, v140, v141
	v_cvt_pk_bf16_f32 v151, v142, v143
	ds_write_b64 v240, v[150:151] offset:768
	s_mov_b64 exec, -1
	s_waitcnt lgkmcnt(0)
	s_barrier
	s_mov_b32 exec_lo, 0x0f0f0f0f
	s_mov_b32 exec_hi, 0xf0f0f0f0
	ds_read_b128 a[236:239], v242 offset:0
	ds_read_b128 a[240:243], v242 offset:384
	ds_read_b128 a[244:247], v242 offset:768
	ds_read_b128 a[248:251], v242 offset:1152
	ds_read_b128 a[252:255], v242 offset:1536
	ds_read_b128 a[216:219], v241 offset:0
	ds_read_b128 a[220:223], v241 offset:384
	ds_read_b128 a[224:227], v241 offset:768
	ds_read_b128 a[228:231], v241 offset:1152
	ds_read_b128 a[232:235], v241 offset:1536
	s_mov_b64 exec, -1
	s_waitcnt lgkmcnt(9)
	v_mfma_f32_32x32x16_bf16 v[80:95], a[236:239], v[192:195], 0
	s_add_u32 m0, s51, 114688
	s_add_u32 s85, s54, 32768
	buffer_load_dwordx4 v1, s[4:7], s85 offen offset:0 sc1 lds
	s_waitcnt lgkmcnt(8)
	v_mfma_f32_32x32x16_bf16 v[80:95], a[240:243], v[196:199], v[80:95]
	s_waitcnt lgkmcnt(7)
	v_mfma_f32_32x32x16_bf16 v[80:95], a[244:247], v[200:203], v[80:95]
	buffer_load_dwordx4 v1, s[4:7], s85 offen offset:1024 sc1 lds
	s_waitcnt lgkmcnt(6)
	v_mfma_f32_32x32x16_bf16 v[80:95], a[248:251], v[204:207], v[80:95]
	s_waitcnt lgkmcnt(5)
	v_mfma_f32_32x32x16_bf16 v[80:95], a[252:255], v[208:211], v[80:95]
	s_waitcnt lgkmcnt(4)
	v_mfma_f32_32x32x16_bf16 v[64:79], a[216:219], v[192:195], 0
	buffer_load_dwordx4 v1, s[4:7], s85 offen offset:2048 sc1 lds
	s_waitcnt lgkmcnt(3)
	v_mfma_f32_32x32x16_bf16 v[64:79], a[220:223], v[196:199], v[64:79]
	s_waitcnt lgkmcnt(2)
	v_mfma_f32_32x32x16_bf16 v[64:79], a[224:227], v[200:203], v[64:79]
	buffer_load_dwordx4 v1, s[4:7], s85 offen offset:3072 sc1 lds
	s_waitcnt lgkmcnt(1)
	v_mfma_f32_32x32x16_bf16 v[64:79], a[228:231], v[204:207], v[64:79]
	s_nop 1
	v_add_f32 v230, 0x358637bd, v84
	v_rcp_f32 v230, v230
	s_waitcnt lgkmcnt(0)
	v_mfma_f32_32x32x16_bf16 v[64:79], a[232:235], v[208:211], v[64:79]
	s_barrier
	v_mul_f32 v80, v80, v230
	v_mul_f32 v81, v81, v230
	v_mul_f32 v82, v82, v230
	v_mul_f32 v83, v83, v230
	v_cvt_pk_bf16_f32 v136, v80, v81
	v_cvt_pk_bf16_f32 v137, v82, v83
	s_cmp_ge_u32 s99, s68
	s_cselect_b64 vcc, -1, 0
	s_cbranch_vccz Lst_14
	buffer_store_dwordx2 v[136:137], v243, s[4:7], s60 offen offset:2048 sc1
	s_branch Lst_14e
Lst_14:
	buffer_store_dwordx2 v[136:137], v243, s[4:7], s60 offen offset:2048
Lst_14e:
	s_nop 0
	v_pk_mul_f32 v[64:65], v[64:65], v[230:231] op_sel_hi:[1,0]
	v_pk_mul_f32 v[66:67], v[66:67], v[230:231] op_sel_hi:[1,0]
	v_pk_mul_f32 v[68:69], v[68:69], v[230:231] op_sel_hi:[1,0]
	v_pk_mul_f32 v[70:71], v[70:71], v[230:231] op_sel_hi:[1,0]
	v_cvt_pk_bf16_f32 v128, v64, v65
	v_cvt_pk_bf16_f32 v129, v66, v67
	v_cvt_pk_bf16_f32 v130, v68, v69
	v_cvt_pk_bf16_f32 v131, v70, v71
	s_cbranch_vccz Lst_15
	buffer_store_dwordx4 v[128:131], v1, s[4:7], s60 offen offset:0 sc1
	s_branch Lst_15e
Lst_15:
	buffer_store_dwordx4 v[128:131], v1, s[4:7], s60 offen offset:0
Lst_15e:
	v_pk_mul_f32 v[72:73], v[72:73], v[230:231] op_sel_hi:[1,0]
	v_pk_mul_f32 v[74:75], v[74:75], v[230:231] op_sel_hi:[1,0]
	v_pk_mul_f32 v[76:77], v[76:77], v[230:231] op_sel_hi:[1,0]
	v_pk_mul_f32 v[78:79], v[78:79], v[230:231] op_sel_hi:[1,0]
	v_cvt_pk_bf16_f32 v132, v72, v73
	v_cvt_pk_bf16_f32 v133, v74, v75
	v_cvt_pk_bf16_f32 v134, v76, v77
	v_cvt_pk_bf16_f32 v135, v78, v79
	s_cbranch_vccz Lst_16
	buffer_store_dwordx4 v[132:135], v1, s[4:7], s60 offen offset:1024 sc1
	s_branch Lst_16e
Lst_16:
	buffer_store_dwordx4 v[132:135], v1, s[4:7], s60 offen offset:1024
Lst_16e:
	s_add_u32 m0, s51, 131072
	s_add_u32 s85, s53, 81920
	buffer_load_dwordx4 v1, s[4:7], s85 offen offset:0 sc1 lds
	buffer_load_dwordx4 v1, s[4:7], s85 offen offset:1024 sc1 lds
	buffer_load_dwordx4 v1, s[4:7], s85 offen offset:2048 sc1 lds
	buffer_load_dwordx4 v1, s[4:7], s85 offen offset:3072 sc1 lds
	s_add_u32 m0, s87, 147456
	s_sub_u32 s85, s53, s51
	s_add_u32 s85, s85, s87
	s_add_u32 s85, s85, 98304
	buffer_load_dwordx4 v1, s[4:7], s85 offen sc1 lds
	s_add_u32 s71, s66, 2048
	s_lshl_b32 s72, s46, 2
	s_add_u32 s72, s72, s71
	s_waitcnt vmcnt(5)
	s_barrier
	s_cmp_lg_u32 s44, 0
	s_cbranch_scc1 Lsa_17
	s_mov_b64 exec, 1
	s_cmp_eq_u32 s99, 0
	s_cbranch_scc1 Lfl_19
	buffer_atomic_swap v244, off, s[4:7], s72 sc1
	s_branch Lfl_19e
Lfl_19:
	buffer_store_dword v244, off, s[4:7], s72
Lfl_19e:
	s_mov_b64 exec, -1
	s_mov_b64 exec, 0xffff
Lpoll_20:
	buffer_load_dword v250, v247, s[4:7], s71 offen sc1
	s_sub_u32 s69, s69, 1
	s_cselect_b32 s69, 0, s69
	s_cbranch_scc1 Lpolle_21
	s_waitcnt vmcnt(0)
	v_cmp_ne_u32 vcc, s70, v250
	s_cbranch_vccnz Lpoll_20
Lpolle_21:
	s_waitcnt vmcnt(0)
	s_mov_b64 exec, -1
Lsa_17:
	s_barrier
	s_mov_b32 s86, s61
	buffer_load_dwordx4 a[0:3], v5, s[4:7], s86 offen offset:0 sc1
	buffer_load_dwordx4 a[4:7], v5, s[4:7], s86 offen offset:2048 sc1
	s_add_u32 s86, s86, 4096
	buffer_load_dwordx4 a[8:11], v5, s[4:7], s86 offen offset:0 sc1
	buffer_load_dwordx4 a[12:15], v5, s[4:7], s86 offen offset:2048 sc1
	s_add_u32 s86, s86, 4096
	buffer_load_dwordx4 a[16:19], v5, s[4:7], s86 offen offset:0 sc1
	buffer_load_dwordx4 a[20:23], v5, s[4:7], s86 offen offset:2048 sc1
	s_add_u32 s86, s86, 4096
	buffer_load_dwordx4 a[24:27], v5, s[4:7], s86 offen offset:0 sc1
	buffer_load_dwordx4 a[28:31], v5, s[4:7], s86 offen offset:2048 sc1
	s_add_u32 s86, s86, 4096
	buffer_load_dwordx4 a[32:35], v5, s[4:7], s86 offen offset:0 sc1
	buffer_load_dwordx4 a[36:39], v5, s[4:7], s86 offen offset:2048 sc1
	ds_read_b128 v[96:99], v1 offset:0
	ds_read_b128 v[100:103], v1 offset:1024
	ds_read_b128 v[104:107], v1 offset:2048
	ds_read_b128 v[108:111], v1 offset:3072
	ds_read_b128 v[112:115], v1 offset:4096
	ds_read_b128 v[116:119], v1 offset:5120
	ds_read_b128 v[120:123], v1 offset:6144
	ds_read_b128 v[124:127], v1 offset:7168
	ds_read_b128 v[128:131], v1 offset:8192
	ds_read_b128 v[132:135], v1 offset:9216
	ds_read_b128 v[136:139], v1 offset:10240
	s_waitcnt vmcnt(9) lgkmcnt(7)
	v_mfma_f32_16x16x32_bf16 v[64:67], v[96:99], a[0:3], 0
	ds_read_b128 v[140:143], v1 offset:11264
	v_mfma_f32_16x16x32_bf16 v[68:71], v[100:103], a[0:3], 0
	s_add_u32 s86, s86, 4096
	buffer_load_dwordx4 a[40:43], v5, s[4:7], s86 offen offset:0 sc1
	v_mfma_f32_16x16x32_bf16 v[72:75], v[104:107], a[0:3], 0
	ds_read_b128 v[96:99], v1 offset:12288
	ds_read_b128 v[100:103], v1 offset:13312
	v_mfma_f32_16x16x32_bf16 v[76:79], v[108:111], a[0:3], 0
	ds_read_b128 v[104:107], v1 offset:14336
	s_waitcnt lgkmcnt(7)
	v_mfma_f32_16x16x32_bf16 v[80:83], v[112:115], a[0:3], 0
	ds_read_b128 v[108:111], v1 offset:15360
	s_waitcnt vmcnt(9)
	v_mfma_f32_16x16x32_bf16 v[64:67], v[116:119], a[4:7], v[64:67]
	ds_read_b128 v[112:115], v1 offset:16384
	v_mfma_f32_16x16x32_bf16 v[68:71], v[120:123], a[4:7], v[68:71]
	buffer_load_dwordx4 a[44:47], v5, s[4:7], s86 offen offset:2048 sc1
	v_mfma_f32_16x16x32_bf16 v[72:75], v[124:127], a[4:7], v[72:75]
	ds_read_b128 v[116:119], v1 offset:17408
	s_waitcnt lgkmcnt(6)
	v_mfma_f32_16x16x32_bf16 v[76:79], v[128:131], a[4:7], v[76:79]
	ds_read_b128 v[120:123], v1 offset:18432
	ds_read_b128 v[124:127], v1 offset:19456
	v_mfma_f32_16x16x32_bf16 v[80:83], v[132:135], a[4:7], v[80:83]
	ds_read_b128 v[128:131], v1 offset:20480
	s_waitcnt vmcnt(9)
	v_mfma_f32_16x16x32_bf16 v[64:67], v[136:139], a[8:11], v[64:67]
	ds_read_b128 v[132:135], v1 offset:21504
	v_mfma_f32_16x16x32_bf16 v[68:71], v[140:143], a[8:11], v[68:71]
	s_add_u32 s86, s86, 4096
	buffer_load_dwordx4 a[48:51], v5, s[4:7], s86 offen offset:0 sc1
	s_waitcnt lgkmcnt(6)
	v_mfma_f32_16x16x32_bf16 v[72:75], v[96:99], a[8:11], v[72:75]
	ds_read_b128 v[136:139], v1 offset:22528
	ds_read_b128 v[140:143], v1 offset:23552
	v_mfma_f32_16x16x32_bf16 v[76:79], v[100:103], a[8:11], v[76:79]
	ds_read_b128 v[96:99], v1 offset:24576
	v_mfma_f32_16x16x32_bf16 v[80:83], v[104:107], a[8:11], v[80:83]
	ds_read_b128 v[100:103], v1 offset:25600
	s_waitcnt vmcnt(9)
	v_mfma_f32_16x16x32_bf16 v[64:67], v[108:111], a[12:15], v[64:67]
	ds_read_b128 v[104:107], v1 offset:26624
	s_waitcnt lgkmcnt(7)
	v_mfma_f32_16x16x32_bf16 v[68:71], v[112:115], a[12:15], v[68:71]
	buffer_load_dwordx4 a[52:55], v5, s[4:7], s86 offen offset:2048 sc1
	v_mfma_f32_16x16x32_bf16 v[72:75], v[116:119], a[12:15], v[72:75]
	ds_read_b128 v[108:111], v1 offset:27648
	ds_read_b128 v[112:115], v1 offset:28672
	v_mfma_f32_16x16x32_bf16 v[76:79], v[120:123], a[12:15], v[76:79]
	ds_read_b128 v[116:119], v1 offset:29696
	v_mfma_f32_16x16x32_bf16 v[80:83], v[124:127], a[12:15], v[80:83]
	ds_read_b128 v[120:123], v1 offset:30720
	s_waitcnt vmcnt(9) lgkmcnt(7)
	v_mfma_f32_16x16x32_bf16 v[64:67], v[128:131], a[16:19], v[64:67]
	ds_read_b128 v[124:127], v1 offset:31744
	v_mfma_f32_16x16x32_bf16 v[68:71], v[132:135], a[16:19], v[68:71]
	s_add_u32 s86, s86, 4096
	buffer_load_dwordx4 a[56:59], v5, s[4:7], s86 offen offset:0 sc1
	v_mfma_f32_16x16x32_bf16 v[72:75], v[136:139], a[16:19], v[72:75]
	ds_read_b128 v[128:131], v1 offset:32768
	ds_read_b128 v[132:135], v1 offset:33792
	v_mfma_f32_16x16x32_bf16 v[76:79], v[140:143], a[16:19], v[76:79]
	ds_read_b128 v[136:139], v1 offset:34816
	s_waitcnt lgkmcnt(7)
	v_mfma_f32_16x16x32_bf16 v[80:83], v[96:99], a[16:19], v[80:83]
	ds_read_b128 v[140:143], v1 offset:35840
	s_waitcnt vmcnt(9)
	v_mfma_f32_16x16x32_bf16 v[64:67], v[100:103], a[20:23], v[64:67]
	ds_read_b128 v[96:99], v1 offset:36864
	v_mfma_f32_16x16x32_bf16 v[68:71], v[104:107], a[20:23], v[68:71]
	buffer_load_dwordx4 a[60:63], v5, s[4:7], s86 offen offset:2048 sc1
	v_mfma_f32_16x16x32_bf16 v[72:75], v[108:111], a[20:23], v[72:75]
	s_barrier
	s_add_u32 m0, s51, 0
	s_add_u32 s85, s54, 49152
	s_waitcnt lgkmcnt(5)
	v_mfma_f32_16x16x32_bf16 v[76:79], v[112:115], a[20:23], v[76:79]
	ds_read_b128 v[100:103], v1 offset:37888
	buffer_load_dwordx4 v1, s[4:7], s85 offen offset:0 sc1 lds
	v_mfma_f32_16x16x32_bf16 v[80:83], v[116:119], a[20:23], v[80:83]
	ds_read_b128 v[104:107], v1 offset:38912
	s_waitcnt vmcnt(10)
	v_mfma_f32_16x16x32_bf16 v[64:67], v[120:123], a[24:27], v[64:67]
	ds_read_b128 v[108:111], v1 offset:39936
	ds_read_b128 v[112:115], v1 offset:40960
	v_mfma_f32_16x16x32_bf16 v[68:71], v[124:127], a[24:27], v[68:71]
	s_add_u32 s86, s86, 4096
	buffer_load_dwordx4 a[64:67], v5, s[4:7], s86 offen offset:0 sc1
	s_waitcnt lgkmcnt(5)
	v_mfma_f32_16x16x32_bf16 v[72:75], v[128:131], a[24:27], v[72:75]
	ds_read_b128 v[116:119], v1 offset:41984
	ds_read_b128 v[120:123], v1 offset:43008
	v_mfma_f32_16x16x32_bf16 v[76:79], v[132:135], a[24:27], v[76:79]
	buffer_load_dwordx4 v1, s[4:7], s85 offen offset:1024 sc1 lds
	v_mfma_f32_16x16x32_bf16 v[80:83], v[136:139], a[24:27], v[80:83]
	ds_read_b128 v[124:127], v1 offset:44032
	s_waitcnt vmcnt(11)
	v_mfma_f32_16x16x32_bf16 v[64:67], v[140:143], a[28:31], v[64:67]
	ds_read_b128 v[128:131], v1 offset:45056
	s_waitcnt lgkmcnt(5)
	v_mfma_f32_16x16x32_bf16 v[68:71], v[96:99], a[28:31], v[68:71]
	ds_read_b128 v[132:135], v1 offset:46080
	buffer_load_dwordx4 a[68:71], v5, s[4:7], s86 offen offset:2048 sc1
	v_mfma_f32_16x16x32_bf16 v[72:75], v[100:103], a[28:31], v[72:75]
	ds_read_b128 v[136:139], v1 offset:47104
	ds_read_b128 v[140:143], v1 offset:48128
	v_mfma_f32_16x16x32_bf16 v[76:79], v[104:107], a[28:31], v[76:79]
	buffer_load_dwordx4 v1, s[4:7], s85 offen offset:2048 sc1 lds
	v_mfma_f32_16x16x32_bf16 v[80:83], v[108:111], a[28:31], v[80:83]
	ds_read_b128 v[96:99], v1 offset:49152
	s_waitcnt vmcnt(12) lgkmcnt(5)
	v_mfma_f32_16x16x32_bf16 v[64:67], v[112:115], a[32:35], v[64:67]
	ds_read_b128 v[100:103], v1 offset:50176
	ds_read_b128 v[104:107], v1 offset:51200
	v_mfma_f32_16x16x32_bf16 v[68:71], v[116:119], a[32:35], v[68:71]
	s_add_u32 s86, s86, 4096
	buffer_load_dwordx4 a[72:75], v5, s[4:7], s86 offen offset:0 sc1
	v_mfma_f32_16x16x32_bf16 v[72:75], v[120:123], a[32:35], v[72:75]
	ds_read_b128 v[108:111], v1 offset:52224
	ds_read_b128 v[112:115], v1 offset:53248
	v_mfma_f32_16x16x32_bf16 v[76:79], v[124:127], a[32:35], v[76:79]
	buffer_load_dwordx4 v1, s[4:7], s85 offen offset:3072 sc1 lds
	s_waitcnt lgkmcnt(5)
	v_mfma_f32_16x16x32_bf16 v[80:83], v[128:131], a[32:35], v[80:83]
	ds_read_b128 v[116:119], v1 offset:54272
	s_waitcnt vmcnt(13)
	v_mfma_f32_16x16x32_bf16 v[64:67], v[132:135], a[36:39], v[64:67]
	ds_read_b128 v[120:123], v1 offset:55296
	ds_read_b128 v[124:127], v1 offset:56320
	v_mfma_f32_16x16x32_bf16 v[68:71], v[136:139], a[36:39], v[68:71]
	buffer_load_dwordx4 a[76:79], v5, s[4:7], s86 offen offset:2048 sc1
	v_mfma_f32_16x16x32_bf16 v[72:75], v[140:143], a[36:39], v[72:75]
	ds_read_b128 v[128:131], v1 offset:57344
	s_waitcnt lgkmcnt(5)
	v_mfma_f32_16x16x32_bf16 v[76:79], v[96:99], a[36:39], v[76:79]
	s_barrier
	ds_read_b128 v[132:135], v1 offset:58368
	s_add_u32 m0, s51, 16384
	s_add_u32 s85, s54, 65536
	v_mfma_f32_16x16x32_bf16 v[80:83], v[100:103], a[36:39], v[80:83]
	ds_read_b128 v[136:139], v1 offset:59392
	buffer_load_dwordx4 v1, s[4:7], s85 offen offset:0 sc1 lds
	s_waitcnt vmcnt(14)
	v_mfma_f32_16x16x32_bf16 v[64:67], v[104:107], a[40:43], v[64:67]
	ds_read_b128 v[140:143], v1 offset:60416
	ds_read_b128 v[96:99], v1 offset:61440
	v_mfma_f32_16x16x32_bf16 v[68:71], v[108:111], a[40:43], v[68:71]
	ds_read_b128 v[100:103], v1 offset:62464
	s_waitcnt lgkmcnt(6)
	v_mfma_f32_16x16x32_bf16 v[72:75], v[112:115], a[40:43], v[72:75]
	ds_read_b128 v[104:107], v1 offset:63488
	ds_read_b128 v[108:111], v1 offset:64512
	v_mfma_f32_16x16x32_bf16 v[76:79], v[116:119], a[40:43], v[76:79]
	buffer_load_dwordx4 v1, s[4:7], s85 offen offset:1024 sc1 lds
	v_mfma_f32_16x16x32_bf16 v[80:83], v[120:123], a[40:43], v[80:83]
	ds_read_b128 v[112:115], v2 offset:0
	s_waitcnt vmcnt(14)
	v_mfma_f32_16x16x32_bf16 v[64:67], v[124:127], a[44:47], v[64:67]
	ds_read_b128 v[116:119], v2 offset:1024
	s_waitcnt lgkmcnt(6)
	v_mfma_f32_16x16x32_bf16 v[68:71], v[128:131], a[44:47], v[68:71]
	ds_read_b128 v[120:123], v2 offset:2048
	ds_read_b128 v[124:127], v2 offset:3072
	v_mfma_f32_16x16x32_bf16 v[72:75], v[132:135], a[44:47], v[72:75]
	buffer_load_dwordx4 v1, s[4:7], s85 offen offset:2048 sc1 lds
	v_mfma_f32_16x16x32_bf16 v[76:79], v[136:139], a[44:47], v[76:79]
	ds_read_b128 v[128:131], v2 offset:4096
	ds_read_b128 v[132:135], v2 offset:5120
	v_mfma_f32_16x16x32_bf16 v[80:83], v[140:143], a[44:47], v[80:83]
	ds_read_b128 v[136:139], v2 offset:6144
	s_waitcnt vmcnt(14) lgkmcnt(7)
	v_mfma_f32_16x16x32_bf16 v[64:67], v[96:99], a[48:51], v[64:67]
	ds_read_b128 v[140:143], v2 offset:7168
	v_mfma_f32_16x16x32_bf16 v[68:71], v[100:103], a[48:51], v[68:71]
	buffer_load_dwordx4 v1, s[4:7], s85 offen offset:3072 sc1 lds
	v_mfma_f32_16x16x32_bf16 v[72:75], v[104:107], a[48:51], v[72:75]
	ds_read_b128 v[96:99], v2 offset:8192
	ds_read_b128 v[100:103], v2 offset:9216
	v_mfma_f32_16x16x32_bf16 v[76:79], v[108:111], a[48:51], v[76:79]
	ds_read_b128 v[104:107], v2 offset:10240
	s_waitcnt lgkmcnt(7)
	v_mfma_f32_16x16x32_bf16 v[80:83], v[112:115], a[48:51], v[80:83]
	ds_read_b128 v[108:111], v2 offset:11264
	s_waitcnt vmcnt(14)
	v_mfma_f32_16x16x32_bf16 v[64:67], v[116:119], a[52:55], v[64:67]
	s_add_u32 m0, s51, 32768
	s_add_u32 s85, s54, 81920
	v_mfma_f32_16x16x32_bf16 v[68:71], v[120:123], a[52:55], v[68:71]
	buffer_load_dwordx4 v1, s[4:7], s85 offen offset:0 sc1 lds
	v_mfma_f32_16x16x32_bf16 v[72:75], v[124:127], a[52:55], v[72:75]
	ds_read_b128 v[112:115], v2 offset:12288
	s_waitcnt lgkmcnt(5)
	v_mfma_f32_16x16x32_bf16 v[76:79], v[128:131], a[52:55], v[76:79]
	ds_read_b128 v[116:119], v2 offset:13312
	ds_read_b128 v[120:123], v2 offset:14336
	v_mfma_f32_16x16x32_bf16 v[80:83], v[132:135], a[52:55], v[80:83]
	ds_read_b128 v[124:127], v2 offset:15360
	s_waitcnt vmcnt(14)
	v_mfma_f32_16x16x32_bf16 v[64:67], v[136:139], a[56:59], v[64:67]
	buffer_load_dwordx4 v1, s[4:7], s85 offen offset:1024 sc1 lds
	v_mfma_f32_16x16x32_bf16 v[68:71], v[140:143], a[56:59], v[68:71]
	ds_read_b128 v[128:131], v245 offset:0
	s_waitcnt lgkmcnt(5)
	v_mfma_f32_16x16x32_bf16 v[72:75], v[96:99], a[56:59], v[72:75]
	ds_read_b128 v[132:135], v245 offset:1024
	ds_read_b128 v[136:139], v245 offset:2048
	v_mfma_f32_16x16x32_bf16 v[76:79], v[100:103], a[56:59], v[76:79]
	ds_read_b128 v[140:143], v245 offset:3072
	ds_read_b128 v[96:99], v245 offset:4096
	v_mfma_f32_16x16x32_bf16 v[80:83], v[104:107], a[56:59], v[80:83]
	buffer_load_dwordx4 v1, s[4:7], s85 offen offset:2048 sc1 lds
	s_waitcnt vmcnt(15)
	v_mfma_f32_16x16x32_bf16 v[64:67], v[108:111], a[60:63], v[64:67]
	ds_read_b128 v[100:103], v245 offset:5120
	s_waitcnt lgkmcnt(6)
	v_mfma_f32_16x16x32_bf16 v[68:71], v[112:115], a[60:63], v[68:71]
	ds_read_b128 v[104:107], v245 offset:6144
	ds_read_b128 v[108:111], v245 offset:7168
	v_mfma_f32_16x16x32_bf16 v[72:75], v[116:119], a[60:63], v[72:75]
	ds_read_b128 v[112:115], v245 offset:8192
	v_mfma_f32_16x16x32_bf16 v[76:79], v[120:123], a[60:63], v[76:79]
	buffer_load_dwordx4 v1, s[4:7], s85 offen offset:3072 sc1 lds
	v_mfma_f32_16x16x32_bf16 v[80:83], v[124:127], a[60:63], v[80:83]
	ds_read_b128 v[116:119], v245 offset:9216
	s_waitcnt vmcnt(14) lgkmcnt(6)
	v_mfma_f32_16x16x32_bf16 v[64:67], v[128:131], a[64:67], v[64:67]
	ds_read_b128 v[120:123], v245 offset:10240
	ds_read_b128 v[124:127], v245 offset:11264
	v_mfma_f32_16x16x32_bf16 v[68:71], v[132:135], a[64:67], v[68:71]
	ds_read_b128 v[128:131], v245 offset:12288
	v_mfma_f32_16x16x32_bf16 v[72:75], v[136:139], a[64:67], v[72:75]
	ds_read_b128 v[132:135], v245 offset:13312
	v_mfma_f32_16x16x32_bf16 v[76:79], v[140:143], a[64:67], v[76:79]
	ds_read_b128 v[136:139], v245 offset:14336
	s_waitcnt lgkmcnt(7)
	v_mfma_f32_16x16x32_bf16 v[80:83], v[96:99], a[64:67], v[80:83]
	ds_read_b128 v[140:143], v245 offset:15360
	s_waitcnt vmcnt(12)
	v_mfma_f32_16x16x32_bf16 v[64:67], v[100:103], a[68:71], v[64:67]
	ds_read_b128 v[96:99], v245 offset:16384
	v_mfma_f32_16x16x32_bf16 v[68:71], v[104:107], a[68:71], v[68:71]
	ds_read_b128 v[100:103], v245 offset:17408
	v_mfma_f32_16x16x32_bf16 v[72:75], v[108:111], a[68:71], v[72:75]
	ds_read_b128 v[104:107], v245 offset:18432
	s_waitcnt lgkmcnt(7)
	v_mfma_f32_16x16x32_bf16 v[76:79], v[112:115], a[68:71], v[76:79]
	ds_read_b128 v[108:111], v245 offset:19456
	v_mfma_f32_16x16x32_bf16 v[80:83], v[116:119], a[68:71], v[80:83]
	s_waitcnt vmcnt(10)
	v_mfma_f32_16x16x32_bf16 v[64:67], v[120:123], a[72:75], v[64:67]
	v_mfma_f32_16x16x32_bf16 v[68:71], v[124:127], a[72:75], v[68:71]
	s_waitcnt lgkmcnt(4)
	v_mfma_f32_16x16x32_bf16 v[72:75], v[128:131], a[72:75], v[72:75]
	v_mfma_f32_16x16x32_bf16 v[76:79], v[132:135], a[72:75], v[76:79]
	v_mfma_f32_16x16x32_bf16 v[80:83], v[136:139], a[72:75], v[80:83]
	s_waitcnt vmcnt(8)
	v_mfma_f32_16x16x32_bf16 v[64:67], v[140:143], a[76:79], v[64:67]
	s_waitcnt lgkmcnt(0)
	v_mfma_f32_16x16x32_bf16 v[68:71], v[96:99], a[76:79], v[68:71]
	v_mfma_f32_16x16x32_bf16 v[72:75], v[100:103], a[76:79], v[72:75]
	v_mfma_f32_16x16x32_bf16 v[76:79], v[104:107], a[76:79], v[76:79]
	v_mfma_f32_16x16x32_bf16 v[80:83], v[108:111], a[76:79], v[80:83]
	s_nop 2
	v_pk_add_f32 v[12:13], v[12:13], v[64:65]
	v_pk_add_f32 v[14:15], v[14:15], v[66:67]
	v_pk_add_f32 v[16:17], v[16:17], v[68:69]
	v_pk_add_f32 v[18:19], v[18:19], v[70:71]
	v_pk_add_f32 v[20:21], v[20:21], v[72:73]
	v_pk_add_f32 v[22:23], v[22:23], v[74:75]
	v_pk_add_f32 v[24:25], v[24:25], v[76:77]
	v_pk_add_f32 v[26:27], v[26:27], v[78:79]
	v_pk_add_f32 v[28:29], v[28:29], v[80:81]
	v_pk_add_f32 v[30:31], v[30:31], v[82:83]
	v_cvt_pk_bf16_f32 v128, v12, v13
	v_cvt_pk_bf16_f32 v129, v14, v15
	v_cvt_pk_bf16_f32 v130, v16, v17
	v_cvt_pk_bf16_f32 v131, v18, v19
	v_cvt_pk_bf16_f32 v132, v20, v21
	v_cvt_pk_bf16_f32 v133, v22, v23
	v_cvt_pk_bf16_f32 v134, v24, v25
	v_cvt_pk_bf16_f32 v135, v26, v27
	v_cvt_pk_bf16_f32 v136, v28, v29
	v_cvt_pk_bf16_f32 v137, v30, v31
	s_add_u32 s71, s58, 2621440
	s_add_u32 s72, s59, 15335424
	s_cmp_ge_u32 s99, s68
	s_cselect_b64 vcc, -1, 0
	s_cbranch_vccz Lst_23
	buffer_store_dwordx4 v[128:131], v5, s[4:7], s71 offen sc1
	s_branch Lst_23e
Lst_23:
	buffer_store_dwordx4 v[128:131], v5, s[4:7], s71 offen
Lst_23e:
	s_cbranch_vccz Lst_24
	buffer_store_dwordx4 v[132:135], v5, s[4:7], s71 offen offset:2048 sc1
	s_branch Lst_24e
Lst_24:
	buffer_store_dwordx4 v[132:135], v5, s[4:7], s71 offen offset:2048
Lst_24e:
	s_cbranch_vccz Lst_25
	buffer_store_dwordx2 v[136:137], v7, s[4:7], s71 offen sc1
	s_branch Lst_25e
Lst_25:
	buffer_store_dwordx2 v[136:137], v7, s[4:7], s71 offen
Lst_25e:
	v_pk_mul_f32 v[144:145], v[12:13], v[12:13]
	v_pk_mul_f32 v[146:147], v[14:15], v[14:15]
	v_pk_fma_f32 v[144:145], v[16:17], v[16:17], v[144:145]
	v_pk_fma_f32 v[146:147], v[18:19], v[18:19], v[146:147]
	v_pk_fma_f32 v[144:145], v[20:21], v[20:21], v[144:145]
	v_pk_fma_f32 v[146:147], v[22:23], v[22:23], v[146:147]
	v_pk_fma_f32 v[144:145], v[24:25], v[24:25], v[144:145]
	v_pk_fma_f32 v[146:147], v[26:27], v[26:27], v[146:147]
	v_pk_fma_f32 v[144:145], v[28:29], v[28:29], v[144:145]
	v_pk_fma_f32 v[146:147], v[30:31], v[30:31], v[146:147]
	v_pk_add_f32 v[140:141], v[12:13], v[14:15]
	v_pk_add_f32 v[142:143], v[16:17], v[18:19]
	v_pk_add_f32 v[140:141], v[140:141], v[20:21]
	v_pk_add_f32 v[142:143], v[142:143], v[22:23]
	v_pk_add_f32 v[140:141], v[140:141], v[24:25]
	v_pk_add_f32 v[142:143], v[142:143], v[26:27]
	v_pk_add_f32 v[140:141], v[140:141], v[28:29]
	v_pk_add_f32 v[142:143], v[142:143], v[30:31]
	v_pk_add_f32 v[140:141], v[140:141], v[142:143]
	v_add_f32 v140, v140, v141
	v_pk_add_f32 v[144:145], v[144:145], v[146:147]
	v_add_f32 v141, v144, v145
	s_nop 1
	v_permlane32_swap_b32 v140, v141
	v_add_f32 v140, v140, v141
	v_mov_b32 v141, v140
	s_nop 1
	v_permlane16_swap_b32 v140, v141
	v_add_f32 v140, v140, v141
	s_cbranch_vccz Lst_26
	buffer_store_dword v140, v8, s[4:7], s72 offen sc1
	s_branch Lst_26e
Lst_26:
	buffer_store_dword v140, v8, s[4:7], s72 offen
Lst_26e:
	s_barrier
	s_add_u32 m0, s51, 49152
	s_add_u32 s85, s54, 98304
	buffer_load_dwordx4 v1, s[4:7], s85 offen offset:0 sc1 lds
	buffer_load_dwordx4 v1, s[4:7], s85 offen offset:1024 sc1 lds
	buffer_load_dwordx4 v1, s[4:7], s85 offen offset:2048 sc1 lds
	buffer_load_dwordx4 v1, s[4:7], s85 offen offset:3072 sc1 lds
	s_add_u32 s71, s66, 4096
	s_lshl_b32 s72, s46, 2
	s_add_u32 s72, s72, s71
	s_waitcnt vmcnt(4)
	s_barrier
	s_cmp_lg_u32 s44, 0
	s_cbranch_scc1 Lsa_27
	s_mov_b64 exec, 1
	s_cmp_eq_u32 s99, 0
	s_cbranch_scc1 Lfl_29
	buffer_atomic_swap v244, off, s[4:7], s72 sc1
	s_branch Lfl_29e
Lfl_29:
	buffer_store_dword v244, off, s[4:7], s72
Lfl_29e:
	s_mov_b64 exec, -1
	s_mov_b64 exec, 0xffff
	buffer_load_dword v250, v247, s[4:7], s71 offen sc1
	s_mov_b64 exec, -1
	s_add_u32 m0, s51, 65536
	s_add_u32 s85, s54, 114688
	buffer_load_dwordx4 v1, s[4:7], s85 offen offset:0 sc1 lds
	buffer_load_dwordx4 v1, s[4:7], s85 offen offset:1024 sc1 lds
	buffer_load_dwordx4 v1, s[4:7], s85 offen offset:2048 sc1 lds
	buffer_load_dwordx4 v1, s[4:7], s85 offen offset:3072 sc1 lds
	s_mov_b64 exec, 0xffff
	s_waitcnt vmcnt(4)
	v_cmp_ne_u32 vcc, s70, v250
	s_cbranch_vccz Lpollf_32
Lpoll_30:
	buffer_load_dword v250, v247, s[4:7], s71 offen sc1
	s_sub_u32 s69, s69, 1
	s_cselect_b32 s69, 0, s69
	s_cbranch_scc1 Lpolle_31
	s_waitcnt vmcnt(0)
	v_cmp_ne_u32 vcc, s70, v250
	s_cbranch_vccnz Lpoll_30
Lpolle_31:
	s_waitcnt vmcnt(0)
Lpollf_32:
	s_mov_b64 exec, -1
	s_branch Lsb_28
Lsa_27:
	s_add_u32 m0, s51, 65536
	s_add_u32 s85, s54, 114688
	buffer_load_dwordx4 v1, s[4:7], s85 offen offset:0 sc1 lds
	buffer_load_dwordx4 v1, s[4:7], s85 offen offset:1024 sc1 lds
	buffer_load_dwordx4 v1, s[4:7], s85 offen offset:2048 sc1 lds
	buffer_load_dwordx4 v1, s[4:7], s85 offen offset:3072 sc1 lds
Lsb_28:
	s_barrier
	s_add_u32 s86, s56, 2621440
	buffer_load_dwordx4 a[0:3], v4, s[4:7], s86 offen offset:0 sc1
	buffer_load_dwordx4 a[4:7], v4, s[4:7], s86 offen offset:256 sc1
	buffer_load_dwordx4 a[8:11], v4, s[4:7], s86 offen offset:2048 sc1
	buffer_load_dwordx4 a[12:15], v4, s[4:7], s86 offen offset:2304 sc1
	s_add_u32 s86, s86, 4096
	buffer_load_dwordx4 a[16:19], v4, s[4:7], s86 offen offset:0 sc1
	buffer_load_dwordx4 a[20:23], v4, s[4:7], s86 offen offset:256 sc1
	ds_read_b128 v[32:35], v2 offset:16384
	ds_read_b128 v[36:39], v2 offset:17408
	ds_read_b128 v[40:43], v2 offset:18432
	ds_read_b128 v[44:47], v2 offset:19456
	ds_read_b128 v[48:51], v2 offset:20480
	ds_read_b128 v[52:55], v2 offset:21504
	ds_read_b128 v[56:59], v2 offset:22528
	s_waitcnt vmcnt(4) lgkmcnt(3)
	v_mfma_f32_16x16x32_bf16 v[64:67], v[32:35], a[0:3], 0
	ds_read_b128 v[60:63], v2 offset:23552
	v_mfma_f32_16x16x32_bf16 v[68:71], v[32:35], a[4:7], 0
	buffer_load_dwordx4 a[24:27], v4, s[4:7], s86 offen offset:2048 sc1
	v_mfma_f32_16x16x32_bf16 v[72:75], v[36:39], a[0:3], 0
	ds_read_b128 v[32:35], v2 offset:24576
	v_mfma_f32_16x16x32_bf16 v[76:79], v[36:39], a[4:7], 0
	buffer_load_dwordx4 a[28:31], v4, s[4:7], s86 offen offset:2304 sc1
	v_mfma_f32_16x16x32_bf16 v[80:83], v[40:43], a[0:3], 0
	ds_read_b128 v[36:39], v2 offset:25600
	v_mfma_f32_16x16x32_bf16 v[84:87], v[40:43], a[4:7], 0
	v_mfma_f32_16x16x32_bf16 v[88:91], v[44:47], a[0:3], 0
	ds_read_b128 v[40:43], v2 offset:26624
	s_add_u32 s86, s86, 4096
	v_mfma_f32_16x16x32_bf16 v[92:95], v[44:47], a[4:7], 0
	buffer_load_dwordx4 a[32:35], v4, s[4:7], s86 offen offset:0 sc1
	s_waitcnt lgkmcnt(3)
	v_mfma_f32_16x16x32_bf16 v[96:99], v[48:51], a[0:3], 0
	ds_read_b128 v[44:47], v2 offset:27648
	v_mfma_f32_16x16x32_bf16 v[100:103], v[48:51], a[4:7], 0
	buffer_load_dwordx4 a[36:39], v4, s[4:7], s86 offen offset:256 sc1
	v_mfma_f32_16x16x32_bf16 v[104:107], v[52:55], a[0:3], 0
	ds_read_b128 v[48:51], v2 offset:28672
	v_mfma_f32_16x16x32_bf16 v[108:111], v[52:55], a[4:7], 0
	s_waitcnt vmcnt(6)
	v_mfma_f32_16x16x32_bf16 v[64:67], v[56:59], a[8:11], v[64:67]
	ds_read_b128 v[52:55], v2 offset:29696
	v_mfma_f32_16x16x32_bf16 v[68:71], v[56:59], a[12:15], v[68:71]
	buffer_load_dwordx4 a[40:43], v4, s[4:7], s86 offen offset:2048 sc1
	v_mfma_f32_16x16x32_bf16 v[72:75], v[60:63], a[8:11], v[72:75]
	ds_read_b128 v[56:59], v2 offset:30720
	s_waitcnt lgkmcnt(3)
	v_mfma_f32_16x16x32_bf16 v[76:79], v[60:63], a[12:15], v[76:79]
	buffer_load_dwordx4 a[44:47], v4, s[4:7], s86 offen offset:2304 sc1
	v_mfma_f32_16x16x32_bf16 v[80:83], v[32:35], a[8:11], v[80:83]
	ds_read_b128 v[60:63], v2 offset:31744
	v_mfma_f32_16x16x32_bf16 v[84:87], v[32:35], a[12:15], v[84:87]
	v_mfma_f32_16x16x32_bf16 v[88:91], v[36:39], a[8:11], v[88:91]
	ds_read_b128 v[32:35], v2 offset:32768
	s_add_u32 s86, s86, 4096
	v_mfma_f32_16x16x32_bf16 v[92:95], v[36:39], a[12:15], v[92:95]
	buffer_load_dwordx4 a[48:51], v4, s[4:7], s86 offen offset:0 sc1
	v_mfma_f32_16x16x32_bf16 v[96:99], v[40:43], a[8:11], v[96:99]
	ds_read_b128 v[36:39], v2 offset:33792
	v_mfma_f32_16x16x32_bf16 v[100:103], v[40:43], a[12:15], v[100:103]
	buffer_load_dwordx4 a[52:55], v4, s[4:7], s86 offen offset:256 sc1
	v_mfma_f32_16x16x32_bf16 v[104:107], v[44:47], a[8:11], v[104:107]
	ds_read_b128 v[40:43], v2 offset:34816
	v_mfma_f32_16x16x32_bf16 v[108:111], v[44:47], a[12:15], v[108:111]
	s_waitcnt vmcnt(8) lgkmcnt(3)
	v_mfma_f32_16x16x32_bf16 v[64:67], v[48:51], a[16:19], v[64:67]
	ds_read_b128 v[44:47], v2 offset:35840
	v_mfma_f32_16x16x32_bf16 v[68:71], v[48:51], a[20:23], v[68:71]
	buffer_load_dwordx4 a[56:59], v4, s[4:7], s86 offen offset:2048 sc1
	v_mfma_f32_16x16x32_bf16 v[72:75], v[52:55], a[16:19], v[72:75]
	ds_read_b128 v[48:51], v2 offset:36864
	v_mfma_f32_16x16x32_bf16 v[76:79], v[52:55], a[20:23], v[76:79]
	v_mfma_f32_16x16x32_bf16 v[80:83], v[56:59], a[16:19], v[80:83]
	ds_read_b128 v[52:55], v2 offset:37888
	v_mfma_f32_16x16x32_bf16 v[84:87], v[56:59], a[20:23], v[84:87]
	v_mfma_f32_16x16x32_bf16 v[88:91], v[60:63], a[16:19], v[88:91]
	ds_read_b128 v[56:59], v2 offset:38912
	s_waitcnt lgkmcnt(3)
	v_mfma_f32_16x16x32_bf16 v[92:95], v[60:63], a[20:23], v[92:95]
	buffer_load_dwordx4 a[60:63], v4, s[4:7], s86 offen offset:2304 sc1
	v_mfma_f32_16x16x32_bf16 v[96:99], v[32:35], a[16:19], v[96:99]
	ds_read_b128 v[60:63], v2 offset:39936
	v_mfma_f32_16x16x32_bf16 v[100:103], v[32:35], a[20:23], v[100:103]
	v_mfma_f32_16x16x32_bf16 v[104:107], v[36:39], a[16:19], v[104:107]
	ds_read_b128 v[32:35], v2 offset:40960
	v_mfma_f32_16x16x32_bf16 v[108:111], v[36:39], a[20:23], v[108:111]
	s_waitcnt vmcnt(8)
	v_mfma_f32_16x16x32_bf16 v[64:67], v[40:43], a[24:27], v[64:67]
	ds_read_b128 v[36:39], v2 offset:41984
	s_add_u32 s86, s86, 4096
	v_mfma_f32_16x16x32_bf16 v[68:71], v[40:43], a[28:31], v[68:71]
	buffer_load_dwordx4 a[64:67], v4, s[4:7], s86 offen offset:0 sc1
	v_mfma_f32_16x16x32_bf16 v[72:75], v[44:47], a[24:27], v[72:75]
	ds_read_b128 v[40:43], v2 offset:43008
	v_mfma_f32_16x16x32_bf16 v[76:79], v[44:47], a[28:31], v[76:79]
	s_waitcnt lgkmcnt(3)
	v_mfma_f32_16x16x32_bf16 v[80:83], v[48:51], a[24:27], v[80:83]
	ds_read_b128 v[44:47], v2 offset:44032
	v_mfma_f32_16x16x32_bf16 v[84:87], v[48:51], a[28:31], v[84:87]
	s_add_u32 m0, s51, 131072
	s_add_u32 s85, s54, 131072
	v_mfma_f32_16x16x32_bf16 v[88:91], v[52:55], a[24:27], v[88:91]
	ds_read_b128 v[48:51], v2 offset:45056
	v_mfma_f32_16x16x32_bf16 v[92:95], v[52:55], a[28:31], v[92:95]
	buffer_load_dwordx4 a[68:71], v4, s[4:7], s86 offen offset:256 sc1
	v_mfma_f32_16x16x32_bf16 v[96:99], v[56:59], a[24:27], v[96:99]
	ds_read_b128 v[52:55], v2 offset:46080
	v_mfma_f32_16x16x32_bf16 v[100:103], v[56:59], a[28:31], v[100:103]
	buffer_load_dwordx4 v1, s[4:7], s85 offen offset:0 sc1 lds
	v_mfma_f32_16x16x32_bf16 v[104:107], v[60:63], a[24:27], v[104:107]
	ds_read_b128 v[56:59], v2 offset:47104
	v_mfma_f32_16x16x32_bf16 v[108:111], v[60:63], a[28:31], v[108:111]
	s_waitcnt vmcnt(9) lgkmcnt(3)
	v_mfma_f32_16x16x32_bf16 v[64:67], v[32:35], a[32:35], v[64:67]
	ds_read_b128 v[60:63], v2 offset:48128
	v_mfma_f32_16x16x32_bf16 v[68:71], v[32:35], a[36:39], v[68:71]
	buffer_load_dwordx4 a[72:75], v4, s[4:7], s86 offen offset:2048 sc1
	v_mfma_f32_16x16x32_bf16 v[72:75], v[36:39], a[32:35], v[72:75]
	ds_read_b128 v[32:35], v2 offset:49152
	v_mfma_f32_16x16x32_bf16 v[76:79], v[36:39], a[36:39], v[76:79]
	v_mfma_f32_16x16x32_bf16 v[80:83], v[40:43], a[32:35], v[80:83]
	ds_read_b128 v[36:39], v2 offset:50176
	v_mfma_f32_16x16x32_bf16 v[84:87], v[40:43], a[36:39], v[84:87]
	v_mfma_f32_16x16x32_bf16 v[88:91], v[44:47], a[32:35], v[88:91]
	ds_read_b128 v[40:43], v2 offset:51200
	s_waitcnt lgkmcnt(3)
	v_mfma_f32_16x16x32_bf16 v[92:95], v[44:47], a[36:39], v[92:95]
	buffer_load_dwordx4 a[76:79], v4, s[4:7], s86 offen offset:2304 sc1
	v_mfma_f32_16x16x32_bf16 v[96:99], v[48:51], a[32:35], v[96:99]
	ds_read_b128 v[44:47], v2 offset:52224
	v_mfma_f32_16x16x32_bf16 v[100:103], v[48:51], a[36:39], v[100:103]
	buffer_load_dwordx4 v1, s[4:7], s85 offen offset:1024 sc1 lds
	v_mfma_f32_16x16x32_bf16 v[104:107], v[52:55], a[32:35], v[104:107]
	ds_read_b128 v[48:51], v2 offset:53248
	v_mfma_f32_16x16x32_bf16 v[108:111], v[52:55], a[36:39], v[108:111]
	s_waitcnt vmcnt(10)
	v_mfma_f32_16x16x32_bf16 v[64:67], v[56:59], a[40:43], v[64:67]
	ds_read_b128 v[52:55], v2 offset:54272
	s_add_u32 s86, s86, 4096
	v_mfma_f32_16x16x32_bf16 v[68:71], v[56:59], a[44:47], v[68:71]
	buffer_load_dwordx4 a[80:83], v4, s[4:7], s86 offen offset:0 sc1
	v_mfma_f32_16x16x32_bf16 v[72:75], v[60:63], a[40:43], v[72:75]
	ds_read_b128 v[56:59], v2 offset:55296
	v_mfma_f32_16x16x32_bf16 v[76:79], v[60:63], a[44:47], v[76:79]
	s_waitcnt lgkmcnt(3)
	v_mfma_f32_16x16x32_bf16 v[80:83], v[32:35], a[40:43], v[80:83]
	ds_read_b128 v[60:63], v2 offset:56320
	v_mfma_f32_16x16x32_bf16 v[84:87], v[32:35], a[44:47], v[84:87]
	v_mfma_f32_16x16x32_bf16 v[88:91], v[36:39], a[40:43], v[88:91]
	ds_read_b128 v[32:35], v2 offset:57344
	v_mfma_f32_16x16x32_bf16 v[92:95], v[36:39], a[44:47], v[92:95]
	buffer_load_dwordx4 a[84:87], v4, s[4:7], s86 offen offset:256 sc1
	v_mfma_f32_16x16x32_bf16 v[96:99], v[40:43], a[40:43], v[96:99]
	ds_read_b128 v[36:39], v2 offset:58368
	v_mfma_f32_16x16x32_bf16 v[100:103], v[40:43], a[44:47], v[100:103]
	buffer_load_dwordx4 v1, s[4:7], s85 offen offset:2048 sc1 lds
	v_mfma_f32_16x16x32_bf16 v[104:107], v[44:47], a[40:43], v[104:107]
	ds_read_b128 v[40:43], v2 offset:59392
	v_mfma_f32_16x16x32_bf16 v[108:111], v[44:47], a[44:47], v[108:111]
	s_waitcnt vmcnt(11) lgkmcnt(3)
	v_mfma_f32_16x16x32_bf16 v[64:67], v[48:51], a[48:51], v[64:67]
	ds_read_b128 v[44:47], v2 offset:60416
	v_mfma_f32_16x16x32_bf16 v[68:71], v[48:51], a[52:55], v[68:71]
	buffer_load_dwordx4 a[88:91], v4, s[4:7], s86 offen offset:2048 sc1
	v_mfma_f32_16x16x32_bf16 v[72:75], v[52:55], a[48:51], v[72:75]
	ds_read_b128 v[48:51], v2 offset:61440
	v_mfma_f32_16x16x32_bf16 v[76:79], v[52:55], a[52:55], v[76:79]
	v_mfma_f32_16x16x32_bf16 v[80:83], v[56:59], a[48:51], v[80:83]
	ds_read_b128 v[52:55], v2 offset:62464
	v_mfma_f32_16x16x32_bf16 v[84:87], v[56:59], a[52:55], v[84:87]
	v_mfma_f32_16x16x32_bf16 v[88:91], v[60:63], a[48:51], v[88:91]
	ds_read_b128 v[56:59], v2 offset:63488
	s_waitcnt lgkmcnt(3)
	v_mfma_f32_16x16x32_bf16 v[92:95], v[60:63], a[52:55], v[92:95]
	buffer_load_dwordx4 a[92:95], v4, s[4:7], s86 offen offset:2304 sc1
	v_mfma_f32_16x16x32_bf16 v[96:99], v[32:35], a[48:51], v[96:99]
	ds_read_b128 v[60:63], v2 offset:64512
	v_mfma_f32_16x16x32_bf16 v[100:103], v[32:35], a[52:55], v[100:103]
	buffer_load_dwordx4 v1, s[4:7], s85 offen offset:3072 sc1 lds
	v_mfma_f32_16x16x32_bf16 v[104:107], v[36:39], a[48:51], v[104:107]
	ds_read_b128 v[32:35], v1 offset:0
	s_add_u32 s76, s57, 15335424
	v_mfma_f32_16x16x32_bf16 v[108:111], v[36:39], a[52:55], v[108:111]
	buffer_load_dwordx2 v[184:185], v9, s[4:7], s76 offen offset:0 sc1
	s_waitcnt vmcnt(13)
	v_mfma_f32_16x16x32_bf16 v[64:67], v[40:43], a[56:59], v[64:67]
	ds_read_b128 v[36:39], v1 offset:1024
	s_add_u32 s86, s86, 4096
	v_mfma_f32_16x16x32_bf16 v[68:71], v[40:43], a[60:63], v[68:71]
	buffer_load_dwordx4 a[96:99], v4, s[4:7], s86 offen offset:0 sc1
	v_mfma_f32_16x16x32_bf16 v[72:75], v[44:47], a[56:59], v[72:75]
	ds_read_b128 v[40:43], v1 offset:2048
	v_mfma_f32_16x16x32_bf16 v[76:79], v[44:47], a[60:63], v[76:79]
	s_waitcnt lgkmcnt(3)
	v_mfma_f32_16x16x32_bf16 v[80:83], v[48:51], a[56:59], v[80:83]
	ds_read_b128 v[44:47], v1 offset:3072
	v_mfma_f32_16x16x32_bf16 v[84:87], v[48:51], a[60:63], v[84:87]
	buffer_load_dwordx2 v[186:187], v9, s[4:7], s76 offen offset:256 sc1
	v_mfma_f32_16x16x32_bf16 v[88:91], v[52:55], a[56:59], v[88:91]
	ds_read_b128 v[48:51], v1 offset:4096
	v_mfma_f32_16x16x32_bf16 v[92:95], v[52:55], a[60:63], v[92:95]
	buffer_load_dwordx4 a[100:103], v4, s[4:7], s86 offen offset:256 sc1
	v_mfma_f32_16x16x32_bf16 v[96:99], v[56:59], a[56:59], v[96:99]
	ds_read_b128 v[52:55], v1 offset:5120
	v_mfma_f32_16x16x32_bf16 v[100:103], v[56:59], a[60:63], v[100:103]
	s_add_u32 m0, s51, 147456
	s_add_u32 s85, s54, 147456
	v_mfma_f32_16x16x32_bf16 v[104:107], v[60:63], a[56:59], v[104:107]
	ds_read_b128 v[56:59], v1 offset:6144
	s_waitcnt vmcnt(14) lgkmcnt(3)
	v_mfma_f32_16x16x32_bf16 v[108:111], v[60:63], a[60:63], v[108:111]
	buffer_load_dwordx2 v[188:189], v9, s[4:7], s76 offen offset:512 sc1
	v_mfma_f32_16x16x32_bf16 v[64:67], v[32:35], a[64:67], v[64:67]
	ds_read_b128 v[60:63], v1 offset:7168
	v_mfma_f32_16x16x32_bf16 v[68:71], v[32:35], a[68:71], v[68:71]
	buffer_load_dwordx4 a[104:107], v4, s[4:7], s86 offen offset:2048 sc1
	v_mfma_f32_16x16x32_bf16 v[72:75], v[36:39], a[64:67], v[72:75]
	ds_read_b128 v[32:35], v1 offset:8192
	v_mfma_f32_16x16x32_bf16 v[76:79], v[36:39], a[68:71], v[76:79]
	buffer_load_dwordx4 v1, s[4:7], s85 offen offset:0 sc1 lds
	v_mfma_f32_16x16x32_bf16 v[80:83], v[40:43], a[64:67], v[80:83]
	ds_read_b128 v[36:39], v1 offset:9216
	v_mfma_f32_16x16x32_bf16 v[84:87], v[40:43], a[68:71], v[84:87]
	buffer_load_dwordx2 v[190:191], v9, s[4:7], s76 offen offset:768 sc1
	v_mfma_f32_16x16x32_bf16 v[88:91], v[44:47], a[64:67], v[88:91]
	ds_read_b128 v[40:43], v1 offset:10240
	s_waitcnt lgkmcnt(3)
	v_mfma_f32_16x16x32_bf16 v[92:95], v[44:47], a[68:71], v[92:95]
	buffer_load_dwordx4 a[108:111], v4, s[4:7], s86 offen offset:2304 sc1
	v_mfma_f32_16x16x32_bf16 v[96:99], v[48:51], a[64:67], v[96:99]
	ds_read_b128 v[44:47], v1 offset:11264
	v_mfma_f32_16x16x32_bf16 v[100:103], v[48:51], a[68:71], v[100:103]
	v_mfma_f32_16x16x32_bf16 v[104:107], v[52:55], a[64:67], v[104:107]
	ds_read_b128 v[48:51], v1 offset:12288
	v_mfma_f32_16x16x32_bf16 v[108:111], v[52:55], a[68:71], v[108:111]
	s_waitcnt vmcnt(16)
	v_mfma_f32_16x16x32_bf16 v[64:67], v[56:59], a[72:75], v[64:67]
	ds_read_b128 v[52:55], v1 offset:13312
	s_add_u32 s86, s86, 4096
	v_mfma_f32_16x16x32_bf16 v[68:71], v[56:59], a[76:79], v[68:71]
	buffer_load_dwordx4 a[112:115], v4, s[4:7], s86 offen offset:0 sc1
	v_mfma_f32_16x16x32_bf16 v[72:75], v[60:63], a[72:75], v[72:75]
	ds_read_b128 v[56:59], v1 offset:14336
	s_waitcnt lgkmcnt(3)
	v_mfma_f32_16x16x32_bf16 v[76:79], v[60:63], a[76:79], v[76:79]
	buffer_load_dwordx4 v1, s[4:7], s85 offen offset:1024 sc1 lds
	v_mfma_f32_16x16x32_bf16 v[80:83], v[32:35], a[72:75], v[80:83]
	ds_read_b128 v[60:63], v1 offset:15360
	v_mfma_f32_16x16x32_bf16 v[84:87], v[32:35], a[76:79], v[84:87]
	v_mfma_f32_16x16x32_bf16 v[88:91], v[36:39], a[72:75], v[88:91]
	ds_read_b128 v[32:35], v1 offset:16384
	v_mfma_f32_16x16x32_bf16 v[92:95], v[36:39], a[76:79], v[92:95]
	buffer_load_dwordx4 a[116:119], v4, s[4:7], s86 offen offset:256 sc1
	v_mfma_f32_16x16x32_bf16 v[96:99], v[40:43], a[72:75], v[96:99]
	ds_read_b128 v[36:39], v1 offset:17408
	v_mfma_f32_16x16x32_bf16 v[100:103], v[40:43], a[76:79], v[100:103]
	v_mfma_f32_16x16x32_bf16 v[104:107], v[44:47], a[72:75], v[104:107]
	ds_read_b128 v[40:43], v1 offset:18432
	v_mfma_f32_16x16x32_bf16 v[108:111], v[44:47], a[76:79], v[108:111]
	s_waitcnt vmcnt(16) lgkmcnt(3)
	v_mfma_f32_16x16x32_bf16 v[64:67], v[48:51], a[80:83], v[64:67]
	ds_read_b128 v[44:47], v1 offset:19456
	v_mfma_f32_16x16x32_bf16 v[68:71], v[48:51], a[84:87], v[68:71]
	buffer_load_dwordx4 a[120:123], v4, s[4:7], s86 offen offset:2048 sc1
	v_mfma_f32_16x16x32_bf16 v[72:75], v[52:55], a[80:83], v[72:75]
	ds_read_b128 v[48:51], v1 offset:20480
	v_mfma_f32_16x16x32_bf16 v[76:79], v[52:55], a[84:87], v[76:79]
	buffer_load_dwordx4 v1, s[4:7], s85 offen offset:2048 sc1 lds
	v_mfma_f32_16x16x32_bf16 v[80:83], v[56:59], a[80:83], v[80:83]
	ds_read_b128 v[52:55], v1 offset:21504
	v_mfma_f32_16x16x32_bf16 v[84:87], v[56:59], a[84:87], v[84:87]
	v_mfma_f32_16x16x32_bf16 v[88:91], v[60:63], a[80:83], v[88:91]
	ds_read_b128 v[56:59], v1 offset:22528
	s_waitcnt lgkmcnt(3)
	v_mfma_f32_16x16x32_bf16 v[92:95], v[60:63], a[84:87], v[92:95]
	buffer_load_dwordx4 a[124:127], v4, s[4:7], s86 offen offset:2304 sc1
	v_mfma_f32_16x16x32_bf16 v[96:99], v[32:35], a[80:83], v[96:99]
	ds_read_b128 v[60:63], v1 offset:23552
	v_mfma_f32_16x16x32_bf16 v[100:103], v[32:35], a[84:87], v[100:103]
	v_mfma_f32_16x16x32_bf16 v[104:107], v[36:39], a[80:83], v[104:107]
	ds_read_b128 v[32:35], v1 offset:24576
	v_mfma_f32_16x16x32_bf16 v[108:111], v[36:39], a[84:87], v[108:111]
	s_waitcnt vmcnt(16)
	v_mfma_f32_16x16x32_bf16 v[64:67], v[40:43], a[88:91], v[64:67]
	ds_read_b128 v[36:39], v1 offset:25600
	s_add_u32 s86, s86, 4096
	v_mfma_f32_16x16x32_bf16 v[68:71], v[40:43], a[92:95], v[68:71]
	buffer_load_dwordx4 a[128:131], v4, s[4:7], s86 offen offset:0 sc1
	v_mfma_f32_16x16x32_bf16 v[72:75], v[44:47], a[88:91], v[72:75]
	ds_read_b128 v[40:43], v1 offset:26624
	s_waitcnt lgkmcnt(3)
	v_mfma_f32_16x16x32_bf16 v[76:79], v[44:47], a[92:95], v[76:79]
	buffer_load_dwordx4 v1, s[4:7], s85 offen offset:3072 sc1 lds
	v_mfma_f32_16x16x32_bf16 v[80:83], v[48:51], a[88:91], v[80:83]
	ds_read_b128 v[44:47], v1 offset:27648
	v_mfma_f32_16x16x32_bf16 v[84:87], v[48:51], a[92:95], v[84:87]
	v_mfma_f32_16x16x32_bf16 v[88:91], v[52:55], a[88:91], v[88:91]
	ds_read_b128 v[48:51], v1 offset:28672
	v_mfma_f32_16x16x32_bf16 v[92:95], v[52:55], a[92:95], v[92:95]
	buffer_load_dwordx4 a[132:135], v4, s[4:7], s86 offen offset:256 sc1
	v_mfma_f32_16x16x32_bf16 v[96:99], v[56:59], a[88:91], v[96:99]
	ds_read_b128 v[52:55], v1 offset:29696
	v_mfma_f32_16x16x32_bf16 v[100:103], v[56:59], a[92:95], v[100:103]
	v_mfma_f32_16x16x32_bf16 v[104:107], v[60:63], a[88:91], v[104:107]
	ds_read_b128 v[56:59], v1 offset:30720
	v_mfma_f32_16x16x32_bf16 v[108:111], v[60:63], a[92:95], v[108:111]
	s_waitcnt vmcnt(14) lgkmcnt(3)
	v_mfma_f32_16x16x32_bf16 v[64:67], v[32:35], a[96:99], v[64:67]
	ds_read_b128 v[60:63], v1 offset:31744
	v_mfma_f32_16x16x32_bf16 v[68:71], v[32:35], a[100:103], v[68:71]
	buffer_load_dwordx4 a[136:139], v4, s[4:7], s86 offen offset:2048 sc1
	v_mfma_f32_16x16x32_bf16 v[72:75], v[36:39], a[96:99], v[72:75]
	ds_read_b128 v[32:35], v1 offset:32768
	s_barrier
	v_mfma_f32_16x16x32_bf16 v[76:79], v[36:39], a[100:103], v[76:79]
	s_add_u32 m0, s51, 0
	s_add_u32 s85, s54, 163840
	v_mfma_f32_16x16x32_bf16 v[80:83], v[40:43], a[96:99], v[80:83]
	ds_read_b128 v[36:39], v1 offset:33792
	v_mfma_f32_16x16x32_bf16 v[84:87], v[40:43], a[100:103], v[84:87]
	buffer_load_dwordx4 v1, s[4:7], s85 offen offset:0 sc1 lds
	v_mfma_f32_16x16x32_bf16 v[88:91], v[44:47], a[96:99], v[88:91]
	ds_read_b128 v[40:43], v1 offset:34816
	s_waitcnt lgkmcnt(3)
	v_mfma_f32_16x16x32_bf16 v[92:95], v[44:47], a[100:103], v[92:95]
	buffer_load_dwordx4 a[140:143], v4, s[4:7], s86 offen offset:2304 sc1
	v_mfma_f32_16x16x32_bf16 v[96:99], v[48:51], a[96:99], v[96:99]
	ds_read_b128 v[44:47], v1 offset:35840
	v_mfma_f32_16x16x32_bf16 v[100:103], v[48:51], a[100:103], v[100:103]
	v_mfma_f32_16x16x32_bf16 v[104:107], v[52:55], a[96:99], v[104:107]
	ds_read_b128 v[48:51], v1 offset:36864
	v_mfma_f32_16x16x32_bf16 v[108:111], v[52:55], a[100:103], v[108:111]
	s_waitcnt vmcnt(12)
	v_mfma_f32_16x16x32_bf16 v[64:67], v[56:59], a[104:107], v[64:67]
	ds_read_b128 v[52:55], v1 offset:37888
	s_add_u32 s86, s86, 4096
	v_mfma_f32_16x16x32_bf16 v[68:71], v[56:59], a[108:111], v[68:71]
	buffer_load_dwordx4 a[144:147], v4, s[4:7], s86 offen offset:0 sc1
	v_mfma_f32_16x16x32_bf16 v[72:75], v[60:63], a[104:107], v[72:75]
	ds_read_b128 v[56:59], v1 offset:38912
	s_waitcnt lgkmcnt(3)
	v_mfma_f32_16x16x32_bf16 v[76:79], v[60:63], a[108:111], v[76:79]
	buffer_load_dwordx4 v1, s[4:7], s85 offen offset:1024 sc1 lds
	v_mfma_f32_16x16x32_bf16 v[80:83], v[32:35], a[104:107], v[80:83]
	ds_read_b128 v[60:63], v1 offset:39936
	v_mfma_f32_16x16x32_bf16 v[84:87], v[32:35], a[108:111], v[84:87]
	v_mfma_f32_16x16x32_bf16 v[88:91], v[36:39], a[104:107], v[88:91]
	ds_read_b128 v[32:35], v1 offset:40960
	v_mfma_f32_16x16x32_bf16 v[92:95], v[36:39], a[108:111], v[92:95]
	buffer_load_dwordx4 a[148:151], v4, s[4:7], s86 offen offset:256 sc1
	v_mfma_f32_16x16x32_bf16 v[96:99], v[40:43], a[104:107], v[96:99]
	ds_read_b128 v[36:39], v1 offset:41984
	v_mfma_f32_16x16x32_bf16 v[100:103], v[40:43], a[108:111], v[100:103]
	v_mfma_f32_16x16x32_bf16 v[104:107], v[44:47], a[104:107], v[104:107]
	ds_read_b128 v[40:43], v1 offset:43008
	v_mfma_f32_16x16x32_bf16 v[108:111], v[44:47], a[108:111], v[108:111]
	s_waitcnt vmcnt(12) lgkmcnt(3)
	v_mfma_f32_16x16x32_bf16 v[64:67], v[48:51], a[112:115], v[64:67]
	ds_read_b128 v[44:47], v1 offset:44032
	v_add_f32 v168, v184, v188
	v_mfma_f32_16x16x32_bf16 v[68:71], v[48:51], a[116:119], v[68:71]
	buffer_load_dwordx4 a[152:155], v4, s[4:7], s86 offen offset:2048 sc1
	v_mfma_f32_16x16x32_bf16 v[72:75], v[52:55], a[112:115], v[72:75]
	ds_read_b128 v[48:51], v1 offset:45056
	v_add_f32 v169, v185, v189
	v_mfma_f32_16x16x32_bf16 v[76:79], v[52:55], a[116:119], v[76:79]
	buffer_load_dwordx4 v1, s[4:7], s85 offen offset:2048 sc1 lds
	v_mfma_f32_16x16x32_bf16 v[80:83], v[56:59], a[112:115], v[80:83]
	ds_read_b128 v[52:55], v1 offset:46080
	v_add_f32 v170, v186, v190
	v_mfma_f32_16x16x32_bf16 v[84:87], v[56:59], a[116:119], v[84:87]
	v_add_f32 v171, v187, v191
	v_add_f32 v168, v168, v170
	v_mfma_f32_16x16x32_bf16 v[88:91], v[60:63], a[112:115], v[88:91]
	ds_read_b128 v[56:59], v1 offset:47104
	s_waitcnt lgkmcnt(3)
	v_mfma_f32_16x16x32_bf16 v[92:95], v[60:63], a[116:119], v[92:95]
	buffer_load_dwordx4 a[156:159], v4, s[4:7], s86 offen offset:2304 sc1
	v_mfma_f32_16x16x32_bf16 v[96:99], v[32:35], a[112:115], v[96:99]
	ds_read_b128 v[60:63], v1 offset:48128
	v_add_f32 v169, v169, v171
	v_mfma_f32_16x16x32_bf16 v[100:103], v[32:35], a[116:119], v[100:103]
	v_mov_b32 v186, 0
	v_mov_b32 v187, 0
	v_mfma_f32_16x16x32_bf16 v[104:107], v[36:39], a[112:115], v[104:107]
	ds_read_b128 v[32:35], v1 offset:49152
	v_permlane32_swap_b32 v168, v169
	v_mfma_f32_16x16x32_bf16 v[108:111], v[36:39], a[116:119], v[108:111]
	v_add_f32 v168, v168, v169
	s_waitcnt vmcnt(12)
	v_mfma_f32_16x16x32_bf16 v[64:67], v[40:43], a[120:123], v[64:67]
	ds_read_b128 v[36:39], v1 offset:50176
	v_mov_b32 v169, v168
	v_mfma_f32_16x16x32_bf16 v[68:71], v[40:43], a[124:127], v[68:71]
	buffer_load_dwordx4 v1, s[4:7], s85 offen offset:3072 sc1 lds
	v_mfma_f32_16x16x32_bf16 v[72:75], v[44:47], a[120:123], v[72:75]
	ds_read_b128 v[40:43], v1 offset:51200
	v_mov_b32 v190, 0
	v_mfma_f32_16x16x32_bf16 v[76:79], v[44:47], a[124:127], v[76:79]
	v_mov_b32 v191, 0
	s_waitcnt lgkmcnt(3)
	v_mfma_f32_16x16x32_bf16 v[80:83], v[48:51], a[120:123], v[80:83]
	ds_read_b128 v[44:47], v1 offset:52224
	v_permlane32_swap_b32 v168, v169
	v_mfma_f32_16x16x32_bf16 v[84:87], v[48:51], a[124:127], v[84:87]
	v_mul_f32 v170, 0xbacccccd, v168
	v_mul_f32 v171, 0xbacccccd, v168
	v_mfma_f32_16x16x32_bf16 v[88:91], v[52:55], a[120:123], v[88:91]
	ds_read_b128 v[48:51], v1 offset:53248
	s_mov_b32 s78, 0xffff
	v_mfma_f32_16x16x32_bf16 v[92:95], v[52:55], a[124:127], v[92:95]
	s_mov_b32 s79, 0
	v_permlane16_swap_b32 v170, v171
	v_mfma_f32_16x16x32_bf16 v[96:99], v[56:59], a[120:123], v[96:99]
	ds_read_b128 v[52:55], v1 offset:54272
	v_cndmask_b32 v170, 0, v170, s[78:79]
	v_mfma_f32_16x16x32_bf16 v[100:103], v[56:59], a[124:127], v[100:103]
	v_cvt_pk_bf16_f32 v184, v170, v170
	v_lshlrev_b32 v185, 16, v184
	v_mfma_f32_16x16x32_bf16 v[104:107], v[60:63], a[120:123], v[104:107]
	ds_read_b128 v[56:59], v1 offset:55296
	v_sub_f32 v170, v170, v185
	v_mfma_f32_16x16x32_bf16 v[108:111], v[60:63], a[124:127], v[108:111]
	s_add_u32 m0, s51, 81920
	s_add_u32 s85, s54, 180224
	s_waitcnt vmcnt(10) lgkmcnt(3)
	v_mfma_f32_16x16x32_bf16 v[64:67], v[32:35], a[128:131], v[64:67]
	ds_read_b128 v[60:63], v1 offset:56320
	v_cvt_pk_bf16_f32 v185, v170, 0
	v_mfma_f32_16x16x32_bf16 v[68:71], v[32:35], a[132:135], v[68:71]
	buffer_load_dwordx4 v1, s[4:7], s85 offen offset:0 sc1 lds
	v_mfma_f32_16x16x32_bf16 v[72:75], v[36:39], a[128:131], v[72:75]
	ds_read_b128 v[32:35], v1 offset:57344
	v_cndmask_b32 v171, 0, v171, s[78:79]
	v_mfma_f32_16x16x32_bf16 v[76:79], v[36:39], a[132:135], v[76:79]
	v_cvt_pk_bf16_f32 v188, v171, v171
	v_lshlrev_b32 v189, 16, v188
	v_mfma_f32_16x16x32_bf16 v[80:83], v[40:43], a[128:131], v[80:83]
	ds_read_b128 v[36:39], v1 offset:58368
	v_sub_f32 v171, v171, v189
	v_mfma_f32_16x16x32_bf16 v[84:87], v[40:43], a[132:135], v[84:87]
	v_cvt_pk_bf16_f32 v189, v171, 0
	v_mfma_f32_16x16x32_bf16 v[88:91], v[44:47], a[128:131], v[88:91]
	ds_read_b128 v[40:43], v1 offset:59392
	v_mfma_f32_16x16x32_bf16 v[92:95], v[44:47], a[132:135], v[92:95]
	s_waitcnt lgkmcnt(3)
	v_mfma_f32_16x16x32_bf16 v[96:99], v[48:51], a[128:131], v[96:99]
	ds_read_b128 v[44:47], v1 offset:60416
	v_mfma_f32_16x16x32_bf16 v[100:103], v[48:51], a[132:135], v[100:103]
	v_mfma_f32_16x16x32_bf16 v[104:107], v[52:55], a[128:131], v[104:107]
	ds_read_b128 v[48:51], v1 offset:61440
	s_waitcnt vmcnt(8)
	v_mfma_f32_16x16x32_bf16 v[108:111], v[52:55], a[132:135], v[108:111]
	buffer_load_dwordx4 v1, s[4:7], s85 offen offset:1024 sc1 lds
	v_mfma_f32_16x16x32_bf16 v[64:67], v[56:59], a[136:139], v[64:67]
	ds_read_b128 v[52:55], v1 offset:62464
	v_mfma_f32_16x16x32_bf16 v[68:71], v[56:59], a[140:143], v[68:71]
	v_mfma_f32_16x16x32_bf16 v[72:75], v[60:63], a[136:139], v[72:75]
	ds_read_b128 v[56:59], v1 offset:63488
	v_mfma_f32_16x16x32_bf16 v[76:79], v[60:63], a[140:143], v[76:79]
	s_waitcnt lgkmcnt(3)
	v_mfma_f32_16x16x32_bf16 v[80:83], v[32:35], a[136:139], v[80:83]
	ds_read_b128 v[60:63], v1 offset:64512
	v_mfma_f32_16x16x32_bf16 v[84:87], v[32:35], a[140:143], v[84:87]
	v_mfma_f32_16x16x32_bf16 v[88:91], v[36:39], a[136:139], v[88:91]
	ds_read_b128 v[32:35], v2 offset:0
	v_mfma_f32_16x16x32_bf16 v[92:95], v[36:39], a[140:143], v[92:95]
	v_mfma_f32_16x16x32_bf16 v[96:99], v[40:43], a[136:139], v[96:99]
	ds_read_b128 v[36:39], v2 offset:1024
	v_mfma_f32_16x16x32_bf16 v[100:103], v[40:43], a[140:143], v[100:103]
	buffer_load_dwordx4 v1, s[4:7], s85 offen offset:2048 sc1 lds
	v_mfma_f32_16x16x32_bf16 v[104:107], v[44:47], a[136:139], v[104:107]
	ds_read_b128 v[40:43], v2 offset:2048
	v_mfma_f32_16x16x32_bf16 v[108:111], v[44:47], a[140:143], v[108:111]
	s_waitcnt vmcnt(7) lgkmcnt(3)
	v_mfma_f32_16x16x32_bf16 v[64:67], v[48:51], a[144:147], v[64:67]
	ds_read_b128 v[44:47], v2 offset:3072
	v_mfma_f32_16x16x32_bf16 v[68:71], v[48:51], a[148:151], v[68:71]
	v_mfma_f32_16x16x32_bf16 v[72:75], v[52:55], a[144:147], v[72:75]
	ds_read_b128 v[48:51], v2 offset:4096
	v_mfma_f32_16x16x32_bf16 v[76:79], v[52:55], a[148:151], v[76:79]
	v_mfma_f32_16x16x32_bf16 v[80:83], v[56:59], a[144:147], v[80:83]
	ds_read_b128 v[52:55], v2 offset:5120
	v_mfma_f32_16x16x32_bf16 v[84:87], v[56:59], a[148:151], v[84:87]
	v_mfma_f32_16x16x32_bf16 v[88:91], v[60:63], a[144:147], v[88:91]
	ds_read_b128 v[56:59], v2 offset:6144
	s_waitcnt lgkmcnt(3)
	v_mfma_f32_16x16x32_bf16 v[92:95], v[60:63], a[148:151], v[92:95]
	buffer_load_dwordx4 v1, s[4:7], s85 offen offset:3072 sc1 lds
	v_mfma_f32_16x16x32_bf16 v[96:99], v[32:35], a[144:147], v[96:99]
	ds_read_b128 v[60:63], v2 offset:7168
	v_mfma_f32_16x16x32_bf16 v[100:103], v[32:35], a[148:151], v[100:103]
	v_mfma_f32_16x16x32_bf16 v[104:107], v[36:39], a[144:147], v[104:107]
	ds_read_b128 v[32:35], v2 offset:8192
	v_mfma_f32_16x16x32_bf16 v[108:111], v[36:39], a[148:151], v[108:111]
	s_waitcnt vmcnt(5)
	v_mfma_f32_16x16x32_bf16 v[64:67], v[40:43], a[152:155], v[64:67]
	ds_read_b128 v[36:39], v2 offset:9216
	v_mfma_f32_16x16x32_bf16 v[68:71], v[40:43], a[156:159], v[68:71]
	v_mfma_f32_16x16x32_bf16 v[72:75], v[44:47], a[152:155], v[72:75]
	ds_read_b128 v[40:43], v2 offset:10240
	v_mfma_f32_16x16x32_bf16 v[76:79], v[44:47], a[156:159], v[76:79]
	s_waitcnt lgkmcnt(3)
	v_mfma_f32_16x16x32_bf16 v[80:83], v[48:51], a[152:155], v[80:83]
	ds_read_b128 v[44:47], v2 offset:11264
	v_mfma_f32_16x16x32_bf16 v[84:87], v[48:51], a[156:159], v[84:87]
	s_add_u32 m0, s51, 98304
	s_add_u32 s85, s54, 196608
	v_mfma_f32_16x16x32_bf16 v[88:91], v[52:55], a[152:155], v[88:91]
	ds_read_b128 v[48:51], v2 offset:12288
	v_mfma_f32_16x16x32_bf16 v[92:95], v[52:55], a[156:159], v[92:95]
	buffer_load_dwordx4 v1, s[4:7], s85 offen offset:0 sc1 lds
	v_mfma_f32_16x16x32_bf16 v[96:99], v[56:59], a[152:155], v[96:99]
	ds_read_b128 v[52:55], v2 offset:13312
	v_mfma_f32_16x16x32_bf16 v[100:103], v[56:59], a[156:159], v[100:103]
	v_mfma_f32_16x16x32_bf16 v[104:107], v[60:63], a[152:155], v[104:107]
	ds_read_b128 v[56:59], v2 offset:14336
	v_mfma_f32_16x16x32_bf16 v[108:111], v[60:63], a[156:159], v[108:111]
	v_mfma_f32_16x16x32_bf16 v[64:67], a[192:195], v[184:187], v[64:67]
	buffer_load_dwordx4 v1, s[4:7], s85 offen offset:1024 sc1 lds
	v_mfma_f32_16x16x32_bf16 v[68:71], a[192:195], v[188:191], v[68:71]
	buffer_load_dwordx4 v1, s[4:7], s85 offen offset:2048 sc1 lds
	v_mfma_f32_16x16x32_bf16 v[72:75], a[194:197], v[184:187], v[72:75]
	buffer_load_dwordx4 v1, s[4:7], s85 offen offset:3072 sc1 lds
	v_mfma_f32_16x16x32_bf16 v[76:79], a[194:197], v[188:191], v[76:79]
	v_mfma_f32_16x16x32_bf16 v[80:83], a[196:199], v[184:187], v[80:83]
	v_mfma_f32_16x16x32_bf16 v[84:87], a[196:199], v[188:191], v[84:87]
	v_mfma_f32_16x16x32_bf16 v[88:91], a[198:201], v[184:187], v[88:91]
	v_mfma_f32_16x16x32_bf16 v[92:95], a[198:201], v[188:191], v[92:95]
	v_mfma_f32_16x16x32_bf16 v[96:99], a[200:203], v[184:187], v[96:99]
	v_mfma_f32_16x16x32_bf16 v[100:103], a[200:203], v[188:191], v[100:103]
	v_mfma_f32_16x16x32_bf16 v[104:107], a[202:205], v[184:187], v[104:107]
	v_mfma_f32_16x16x32_bf16 v[108:111], a[202:205], v[188:191], v[108:111]
	s_waitcnt lgkmcnt(3)
	v_mfma_f32_16x16x32_bf16 v[112:115], v[32:35], a[0:3], 0
	ds_read_b128 v[60:63], v2 offset:15360
	v_mfma_f32_16x16x32_bf16 v[116:119], v[32:35], a[4:7], 0
	s_add_u32 m0, s51, 114688
	s_add_u32 s85, s54, 212992
	v_mfma_f32_16x16x32_bf16 v[120:123], v[36:39], a[0:3], 0
	ds_read_b128 v[32:35], v245 offset:0
	v_mfma_f32_16x16x32_bf16 v[124:127], v[36:39], a[4:7], 0
	buffer_load_dwordx4 v1, s[4:7], s85 offen offset:0 sc1 lds
	v_mfma_f32_16x16x32_bf16 v[128:131], v[40:43], a[0:3], 0
	ds_read_b128 v[36:39], v245 offset:1024
	v_max_f32 v64, 0, v64
	v_mfma_f32_16x16x32_bf16 v[132:135], v[40:43], a[4:7], 0
	v_max_f32 v65, 0, v65
	v_max_f32 v66, 0, v66
	v_mfma_f32_16x16x32_bf16 v[136:139], v[44:47], a[0:3], 0
	ds_read_b128 v[40:43], v245 offset:2048
	s_waitcnt lgkmcnt(3)
	v_mfma_f32_16x16x32_bf16 v[140:143], v[44:47], a[4:7], 0
	buffer_load_dwordx4 v1, s[4:7], s85 offen offset:1024 sc1 lds
	v_mfma_f32_16x16x32_bf16 v[112:115], v[48:51], a[8:11], v[112:115]
	ds_read_b128 v[44:47], v245 offset:3072
	v_max_f32 v67, 0, v67
	v_mfma_f32_16x16x32_bf16 v[116:119], v[48:51], a[12:15], v[116:119]
	v_max_f32 v68, 0, v68
	v_max_f32 v69, 0, v69
	v_mfma_f32_16x16x32_bf16 v[120:123], v[52:55], a[8:11], v[120:123]
	ds_read_b128 v[48:51], v245 offset:4096
	v_max_f32 v70, 0, v70
	v_mfma_f32_16x16x32_bf16 v[124:127], v[52:55], a[12:15], v[124:127]
	buffer_load_dwordx4 v1, s[4:7], s85 offen offset:2048 sc1 lds
	v_mfma_f32_16x16x32_bf16 v[128:131], v[56:59], a[8:11], v[128:131]
	ds_read_b128 v[52:55], v245 offset:5120
	v_max_f32 v71, 0, v71
	v_mfma_f32_16x16x32_bf16 v[132:135], v[56:59], a[12:15], v[132:135]
	v_mul_f32 v64, v64, v72
	v_mul_f32 v65, v65, v73
	v_mfma_f32_16x16x32_bf16 v[136:139], v[60:63], a[8:11], v[136:139]
	ds_read_b128 v[56:59], v245 offset:6144
	s_waitcnt lgkmcnt(3)
	v_mfma_f32_16x16x32_bf16 v[140:143], v[60:63], a[12:15], v[140:143]
	buffer_load_dwordx4 v1, s[4:7], s85 offen offset:3072 sc1 lds
	v_mfma_f32_16x16x32_bf16 v[112:115], v[32:35], a[16:19], v[112:115]
	ds_read_b128 v[60:63], v245 offset:7168
	v_mul_f32 v66, v66, v74
	v_mfma_f32_16x16x32_bf16 v[116:119], v[32:35], a[20:23], v[116:119]
	v_mul_f32 v67, v67, v75
	v_mul_f32 v68, v68, v76
	v_mfma_f32_16x16x32_bf16 v[120:123], v[36:39], a[16:19], v[120:123]
	ds_read_b128 v[32:35], v245 offset:8192
	v_mul_f32 v69, v69, v77
	v_mfma_f32_16x16x32_bf16 v[124:127], v[36:39], a[20:23], v[124:127]
	v_mul_f32 v70, v70, v78
	v_mul_f32 v71, v71, v79
	v_mfma_f32_16x16x32_bf16 v[128:131], v[40:43], a[16:19], v[128:131]
	ds_read_b128 v[36:39], v245 offset:9216
	s_barrier
	v_mfma_f32_16x16x32_bf16 v[132:135], v[40:43], a[20:23], v[132:135]
	s_add_u32 m0, s51, 16384
	s_add_u32 s85, s54, 229376
	v_mfma_f32_16x16x32_bf16 v[136:139], v[44:47], a[16:19], v[136:139]
	ds_read_b128 v[40:43], v245 offset:10240
	s_waitcnt lgkmcnt(3)
	v_mfma_f32_16x16x32_bf16 v[140:143], v[44:47], a[20:23], v[140:143]
	buffer_load_dwordx4 v1, s[4:7], s85 offen offset:0 sc1 lds
	v_mfma_f32_16x16x32_bf16 v[112:115], v[48:51], a[24:27], v[112:115]
	ds_read_b128 v[44:47], v245 offset:11264
	v_cvt_pk_bf16_f32 v160, v64, v65
	v_mfma_f32_16x16x32_bf16 v[116:119], v[48:51], a[28:31], v[116:119]
	v_cvt_pk_bf16_f32 v161, v66, v67
	v_cvt_pk_bf16_f32 v164, v68, v69
	v_mfma_f32_16x16x32_bf16 v[120:123], v[52:55], a[24:27], v[120:123]
	ds_read_b128 v[48:51], v245 offset:12288
	v_cvt_pk_bf16_f32 v165, v70, v71
	v_mfma_f32_16x16x32_bf16 v[124:127], v[52:55], a[28:31], v[124:127]
	buffer_load_dwordx4 v1, s[4:7], s85 offen offset:1024 sc1 lds
	v_mfma_f32_16x16x32_bf16 v[128:131], v[56:59], a[24:27], v[128:131]
	ds_read_b128 v[52:55], v245 offset:13312
	v_max_f32 v80, 0, v80
	v_mfma_f32_16x16x32_bf16 v[132:135], v[56:59], a[28:31], v[132:135]
	v_max_f32 v81, 0, v81
	v_max_f32 v82, 0, v82
	v_mfma_f32_16x16x32_bf16 v[136:139], v[60:63], a[24:27], v[136:139]
	ds_read_b128 v[56:59], v245 offset:14336
	s_waitcnt lgkmcnt(3)
	v_mfma_f32_16x16x32_bf16 v[140:143], v[60:63], a[28:31], v[140:143]
	buffer_load_dwordx4 v1, s[4:7], s85 offen offset:2048 sc1 lds
	v_mfma_f32_16x16x32_bf16 v[112:115], v[32:35], a[32:35], v[112:115]
	ds_read_b128 v[60:63], v245 offset:15360
	v_max_f32 v83, 0, v83
	v_mfma_f32_16x16x32_bf16 v[116:119], v[32:35], a[36:39], v[116:119]
	v_max_f32 v84, 0, v84
	v_max_f32 v85, 0, v85
	v_mfma_f32_16x16x32_bf16 v[120:123], v[36:39], a[32:35], v[120:123]
	ds_read_b128 v[32:35], v245 offset:16384
	v_max_f32 v86, 0, v86
	v_mfma_f32_16x16x32_bf16 v[124:127], v[36:39], a[36:39], v[124:127]
	buffer_load_dwordx4 v1, s[4:7], s85 offen offset:3072 sc1 lds
	v_mfma_f32_16x16x32_bf16 v[128:131], v[40:43], a[32:35], v[128:131]
	ds_read_b128 v[36:39], v245 offset:17408
	v_max_f32 v87, 0, v87
	v_mfma_f32_16x16x32_bf16 v[132:135], v[40:43], a[36:39], v[132:135]
	v_mul_f32 v80, v80, v88
	v_mul_f32 v81, v81, v89
	v_mfma_f32_16x16x32_bf16 v[136:139], v[44:47], a[32:35], v[136:139]
	ds_read_b128 v[40:43], v245 offset:18432
	v_mul_f32 v82, v82, v90
	v_mfma_f32_16x16x32_bf16 v[140:143], v[44:47], a[36:39], v[140:143]
	v_mul_f32 v83, v83, v91
	s_waitcnt lgkmcnt(3)
	v_mfma_f32_16x16x32_bf16 v[112:115], v[48:51], a[40:43], v[112:115]
	ds_read_b128 v[44:47], v245 offset:19456
	v_mul_f32 v84, v84, v92
	v_mfma_f32_16x16x32_bf16 v[116:119], v[48:51], a[44:47], v[116:119]
	s_add_u32 m0, s51, 32768
	s_add_u32 s85, s55, 0
	v_mfma_f32_16x16x32_bf16 v[120:123], v[52:55], a[40:43], v[120:123]
	ds_read_b128 v[48:51], v245 offset:20480
	v_mul_f32 v85, v85, v93
	v_mfma_f32_16x16x32_bf16 v[124:127], v[52:55], a[44:47], v[124:127]
	buffer_load_dwordx4 v1, s[4:7], s85 offen offset:0 sc1 lds
	v_mfma_f32_16x16x32_bf16 v[128:131], v[56:59], a[40:43], v[128:131]
	ds_read_b128 v[52:55], v245 offset:21504
	v_mul_f32 v86, v86, v94
	v_mfma_f32_16x16x32_bf16 v[132:135], v[56:59], a[44:47], v[132:135]
	v_mul_f32 v87, v87, v95
	v_cvt_pk_bf16_f32 v162, v80, v81
	v_mfma_f32_16x16x32_bf16 v[136:139], v[60:63], a[40:43], v[136:139]
	ds_read_b128 v[56:59], v245 offset:22528
	s_waitcnt lgkmcnt(3)
	v_mfma_f32_16x16x32_bf16 v[140:143], v[60:63], a[44:47], v[140:143]
	buffer_load_dwordx4 v1, s[4:7], s85 offen offset:1024 sc1 lds
	v_mfma_f32_16x16x32_bf16 v[112:115], v[32:35], a[48:51], v[112:115]
	ds_read_b128 v[60:63], v245 offset:23552
	v_cvt_pk_bf16_f32 v163, v82, v83
	v_mfma_f32_16x16x32_bf16 v[116:119], v[32:35], a[52:55], v[116:119]
	v_mfma_f32_16x16x32_bf16 v[120:123], v[36:39], a[48:51], v[120:123]
	ds_read_b128 v[32:35], v245 offset:24576
	v_cvt_pk_bf16_f32 v166, v84, v85
	v_mfma_f32_16x16x32_bf16 v[124:127], v[36:39], a[52:55], v[124:127]
	buffer_store_dwordx4 v[160:163], v4, s[4:7], s62 offen offset:0 sc1
	v_mfma_f32_16x16x32_bf16 v[128:131], v[40:43], a[48:51], v[128:131]
	ds_read_b128 v[36:39], v245 offset:25600
	v_cvt_pk_bf16_f32 v167, v86, v87
	v_mfma_f32_16x16x32_bf16 v[132:135], v[40:43], a[52:55], v[132:135]
	buffer_load_dwordx4 v1, s[4:7], s85 offen offset:2048 sc1 lds
	v_mfma_f32_16x16x32_bf16 v[136:139], v[44:47], a[48:51], v[136:139]
	ds_read_b128 v[40:43], v245 offset:26624
	s_waitcnt lgkmcnt(3)
	v_mfma_f32_16x16x32_bf16 v[140:143], v[44:47], a[52:55], v[140:143]
	buffer_store_dwordx4 v[164:167], v4, s[4:7], s62 offen offset:256 sc1
	v_mfma_f32_16x16x32_bf16 v[112:115], v[48:51], a[56:59], v[112:115]
	ds_read_b128 v[44:47], v245 offset:27648
	v_max_f32 v96, 0, v96
	v_mfma_f32_16x16x32_bf16 v[116:119], v[48:51], a[60:63], v[116:119]
	buffer_load_dwordx4 v1, s[4:7], s85 offen offset:3072 sc1 lds
	v_mfma_f32_16x16x32_bf16 v[120:123], v[52:55], a[56:59], v[120:123]
	ds_read_b128 v[48:51], v245 offset:28672
	v_max_f32 v97, 0, v97
	v_mfma_f32_16x16x32_bf16 v[124:127], v[52:55], a[60:63], v[124:127]
	v_max_f32 v98, 0, v98
	v_max_f32 v99, 0, v99
	v_mfma_f32_16x16x32_bf16 v[128:131], v[56:59], a[56:59], v[128:131]
	ds_read_b128 v[52:55], v245 offset:29696
	v_max_f32 v100, 0, v100
	v_mfma_f32_16x16x32_bf16 v[132:135], v[56:59], a[60:63], v[132:135]
	s_add_u32 m0, s51, 49152
	s_add_u32 s85, s55, 16384
	v_mfma_f32_16x16x32_bf16 v[136:139], v[60:63], a[56:59], v[136:139]
	ds_read_b128 v[56:59], v245 offset:30720
	s_waitcnt lgkmcnt(3)
	v_mfma_f32_16x16x32_bf16 v[140:143], v[60:63], a[60:63], v[140:143]
	buffer_load_dwordx4 v1, s[4:7], s85 offen offset:0 sc1 lds
	v_mfma_f32_16x16x32_bf16 v[112:115], v[32:35], a[64:67], v[112:115]
	ds_read_b128 v[60:63], v245 offset:31744
	v_max_f32 v101, 0, v101
	v_mfma_f32_16x16x32_bf16 v[116:119], v[32:35], a[68:71], v[116:119]
	v_max_f32 v102, 0, v102
	v_max_f32 v103, 0, v103
	v_mfma_f32_16x16x32_bf16 v[120:123], v[36:39], a[64:67], v[120:123]
	s_waitcnt vmcnt(23)
	s_barrier
	ds_read_b128 v[32:35], v1 offset:0
	v_mfma_f32_16x16x32_bf16 v[124:127], v[36:39], a[68:71], v[124:127]
	buffer_load_dwordx4 v1, s[4:7], s85 offen offset:1024 sc1 lds
	v_mfma_f32_16x16x32_bf16 v[128:131], v[40:43], a[64:67], v[128:131]
	ds_read_b128 v[36:39], v1 offset:1024
	v_mul_f32 v96, v96, v104
	v_mfma_f32_16x16x32_bf16 v[132:135], v[40:43], a[68:71], v[132:135]
	v_mul_f32 v97, v97, v105
	v_mul_f32 v98, v98, v106
	v_mfma_f32_16x16x32_bf16 v[136:139], v[44:47], a[64:67], v[136:139]
	ds_read_b128 v[40:43], v1 offset:2048
	s_waitcnt lgkmcnt(3)
	v_mfma_f32_16x16x32_bf16 v[140:143], v[44:47], a[68:71], v[140:143]
	buffer_load_dwordx4 v1, s[4:7], s85 offen offset:2048 sc1 lds
	v_mfma_f32_16x16x32_bf16 v[112:115], v[48:51], a[72:75], v[112:115]
	ds_read_b128 v[44:47], v1 offset:3072
	v_mul_f32 v99, v99, v107
	v_mfma_f32_16x16x32_bf16 v[116:119], v[48:51], a[76:79], v[116:119]
	v_mul_f32 v100, v100, v108
	v_mul_f32 v101, v101, v109
	v_mfma_f32_16x16x32_bf16 v[120:123], v[52:55], a[72:75], v[120:123]
	ds_read_b128 v[48:51], v1 offset:4096
	v_mul_f32 v102, v102, v110
	v_mfma_f32_16x16x32_bf16 v[124:127], v[52:55], a[76:79], v[124:127]
	buffer_load_dwordx4 v1, s[4:7], s85 offen offset:3072 sc1 lds
	v_mfma_f32_16x16x32_bf16 v[128:131], v[56:59], a[72:75], v[128:131]
	ds_read_b128 v[52:55], v1 offset:5120
	v_mul_f32 v103, v103, v111
	v_mfma_f32_16x16x32_bf16 v[132:135], v[56:59], a[76:79], v[132:135]
	v_cvt_pk_bf16_f32 v168, v96, v97
	v_cvt_pk_bf16_f32 v169, v98, v99
	v_mfma_f32_16x16x32_bf16 v[136:139], v[60:63], a[72:75], v[136:139]
	ds_read_b128 v[56:59], v1 offset:6144
	v_cvt_pk_bf16_f32 v172, v100, v101
	v_mfma_f32_16x16x32_bf16 v[140:143], v[60:63], a[76:79], v[140:143]
	v_cvt_pk_bf16_f32 v173, v102, v103
	s_waitcnt lgkmcnt(3)
	v_mfma_f32_16x16x32_bf16 v[112:115], v[32:35], a[80:83], v[112:115]
	ds_read_b128 v[60:63], v1 offset:7168
	v_mfma_f32_16x16x32_bf16 v[116:119], v[32:35], a[84:87], v[116:119]
	s_add_u32 m0, s51, 65536
	s_add_u32 s85, s55, 32768
	v_mfma_f32_16x16x32_bf16 v[120:123], v[36:39], a[80:83], v[120:123]
	ds_read_b128 v[32:35], v1 offset:8192
	v_mfma_f32_16x16x32_bf16 v[124:127], v[36:39], a[84:87], v[124:127]
	buffer_load_dwordx4 v1, s[4:7], s85 offen offset:0 sc1 lds
	v_mfma_f32_16x16x32_bf16 v[128:131], v[40:43], a[80:83], v[128:131]
	ds_read_b128 v[36:39], v1 offset:9216
	v_mfma_f32_16x16x32_bf16 v[132:135], v[40:43], a[84:87], v[132:135]
	v_mfma_f32_16x16x32_bf16 v[136:139], v[44:47], a[80:83], v[136:139]
	ds_read_b128 v[40:43], v1 offset:10240
	s_waitcnt lgkmcnt(3)
	v_mfma_f32_16x16x32_bf16 v[140:143], v[44:47], a[84:87], v[140:143]
	buffer_load_dwordx4 v1, s[4:7], s85 offen offset:1024 sc1 lds
	v_mfma_f32_16x16x32_bf16 v[112:115], v[48:51], a[88:91], v[112:115]
	ds_read_b128 v[44:47], v1 offset:11264
	v_mfma_f32_16x16x32_bf16 v[116:119], v[48:51], a[92:95], v[116:119]
	v_mfma_f32_16x16x32_bf16 v[120:123], v[52:55], a[88:91], v[120:123]
	ds_read_b128 v[48:51], v1 offset:12288
	v_mfma_f32_16x16x32_bf16 v[124:127], v[52:55], a[92:95], v[124:127]
	buffer_load_dwordx4 v1, s[4:7], s85 offen offset:2048 sc1 lds
	v_mfma_f32_16x16x32_bf16 v[128:131], v[56:59], a[88:91], v[128:131]
	ds_read_b128 v[52:55], v1 offset:13312
	v_mfma_f32_16x16x32_bf16 v[132:135], v[56:59], a[92:95], v[132:135]
	v_mfma_f32_16x16x32_bf16 v[136:139], v[60:63], a[88:91], v[136:139]
	ds_read_b128 v[56:59], v1 offset:14336
	s_waitcnt lgkmcnt(3)
	v_mfma_f32_16x16x32_bf16 v[140:143], v[60:63], a[92:95], v[140:143]
	buffer_load_dwordx4 v1, s[4:7], s85 offen offset:3072 sc1 lds
	v_mfma_f32_16x16x32_bf16 v[112:115], v[32:35], a[96:99], v[112:115]
	ds_read_b128 v[60:63], v1 offset:15360
	v_mfma_f32_16x16x32_bf16 v[116:119], v[32:35], a[100:103], v[116:119]
	v_mfma_f32_16x16x32_bf16 v[120:123], v[36:39], a[96:99], v[120:123]
	s_waitcnt vmcnt(26)
	s_barrier
	ds_read_b128 v[32:35], v2 offset:16384
	v_mfma_f32_16x16x32_bf16 v[124:127], v[36:39], a[100:103], v[124:127]
	v_mfma_f32_16x16x32_bf16 v[128:131], v[40:43], a[96:99], v[128:131]
	ds_read_b128 v[36:39], v2 offset:17408
	v_mfma_f32_16x16x32_bf16 v[132:135], v[40:43], a[100:103], v[132:135]
	s_add_u32 m0, s51, 131072
	s_add_u32 s85, s55, 49152
	v_mfma_f32_16x16x32_bf16 v[136:139], v[44:47], a[96:99], v[136:139]
	ds_read_b128 v[40:43], v2 offset:18432
	s_waitcnt lgkmcnt(3)
	v_mfma_f32_16x16x32_bf16 v[140:143], v[44:47], a[100:103], v[140:143]
	buffer_load_dwordx4 v1, s[4:7], s85 offen offset:0 sc1 lds
	v_mfma_f32_16x16x32_bf16 v[112:115], v[48:51], a[104:107], v[112:115]
	ds_read_b128 v[44:47], v2 offset:19456
	v_mfma_f32_16x16x32_bf16 v[116:119], v[48:51], a[108:111], v[116:119]
	v_mfma_f32_16x16x32_bf16 v[120:123], v[52:55], a[104:107], v[120:123]
	ds_read_b128 v[48:51], v2 offset:20480
	v_mfma_f32_16x16x32_bf16 v[124:127], v[52:55], a[108:111], v[124:127]
	buffer_load_dwordx4 v1, s[4:7], s85 offen offset:1024 sc1 lds
	v_mfma_f32_16x16x32_bf16 v[128:131], v[56:59], a[104:107], v[128:131]
	ds_read_b128 v[52:55], v2 offset:21504
	v_mfma_f32_16x16x32_bf16 v[132:135], v[56:59], a[108:111], v[132:135]
	v_mfma_f32_16x16x32_bf16 v[136:139], v[60:63], a[104:107], v[136:139]
	ds_read_b128 v[56:59], v2 offset:22528
	s_waitcnt lgkmcnt(3)
	v_mfma_f32_16x16x32_bf16 v[140:143], v[60:63], a[108:111], v[140:143]
	buffer_load_dwordx4 v1, s[4:7], s85 offen offset:2048 sc1 lds
	v_mfma_f32_16x16x32_bf16 v[112:115], v[32:35], a[112:115], v[112:115]
	ds_read_b128 v[60:63], v2 offset:23552
	v_mfma_f32_16x16x32_bf16 v[116:119], v[32:35], a[116:119], v[116:119]
	s_lshl_b32 s72, s46, 2
	s_add_u32 s72, s72, s66
	s_add_u32 s72, s72, 24576
	s_waitcnt vmcnt(12)
	s_barrier
	s_cmp_lg_u32 s44, 0
	s_cbranch_scc1 Lw0_33
	s_mov_b64 exec, 1
	s_cmp_eq_u32 s99, 0
	s_cbranch_scc1 Lfl_34
	buffer_atomic_swap v244, off, s[4:7], s72 sc1
	s_branch Lfl_34e
Lfl_34:
	buffer_store_dword v244, off, s[4:7], s72
Lfl_34e:
	s_mov_b64 exec, -1
Lw0_33:
	v_mfma_f32_16x16x32_bf16 v[120:123], v[36:39], a[112:115], v[120:123]
	ds_read_b128 v[32:35], v2 offset:24576
	v_mfma_f32_16x16x32_bf16 v[124:127], v[36:39], a[116:119], v[124:127]
	buffer_load_dwordx4 v1, s[4:7], s85 offen offset:3072 sc1 lds
	v_mfma_f32_16x16x32_bf16 v[128:131], v[40:43], a[112:115], v[128:131]
	ds_read_b128 v[36:39], v2 offset:25600
	v_mfma_f32_16x16x32_bf16 v[132:135], v[40:43], a[116:119], v[132:135]
	v_mfma_f32_16x16x32_bf16 v[136:139], v[44:47], a[112:115], v[136:139]
	ds_read_b128 v[40:43], v2 offset:26624
	v_mfma_f32_16x16x32_bf16 v[140:143], v[44:47], a[116:119], v[140:143]
	s_waitcnt lgkmcnt(3)
	v_mfma_f32_16x16x32_bf16 v[112:115], v[48:51], a[120:123], v[112:115]
	ds_read_b128 v[44:47], v2 offset:27648
	v_mfma_f32_16x16x32_bf16 v[116:119], v[48:51], a[124:127], v[116:119]
	s_add_u32 m0, s51, 0
	s_add_u32 s85, s55, 65536
	v_mfma_f32_16x16x32_bf16 v[120:123], v[52:55], a[120:123], v[120:123]
	ds_read_b128 v[48:51], v2 offset:28672
	v_mfma_f32_16x16x32_bf16 v[124:127], v[52:55], a[124:127], v[124:127]
	buffer_load_dwordx4 v1, s[4:7], s85 offen offset:0 sc1 lds
	v_mfma_f32_16x16x32_bf16 v[128:131], v[56:59], a[120:123], v[128:131]
	ds_read_b128 v[52:55], v2 offset:29696
	v_mfma_f32_16x16x32_bf16 v[132:135], v[56:59], a[124:127], v[132:135]
	v_mfma_f32_16x16x32_bf16 v[136:139], v[60:63], a[120:123], v[136:139]
	ds_read_b128 v[56:59], v2 offset:30720
	s_waitcnt lgkmcnt(3)
	v_mfma_f32_16x16x32_bf16 v[140:143], v[60:63], a[124:127], v[140:143]
	buffer_load_dwordx4 v1, s[4:7], s85 offen offset:1024 sc1 lds
	v_mfma_f32_16x16x32_bf16 v[112:115], v[32:35], a[128:131], v[112:115]
	ds_read_b128 v[60:63], v2 offset:31744
	v_mfma_f32_16x16x32_bf16 v[116:119], v[32:35], a[132:135], v[116:119]
	v_mfma_f32_16x16x32_bf16 v[120:123], v[36:39], a[128:131], v[120:123]
	ds_read_b128 v[32:35], v2 offset:32768
	v_mfma_f32_16x16x32_bf16 v[124:127], v[36:39], a[132:135], v[124:127]
	buffer_load_dwordx4 v1, s[4:7], s85 offen offset:2048 sc1 lds
	v_mfma_f32_16x16x32_bf16 v[128:131], v[40:43], a[128:131], v[128:131]
	ds_read_b128 v[36:39], v2 offset:33792
	v_mfma_f32_16x16x32_bf16 v[132:135], v[40:43], a[132:135], v[132:135]
	v_mfma_f32_16x16x32_bf16 v[136:139], v[44:47], a[128:131], v[136:139]
	ds_read_b128 v[40:43], v2 offset:34816
	s_waitcnt lgkmcnt(3)
	v_mfma_f32_16x16x32_bf16 v[140:143], v[44:47], a[132:135], v[140:143]
	buffer_load_dwordx4 v1, s[4:7], s85 offen offset:3072 sc1 lds
	v_mfma_f32_16x16x32_bf16 v[112:115], v[48:51], a[136:139], v[112:115]
	ds_read_b128 v[44:47], v2 offset:35840
	v_mfma_f32_16x16x32_bf16 v[116:119], v[48:51], a[140:143], v[116:119]
	v_mfma_f32_16x16x32_bf16 v[120:123], v[52:55], a[136:139], v[120:123]
	ds_read_b128 v[48:51], v2 offset:36864
	v_mfma_f32_16x16x32_bf16 v[124:127], v[52:55], a[140:143], v[124:127]
	v_mfma_f32_16x16x32_bf16 v[128:131], v[56:59], a[136:139], v[128:131]
	ds_read_b128 v[52:55], v2 offset:37888
	v_mfma_f32_16x16x32_bf16 v[132:135], v[56:59], a[140:143], v[132:135]
	s_add_u32 m0, s51, 147456
	s_add_u32 s85, s55, 81920
	v_mfma_f32_16x16x32_bf16 v[136:139], v[60:63], a[136:139], v[136:139]
	ds_read_b128 v[56:59], v2 offset:38912
	s_waitcnt lgkmcnt(3)
	v_mfma_f32_16x16x32_bf16 v[140:143], v[60:63], a[140:143], v[140:143]
	buffer_load_dwordx4 v1, s[4:7], s85 offen offset:0 sc1 lds
	v_mfma_f32_16x16x32_bf16 v[112:115], v[32:35], a[144:147], v[112:115]
	ds_read_b128 v[60:63], v2 offset:39936
	v_mfma_f32_16x16x32_bf16 v[116:119], v[32:35], a[148:151], v[116:119]
	v_mfma_f32_16x16x32_bf16 v[120:123], v[36:39], a[144:147], v[120:123]
	ds_read_b128 v[32:35], v2 offset:40960
	v_mfma_f32_16x16x32_bf16 v[124:127], v[36:39], a[148:151], v[124:127]
	buffer_load_dwordx4 v1, s[4:7], s85 offen offset:1024 sc1 lds
	v_mfma_f32_16x16x32_bf16 v[128:131], v[40:43], a[144:147], v[128:131]
	ds_read_b128 v[36:39], v2 offset:41984
	v_mfma_f32_16x16x32_bf16 v[132:135], v[40:43], a[148:151], v[132:135]
	v_mfma_f32_16x16x32_bf16 v[136:139], v[44:47], a[144:147], v[136:139]
	ds_read_b128 v[40:43], v2 offset:43008
	s_waitcnt lgkmcnt(3)
	v_mfma_f32_16x16x32_bf16 v[140:143], v[44:47], a[148:151], v[140:143]
	buffer_load_dwordx4 v1, s[4:7], s85 offen offset:2048 sc1 lds
	v_mfma_f32_16x16x32_bf16 v[112:115], v[48:51], a[152:155], v[112:115]
	ds_read_b128 v[44:47], v2 offset:44032
	v_mfma_f32_16x16x32_bf16 v[116:119], v[48:51], a[156:159], v[116:119]
	v_mfma_f32_16x16x32_bf16 v[120:123], v[52:55], a[152:155], v[120:123]
	ds_read_b128 v[48:51], v2 offset:45056
	v_mfma_f32_16x16x32_bf16 v[124:127], v[52:55], a[156:159], v[124:127]
	buffer_load_dwordx4 v1, s[4:7], s85 offen offset:3072 sc1 lds
	v_mfma_f32_16x16x32_bf16 v[128:131], v[56:59], a[152:155], v[128:131]
	ds_read_b128 v[52:55], v2 offset:46080
	v_mfma_f32_16x16x32_bf16 v[132:135], v[56:59], a[156:159], v[132:135]
	v_mfma_f32_16x16x32_bf16 v[136:139], v[60:63], a[152:155], v[136:139]
	ds_read_b128 v[56:59], v2 offset:47104
	v_mfma_f32_16x16x32_bf16 v[140:143], v[60:63], a[156:159], v[140:143]
	v_mfma_f32_16x16x32_bf16 v[112:115], a[204:207], v[184:187], v[112:115]
	v_mfma_f32_16x16x32_bf16 v[116:119], a[204:207], v[188:191], v[116:119]
	v_mfma_f32_16x16x32_bf16 v[120:123], a[206:209], v[184:187], v[120:123]
	v_mfma_f32_16x16x32_bf16 v[124:127], a[206:209], v[188:191], v[124:127]
	v_mfma_f32_16x16x32_bf16 v[128:131], a[208:211], v[184:187], v[128:131]
	v_mfma_f32_16x16x32_bf16 v[132:135], a[208:211], v[188:191], v[132:135]
	v_mfma_f32_16x16x32_bf16 v[136:139], a[210:213], v[184:187], v[136:139]
	v_mfma_f32_16x16x32_bf16 v[140:143], a[210:213], v[188:191], v[140:143]
	s_waitcnt lgkmcnt(3)
	v_mfma_f32_16x16x32_bf16 v[144:147], v[32:35], a[0:3], 0
	ds_read_b128 v[60:63], v2 offset:48128
	v_mfma_f32_16x16x32_bf16 v[148:151], v[32:35], a[4:7], 0
	s_add_u32 s71, s66, 24576
	buffer_load_dword v250, v247, s[4:7], s71 offen sc1
	v_mfma_f32_16x16x32_bf16 v[152:155], v[36:39], a[0:3], 0
	ds_read_b128 v[32:35], v2 offset:49152
	s_barrier
	v_mfma_f32_16x16x32_bf16 v[156:159], v[36:39], a[4:7], 0
	s_add_u32 m0, s51, 81920
	s_add_u32 s85, s55, 98304
	v_mfma_f32_16x16x32_bf16 v[144:147], v[40:43], a[8:11], v[144:147]
	ds_read_b128 v[36:39], v2 offset:50176
	v_max_f32 v112, 0, v112
	v_mfma_f32_16x16x32_bf16 v[148:151], v[40:43], a[12:15], v[148:151]
	buffer_load_dwordx4 v1, s[4:7], s85 offen offset:0 sc1 lds
	v_mfma_f32_16x16x32_bf16 v[152:155], v[44:47], a[8:11], v[152:155]
	ds_read_b128 v[40:43], v2 offset:51200
	v_max_f32 v113, 0, v113
	v_mfma_f32_16x16x32_bf16 v[156:159], v[44:47], a[12:15], v[156:159]
	v_max_f32 v114, 0, v114
	s_waitcnt lgkmcnt(3)
	v_mfma_f32_16x16x32_bf16 v[144:147], v[48:51], a[16:19], v[144:147]
	ds_read_b128 v[44:47], v2 offset:52224
	v_max_f32 v115, 0, v115
	v_mfma_f32_16x16x32_bf16 v[148:151], v[48:51], a[20:23], v[148:151]
	buffer_load_dwordx4 v1, s[4:7], s85 offen offset:1024 sc1 lds
	v_mfma_f32_16x16x32_bf16 v[152:155], v[52:55], a[16:19], v[152:155]
	ds_read_b128 v[48:51], v2 offset:53248
	v_max_f32 v116, 0, v116
	v_mfma_f32_16x16x32_bf16 v[156:159], v[52:55], a[20:23], v[156:159]
	v_max_f32 v117, 0, v117
	v_max_f32 v118, 0, v118
	v_mfma_f32_16x16x32_bf16 v[144:147], v[56:59], a[24:27], v[144:147]
	ds_read_b128 v[52:55], v2 offset:54272
	v_max_f32 v119, 0, v119
	v_mfma_f32_16x16x32_bf16 v[148:151], v[56:59], a[28:31], v[148:151]
	buffer_load_dwordx4 v1, s[4:7], s85 offen offset:2048 sc1 lds
	v_mfma_f32_16x16x32_bf16 v[152:155], v[60:63], a[24:27], v[152:155]
	ds_read_b128 v[56:59], v2 offset:55296
	v_mul_f32 v112, v112, v120
	v_mfma_f32_16x16x32_bf16 v[156:159], v[60:63], a[28:31], v[156:159]
	v_mul_f32 v113, v113, v121
	s_waitcnt lgkmcnt(3)
	v_mfma_f32_16x16x32_bf16 v[144:147], v[32:35], a[32:35], v[144:147]
	ds_read_b128 v[60:63], v2 offset:56320
	v_mul_f32 v114, v114, v122
	v_mfma_f32_16x16x32_bf16 v[148:151], v[32:35], a[36:39], v[148:151]
	buffer_load_dwordx4 v1, s[4:7], s85 offen offset:3072 sc1 lds
	v_mfma_f32_16x16x32_bf16 v[152:155], v[36:39], a[32:35], v[152:155]
	ds_read_b128 v[32:35], v2 offset:57344
	v_mul_f32 v115, v115, v123
	v_mfma_f32_16x16x32_bf16 v[156:159], v[36:39], a[36:39], v[156:159]
	v_mul_f32 v116, v116, v124
	v_mul_f32 v117, v117, v125
	v_mfma_f32_16x16x32_bf16 v[144:147], v[40:43], a[40:43], v[144:147]
	ds_read_b128 v[36:39], v2 offset:58368
	s_barrier
	v_mfma_f32_16x16x32_bf16 v[148:151], v[40:43], a[44:47], v[148:151]
	s_add_u32 m0, s51, 98304
	s_add_u32 s85, s55, 114688
	v_mfma_f32_16x16x32_bf16 v[152:155], v[44:47], a[40:43], v[152:155]
	ds_read_b128 v[40:43], v2 offset:59392
	s_waitcnt lgkmcnt(3)
	v_mfma_f32_16x16x32_bf16 v[156:159], v[44:47], a[44:47], v[156:159]
	buffer_load_dwordx4 v1, s[4:7], s85 offen offset:0 sc1 lds
	v_mfma_f32_16x16x32_bf16 v[144:147], v[48:51], a[48:51], v[144:147]
	ds_read_b128 v[44:47], v2 offset:60416
	v_mul_f32 v118, v118, v126
	v_mfma_f32_16x16x32_bf16 v[148:151], v[48:51], a[52:55], v[148:151]
	s_waitcnt vmcnt(5)
	v_cmp_ne_u32 vcc, s70, v250
	s_nop 0
	s_and_b32 s72, vcc_lo, 0xffff
	s_cbranch_scc1 Lslow_35
Lslow_35r:
	v_mfma_f32_16x16x32_bf16 v[152:155], v[52:55], a[48:51], v[152:155]
	ds_read_b128 v[48:51], v2 offset:61440
	v_mul_f32 v119, v119, v127
	v_mfma_f32_16x16x32_bf16 v[156:159], v[52:55], a[52:55], v[156:159]
	buffer_load_dwordx4 v1, s[4:7], s85 offen offset:1024 sc1 lds
	v_mfma_f32_16x16x32_bf16 v[144:147], v[56:59], a[56:59], v[144:147]
	ds_read_b128 v[52:55], v2 offset:62464
	v_cvt_pk_bf16_f32 v170, v112, v113
	v_mfma_f32_16x16x32_bf16 v[148:151], v[56:59], a[60:63], v[148:151]
	v_cvt_pk_bf16_f32 v171, v114, v115
	v_mfma_f32_16x16x32_bf16 v[152:155], v[60:63], a[56:59], v[152:155]
	ds_read_b128 v[56:59], v2 offset:63488
	s_waitcnt lgkmcnt(3)
	v_mfma_f32_16x16x32_bf16 v[156:159], v[60:63], a[60:63], v[156:159]
	buffer_store_dwordx4 v[168:171], v4, s[4:7], s77 offen offset:0 sc1
	v_mfma_f32_16x16x32_bf16 v[144:147], v[32:35], a[64:67], v[144:147]
	ds_read_b128 v[60:63], v2 offset:64512
	s_mov_b32 s86, s63
	v_mfma_f32_16x16x32_bf16 v[148:151], v[32:35], a[68:71], v[148:151]
	buffer_load_dwordx4 a[160:163], v5, s[4:7], s86 offen offset:0 sc1
	v_mfma_f32_16x16x32_bf16 v[152:155], v[36:39], a[64:67], v[152:155]
	ds_read_b128 v[32:35], v1 offset:16384
	v_cvt_pk_bf16_f32 v174, v116, v117
	v_mfma_f32_16x16x32_bf16 v[156:159], v[36:39], a[68:71], v[156:159]
	buffer_load_dwordx4 v1, s[4:7], s85 offen offset:2048 sc1 lds
	v_mfma_f32_16x16x32_bf16 v[144:147], v[40:43], a[72:75], v[144:147]
	ds_read_b128 v[36:39], v1 offset:17408
	v_cvt_pk_bf16_f32 v175, v118, v119
	v_mfma_f32_16x16x32_bf16 v[148:151], v[40:43], a[76:79], v[148:151]
	buffer_load_dwordx4 a[164:167], v5, s[4:7], s86 offen offset:2048 sc1
	v_mfma_f32_16x16x32_bf16 v[152:155], v[44:47], a[72:75], v[152:155]
	ds_read_b128 v[40:43], v1 offset:18432
	s_waitcnt lgkmcnt(3)
	v_mfma_f32_16x16x32_bf16 v[156:159], v[44:47], a[76:79], v[156:159]
	buffer_store_dwordx4 v[172:175], v4, s[4:7], s77 offen offset:256 sc1
	v_mfma_f32_16x16x32_bf16 v[144:147], v[48:51], a[80:83], v[144:147]
	ds_read_b128 v[44:47], v1 offset:19456
	v_max_f32 v128, 0, v128
	v_mfma_f32_16x16x32_bf16 v[148:151], v[48:51], a[84:87], v[148:151]
	buffer_load_dwordx4 v1, s[4:7], s85 offen offset:3072 sc1 lds
	v_mfma_f32_16x16x32_bf16 v[152:155], v[52:55], a[80:83], v[152:155]
	ds_read_b128 v[48:51], v1 offset:20480
	s_add_u32 s86, s86, 4096
	v_mfma_f32_16x16x32_bf16 v[156:159], v[52:55], a[84:87], v[156:159]
	buffer_load_dwordx4 a[168:171], v5, s[4:7], s86 offen offset:0 sc1
	v_mfma_f32_16x16x32_bf16 v[144:147], v[56:59], a[88:91], v[144:147]
	ds_read_b128 v[52:55], v1 offset:21504
	v_max_f32 v129, 0, v129
	v_mfma_f32_16x16x32_bf16 v[148:151], v[56:59], a[92:95], v[148:151]
	v_max_f32 v130, 0, v130
	v_max_f32 v131, 0, v131
	v_mfma_f32_16x16x32_bf16 v[152:155], v[60:63], a[88:91], v[152:155]
	ds_read_b128 v[56:59], v1 offset:22528
	v_max_f32 v132, 0, v132
	v_mfma_f32_16x16x32_bf16 v[156:159], v[60:63], a[92:95], v[156:159]
	v_max_f32 v133, 0, v133
	s_waitcnt lgkmcnt(3)
	v_mfma_f32_16x16x32_bf16 v[144:147], v[32:35], a[96:99], v[144:147]
	ds_read_b128 v[60:63], v1 offset:23552
	v_max_f32 v134, 0, v134
	v_mfma_f32_16x16x32_bf16 v[148:151], v[32:35], a[100:103], v[148:151]
	buffer_load_dwordx4 a[172:175], v5, s[4:7], s86 offen offset:2048 sc1
	v_mfma_f32_16x16x32_bf16 v[152:155], v[36:39], a[96:99], v[152:155]
	ds_read_b128 v[32:35], v1 offset:24576
	v_max_f32 v135, 0, v135
	v_mfma_f32_16x16x32_bf16 v[156:159], v[36:39], a[100:103], v[156:159]
	v_mul_f32 v128, v128, v136
	v_mul_f32 v129, v129, v137
	v_mfma_f32_16x16x32_bf16 v[144:147], v[40:43], a[104:107], v[144:147]
	ds_read_b128 v[36:39], v1 offset:25600
	v_mul_f32 v130, v130, v138
	v_mfma_f32_16x16x32_bf16 v[148:151], v[40:43], a[108:111], v[148:151]
	v_mul_f32 v131, v131, v139
	v_mul_f32 v132, v132, v140
	v_mfma_f32_16x16x32_bf16 v[152:155], v[44:47], a[104:107], v[152:155]
	ds_read_b128 v[40:43], v1 offset:26624
	v_mul_f32 v133, v133, v141
	v_mfma_f32_16x16x32_bf16 v[156:159], v[44:47], a[108:111], v[156:159]
	v_mul_f32 v134, v134, v142
	s_waitcnt lgkmcnt(3)
	v_mfma_f32_16x16x32_bf16 v[144:147], v[48:51], a[112:115], v[144:147]
	ds_read_b128 v[44:47], v1 offset:27648
	v_mul_f32 v135, v135, v143
	v_mfma_f32_16x16x32_bf16 v[148:151], v[48:51], a[116:119], v[148:151]
	v_cvt_pk_bf16_f32 v176, v128, v129
	v_cvt_pk_bf16_f32 v177, v130, v131
	v_mfma_f32_16x16x32_bf16 v[152:155], v[52:55], a[112:115], v[152:155]
	ds_read_b128 v[48:51], v1 offset:28672
	v_cvt_pk_bf16_f32 v180, v132, v133
	v_mfma_f32_16x16x32_bf16 v[156:159], v[52:55], a[116:119], v[156:159]
	v_cvt_pk_bf16_f32 v181, v134, v135
	v_mfma_f32_16x16x32_bf16 v[144:147], v[56:59], a[120:123], v[144:147]
	ds_read_b128 v[52:55], v1 offset:29696
	s_barrier
	v_mfma_f32_16x16x32_bf16 v[148:151], v[56:59], a[124:127], v[148:151]
	s_add_u32 m0, s51, 114688
	s_add_u32 s85, s55, 131072
	v_mfma_f32_16x16x32_bf16 v[152:155], v[60:63], a[120:123], v[152:155]
	ds_read_b128 v[56:59], v1 offset:30720
	s_waitcnt lgkmcnt(3)
	v_mfma_f32_16x16x32_bf16 v[156:159], v[60:63], a[124:127], v[156:159]
	buffer_load_dwordx4 v1, s[4:7], s85 offen offset:0 sc1 lds
	v_mfma_f32_16x16x32_bf16 v[144:147], v[32:35], a[128:131], v[144:147]
	ds_read_b128 v[60:63], v1 offset:31744
	v_mfma_f32_16x16x32_bf16 v[148:151], v[32:35], a[132:135], v[148:151]
	v_mfma_f32_16x16x32_bf16 v[152:155], v[36:39], a[128:131], v[152:155]
	v_mfma_f32_16x16x32_bf16 v[156:159], v[36:39], a[132:135], v[156:159]
	buffer_load_dwordx4 v1, s[4:7], s85 offen offset:1024 sc1 lds
	v_mfma_f32_16x16x32_bf16 v[144:147], v[40:43], a[136:139], v[144:147]
	v_mfma_f32_16x16x32_bf16 v[148:151], v[40:43], a[140:143], v[148:151]
	v_mfma_f32_16x16x32_bf16 v[152:155], v[44:47], a[136:139], v[152:155]
	s_waitcnt lgkmcnt(0)
	v_mfma_f32_16x16x32_bf16 v[156:159], v[44:47], a[140:143], v[156:159]
	buffer_load_dwordx4 v1, s[4:7], s85 offen offset:2048 sc1 lds
	v_mfma_f32_16x16x32_bf16 v[144:147], v[48:51], a[144:147], v[144:147]
	v_mfma_f32_16x16x32_bf16 v[148:151], v[48:51], a[148:151], v[148:151]
	v_mfma_f32_16x16x32_bf16 v[152:155], v[52:55], a[144:147], v[152:155]
	v_mfma_f32_16x16x32_bf16 v[156:159], v[52:55], a[148:151], v[156:159]
	buffer_load_dwordx4 v1, s[4:7], s85 offen offset:3072 sc1 lds
	v_mfma_f32_16x16x32_bf16 v[144:147], v[56:59], a[152:155], v[144:147]
	v_mfma_f32_16x16x32_bf16 v[148:151], v[56:59], a[156:159], v[148:151]
	v_mfma_f32_16x16x32_bf16 v[152:155], v[60:63], a[152:155], v[152:155]
	v_mfma_f32_16x16x32_bf16 v[156:159], v[60:63], a[156:159], v[156:159]
	v_mfma_f32_16x16x32_bf16 v[144:147], a[212:215], v[184:187], v[144:147]
	v_mfma_f32_16x16x32_bf16 v[148:151], a[212:215], v[188:191], v[148:151]
	v_mfma_f32_16x16x32_bf16 v[152:155], a[214:217], v[184:187], v[152:155]
	v_mfma_f32_16x16x32_bf16 v[156:159], a[214:217], v[188:191], v[156:159]
	s_nop 4
	v_max_f32 v144, 0, v144
	v_max_f32 v145, 0, v145
	v_max_f32 v146, 0, v146
	v_max_f32 v147, 0, v147
	v_max_f32 v148, 0, v148
	v_max_f32 v149, 0, v149
	v_max_f32 v150, 0, v150
	v_max_f32 v151, 0, v151
	v_mul_f32 v144, v144, v152
	v_mul_f32 v145, v145, v153
	v_mul_f32 v146, v146, v154
	v_mul_f32 v147, v147, v155
	v_mul_f32 v148, v148, v156
	v_mul_f32 v149, v149, v157
	v_mul_f32 v150, v150, v158
	v_mul_f32 v151, v151, v159
	v_cvt_pk_bf16_f32 v178, v144, v145
	v_cvt_pk_bf16_f32 v179, v146, v147
	buffer_store_dwordx4 v[176:179], v4, s[4:7], s77 offen offset:2048 sc1
	v_cvt_pk_bf16_f32 v182, v148, v149
	v_cvt_pk_bf16_f32 v183, v150, v151
	buffer_store_dwordx4 v[180:183], v4, s[4:7], s77 offen offset:2304 sc1
	s_cmp_eq_u32 s68, 1
	s_cselect_b32 s52, 1073741824, s52
	s_barrier
	s_add_u32 s86, s86, 4096
	buffer_load_dwordx4 a[0:3], v5, s[4:7], s86 offen offset:0 sc1
	buffer_load_dwordx4 a[4:7], v5, s[4:7], s86 offen offset:2048 sc1
	s_add_u32 s86, s86, 4096
	buffer_load_dwordx4 a[8:11], v5, s[4:7], s86 offen offset:0 sc1
	buffer_load_dwordx4 a[12:15], v5, s[4:7], s86 offen offset:2048 sc1
	s_add_u32 s86, s86, 4096
	buffer_load_dwordx4 a[16:19], v5, s[4:7], s86 offen offset:0 sc1
	buffer_load_dwordx4 a[20:23], v5, s[4:7], s86 offen offset:2048 sc1
	ds_read_b128 v[96:99], v1 offset:32768
	ds_read_b128 v[100:103], v1 offset:33792
	ds_read_b128 v[104:107], v1 offset:34816
	ds_read_b128 v[108:111], v1 offset:35840
	ds_read_b128 v[112:115], v1 offset:36864
	ds_read_b128 v[116:119], v1 offset:37888
	ds_read_b128 v[120:123], v1 offset:38912
	ds_read_b128 v[124:127], v1 offset:39936
	ds_read_b128 v[128:131], v1 offset:40960
	ds_read_b128 v[132:135], v1 offset:41984
	ds_read_b128 v[136:139], v1 offset:43008
	s_waitcnt vmcnt(18) lgkmcnt(7)
	v_mfma_f32_16x16x32_bf16 v[64:67], v[96:99], a[160:163], 0
	s_add_u32 m0, s51, 16384
	s_add_u32 s85, s55, 147456
	v_mfma_f32_16x16x32_bf16 v[68:71], v[100:103], a[160:163], 0
	s_add_u32 s86, s86, 4096
	buffer_load_dwordx4 a[24:27], v5, s[4:7], s86 offen offset:0 sc1
	v_mfma_f32_16x16x32_bf16 v[72:75], v[104:107], a[160:163], 0
	ds_read_b128 v[140:143], v1 offset:44032
	buffer_load_dwordx4 v1, s[4:7], s85 offen offset:0 sc1 lds
	v_mfma_f32_16x16x32_bf16 v[76:79], v[108:111], a[160:163], 0
	ds_read_b128 v[96:99], v1 offset:45056
	s_waitcnt lgkmcnt(5)
	v_mfma_f32_16x16x32_bf16 v[80:83], v[112:115], a[160:163], 0
	ds_read_b128 v[100:103], v1 offset:46080
	s_waitcnt vmcnt(18)
	v_mfma_f32_16x16x32_bf16 v[64:67], v[116:119], a[164:167], v[64:67]
	ds_read_b128 v[104:107], v1 offset:47104
	ds_read_b128 v[108:111], v1 offset:48128
	v_mfma_f32_16x16x32_bf16 v[68:71], v[120:123], a[164:167], v[68:71]
	buffer_load_dwordx4 a[28:31], v5, s[4:7], s86 offen offset:2048 sc1
	v_mfma_f32_16x16x32_bf16 v[72:75], v[124:127], a[164:167], v[72:75]
	ds_read_b128 v[112:115], v1 offset:49152
	buffer_load_dwordx4 v1, s[4:7], s85 offen offset:1024 sc1 lds
	s_waitcnt lgkmcnt(5)
	v_mfma_f32_16x16x32_bf16 v[76:79], v[128:131], a[164:167], v[76:79]
	ds_read_b128 v[116:119], v1 offset:50176
	ds_read_b128 v[120:123], v1 offset:51200
	v_mfma_f32_16x16x32_bf16 v[80:83], v[132:135], a[164:167], v[80:83]
	ds_read_b128 v[124:127], v1 offset:52224
	s_waitcnt vmcnt(17)
	v_mfma_f32_16x16x32_bf16 v[64:67], v[136:139], a[168:171], v[64:67]
	ds_read_b128 v[128:131], v1 offset:53248
	ds_read_b128 v[132:135], v1 offset:54272
	v_mfma_f32_16x16x32_bf16 v[68:71], v[140:143], a[168:171], v[68:71]
	s_add_u32 s86, s86, 4096
	buffer_load_dwordx4 a[32:35], v5, s[4:7], s86 offen offset:0 sc1
	s_waitcnt lgkmcnt(6)
	v_mfma_f32_16x16x32_bf16 v[72:75], v[96:99], a[168:171], v[72:75]
	buffer_load_dwordx4 v1, s[4:7], s85 offen offset:2048 sc1 lds
	v_mfma_f32_16x16x32_bf16 v[76:79], v[100:103], a[168:171], v[76:79]
	ds_read_b128 v[136:139], v1 offset:55296
	ds_read_b128 v[140:143], v1 offset:56320
	v_mfma_f32_16x16x32_bf16 v[80:83], v[104:107], a[168:171], v[80:83]
	ds_read_b128 v[96:99], v1 offset:57344
	s_waitcnt vmcnt(18)
	v_mfma_f32_16x16x32_bf16 v[64:67], v[108:111], a[172:175], v[64:67]
	ds_read_b128 v[100:103], v1 offset:58368
	s_waitcnt lgkmcnt(6)
	v_mfma_f32_16x16x32_bf16 v[68:71], v[112:115], a[172:175], v[68:71]
	ds_read_b128 v[104:107], v1 offset:59392
	s_lshl_b32 s72, s46, 2
	s_add_u32 s72, s72, s66
	s_add_u32 s72, s72, 6144
	s_waitcnt vmcnt(12)
	s_barrier
	s_cmp_lg_u32 s44, 0
	s_cbranch_scc1 Lw0_36
	s_mov_b64 exec, 1
	s_cmp_eq_u32 s99, 0
	s_cbranch_scc1 Lfl_37
	buffer_atomic_swap v244, off, s[4:7], s72 sc1
	s_branch Lfl_37e
Lfl_37:
	buffer_store_dword v244, off, s[4:7], s72
Lfl_37e:
	s_mov_b64 exec, -1
Lw0_36:
	v_mfma_f32_16x16x32_bf16 v[72:75], v[116:119], a[172:175], v[72:75]
	buffer_load_dwordx4 a[36:39], v5, s[4:7], s86 offen offset:2048 sc1
	v_mfma_f32_16x16x32_bf16 v[76:79], v[120:123], a[172:175], v[76:79]
	ds_read_b128 v[108:111], v1 offset:60416
	buffer_load_dwordx4 v1, s[4:7], s85 offen offset:3072 sc1 lds
	v_mfma_f32_16x16x32_bf16 v[80:83], v[124:127], a[172:175], v[80:83]
	ds_read_b128 v[112:115], v1 offset:61440
	s_waitcnt vmcnt(13) lgkmcnt(5)
	v_mfma_f32_16x16x32_bf16 v[64:67], v[128:131], a[0:3], v[64:67]
	ds_read_b128 v[116:119], v1 offset:62464
	ds_read_b128 v[120:123], v1 offset:63488
	v_mfma_f32_16x16x32_bf16 v[68:71], v[132:135], a[0:3], v[68:71]
	s_add_u32 s86, s86, 4096
	buffer_load_dwordx4 a[40:43], v5, s[4:7], s86 offen offset:0 sc1
	v_mfma_f32_16x16x32_bf16 v[72:75], v[136:139], a[0:3], v[72:75]
	ds_read_b128 v[124:127], v1 offset:64512
	ds_read_b128 v[128:131], v2 offset:0
	v_mfma_f32_16x16x32_bf16 v[76:79], v[140:143], a[0:3], v[76:79]
	ds_read_b128 v[132:135], v2 offset:1024
	s_waitcnt lgkmcnt(6)
	v_mfma_f32_16x16x32_bf16 v[80:83], v[96:99], a[0:3], v[80:83]
	ds_read_b128 v[136:139], v2 offset:2048
	s_waitcnt vmcnt(13)
	v_mfma_f32_16x16x32_bf16 v[64:67], v[100:103], a[4:7], v[64:67]
	ds_read_b128 v[140:143], v2 offset:3072
	ds_read_b128 v[96:99], v2 offset:4096
	v_mfma_f32_16x16x32_bf16 v[68:71], v[104:107], a[4:7], v[68:71]
	buffer_load_dwordx4 a[44:47], v5, s[4:7], s86 offen offset:2048 sc1
	v_mfma_f32_16x16x32_bf16 v[72:75], v[108:111], a[4:7], v[72:75]
	s_add_u32 m0, s51, 32768
	s_add_u32 s85, s55, 163840
	s_waitcnt lgkmcnt(5)
	v_mfma_f32_16x16x32_bf16 v[76:79], v[112:115], a[4:7], v[76:79]
	ds_read_b128 v[100:103], v2 offset:5120
	buffer_load_dwordx4 v1, s[4:7], s85 offen offset:0 sc1 lds
	v_mfma_f32_16x16x32_bf16 v[80:83], v[116:119], a[4:7], v[80:83]
	ds_read_b128 v[104:107], v2 offset:6144
	s_waitcnt vmcnt(14)
	v_mfma_f32_16x16x32_bf16 v[64:67], v[120:123], a[8:11], v[64:67]
	ds_read_b128 v[108:111], v2 offset:7168
	ds_read_b128 v[112:115], v2 offset:8192
	v_mfma_f32_16x16x32_bf16 v[68:71], v[124:127], a[8:11], v[68:71]
	ds_read_b128 v[116:119], v2 offset:9216
	s_waitcnt lgkmcnt(6)
	v_mfma_f32_16x16x32_bf16 v[72:75], v[128:131], a[8:11], v[72:75]
	ds_read_b128 v[120:123], v2 offset:10240
	s_add_u32 s71, s66, 6144
	buffer_load_dword v250, v247, s[4:7], s71 offen sc1
	v_mfma_f32_16x16x32_bf16 v[76:79], v[132:135], a[8:11], v[76:79]
	buffer_load_dwordx4 v1, s[4:7], s85 offen offset:1024 sc1 lds
	v_mfma_f32_16x16x32_bf16 v[80:83], v[136:139], a[8:11], v[80:83]
	ds_read_b128 v[124:127], v2 offset:11264
	s_waitcnt vmcnt(15)
	v_mfma_f32_16x16x32_bf16 v[64:67], v[140:143], a[12:15], v[64:67]
	ds_read_b128 v[128:131], v2 offset:12288
	s_waitcnt lgkmcnt(5)
	v_mfma_f32_16x16x32_bf16 v[68:71], v[96:99], a[12:15], v[68:71]
	ds_read_b128 v[132:135], v2 offset:13312
	ds_read_b128 v[136:139], v2 offset:14336
	v_mfma_f32_16x16x32_bf16 v[72:75], v[100:103], a[12:15], v[72:75]
	buffer_load_dwordx4 v1, s[4:7], s85 offen offset:2048 sc1 lds
	v_mfma_f32_16x16x32_bf16 v[76:79], v[104:107], a[12:15], v[76:79]
	ds_read_b128 v[140:143], v2 offset:15360
	ds_read_b128 v[96:99], v245 offset:0
	v_mfma_f32_16x16x32_bf16 v[80:83], v[108:111], a[12:15], v[80:83]
	ds_read_b128 v[100:103], v245 offset:1024
	s_waitcnt vmcnt(15) lgkmcnt(6)
	v_mfma_f32_16x16x32_bf16 v[64:67], v[112:115], a[16:19], v[64:67]
	ds_read_b128 v[104:107], v245 offset:2048
	ds_read_b128 v[108:111], v245 offset:3072
	v_mfma_f32_16x16x32_bf16 v[68:71], v[116:119], a[16:19], v[68:71]
	buffer_load_dwordx4 v1, s[4:7], s85 offen offset:3072 sc1 lds
	v_mfma_f32_16x16x32_bf16 v[72:75], v[120:123], a[16:19], v[72:75]
	ds_read_b128 v[112:115], v245 offset:4096
	ds_read_b128 v[116:119], v245 offset:5120
	v_mfma_f32_16x16x32_bf16 v[76:79], v[124:127], a[16:19], v[76:79]
	ds_read_b128 v[120:123], v245 offset:6144
	s_waitcnt lgkmcnt(7)
	v_mfma_f32_16x16x32_bf16 v[80:83], v[128:131], a[16:19], v[80:83]
	ds_read_b128 v[124:127], v245 offset:7168
	s_waitcnt vmcnt(15)
	v_mfma_f32_16x16x32_bf16 v[64:67], v[132:135], a[20:23], v[64:67]
	s_barrier
	s_add_u32 m0, s51, 49152
	s_add_u32 s85, s55, 180224
	v_mfma_f32_16x16x32_bf16 v[68:71], v[136:139], a[20:23], v[68:71]
	buffer_load_dwordx4 v1, s[4:7], s85 offen offset:0 sc1 lds
	v_mfma_f32_16x16x32_bf16 v[72:75], v[140:143], a[20:23], v[72:75]
	ds_read_b128 v[128:131], v245 offset:8192
	s_waitcnt lgkmcnt(5)
	v_mfma_f32_16x16x32_bf16 v[76:79], v[96:99], a[20:23], v[76:79]
	ds_read_b128 v[132:135], v245 offset:9216
	s_waitcnt vmcnt(4)
	v_cmp_ne_u32 vcc, s70, v250
	s_nop 0
	s_and_b32 s72, vcc_lo, 0xffff
	s_cbranch_scc1 Lslow_38
Lslow_38r:
	v_mfma_f32_16x16x32_bf16 v[80:83], v[100:103], a[20:23], v[80:83]
	ds_read_b128 v[136:139], v245 offset:10240
	s_add_u32 s86, s86, 4096
	buffer_load_dwordx4 a[48:51], v5, s[4:7], s86 offen offset:0 sc1
	v_mfma_f32_16x16x32_bf16 v[64:67], v[104:107], a[24:27], v[64:67]
	ds_read_b128 v[140:143], v245 offset:11264
	buffer_load_dwordx4 v1, s[4:7], s85 offen offset:1024 sc1 lds
	v_mfma_f32_16x16x32_bf16 v[68:71], v[108:111], a[24:27], v[68:71]
	ds_read_b128 v[96:99], v245 offset:12288
	s_waitcnt lgkmcnt(5)
	v_mfma_f32_16x16x32_bf16 v[72:75], v[112:115], a[24:27], v[72:75]
	ds_read_b128 v[100:103], v245 offset:13312
	buffer_load_dwordx4 a[52:55], v5, s[4:7], s86 offen offset:2048 sc1
	v_mfma_f32_16x16x32_bf16 v[76:79], v[116:119], a[24:27], v[76:79]
	ds_read_b128 v[104:107], v245 offset:14336
	ds_read_b128 v[108:111], v245 offset:15360
	v_mfma_f32_16x16x32_bf16 v[80:83], v[120:123], a[24:27], v[80:83]
	buffer_load_dwordx4 v1, s[4:7], s85 offen offset:2048 sc1 lds
	v_mfma_f32_16x16x32_bf16 v[64:67], v[124:127], a[28:31], v[64:67]
	ds_read_b128 v[112:115], v1 offset:0
	s_add_u32 s86, s86, 4096
	buffer_load_dwordx4 a[56:59], v5, s[4:7], s86 offen offset:0 sc1
	s_waitcnt lgkmcnt(5)
	v_mfma_f32_16x16x32_bf16 v[68:71], v[128:131], a[28:31], v[68:71]
	ds_read_b128 v[116:119], v1 offset:1024
	ds_read_b128 v[120:123], v1 offset:2048
	v_mfma_f32_16x16x32_bf16 v[72:75], v[132:135], a[28:31], v[72:75]
	ds_read_b128 v[124:127], v1 offset:3072
	ds_read_b128 v[128:131], v1 offset:4096
	v_mfma_f32_16x16x32_bf16 v[76:79], v[136:139], a[28:31], v[76:79]
	buffer_load_dwordx4 a[60:63], v5, s[4:7], s86 offen offset:2048 sc1
	v_mfma_f32_16x16x32_bf16 v[80:83], v[140:143], a[28:31], v[80:83]
	buffer_load_dwordx4 v1, s[4:7], s85 offen offset:3072 sc1 lds
	s_waitcnt lgkmcnt(5)
	v_mfma_f32_16x16x32_bf16 v[64:67], v[96:99], a[32:35], v[64:67]
	ds_read_b128 v[132:135], v1 offset:5120
	ds_read_b128 v[136:139], v1 offset:6144
	v_mfma_f32_16x16x32_bf16 v[68:71], v[100:103], a[32:35], v[68:71]
	s_add_u32 s86, s86, 4096
	buffer_load_dwordx4 a[64:67], v5, s[4:7], s86 offen offset:0 sc1
	v_mfma_f32_16x16x32_bf16 v[72:75], v[104:107], a[32:35], v[72:75]
	ds_read_b128 v[140:143], v1 offset:7168
	ds_read_b128 v[96:99], v1 offset:8192
	v_mfma_f32_16x16x32_bf16 v[76:79], v[108:111], a[32:35], v[76:79]
	s_add_u32 m0, s51, 65536
	s_add_u32 s85, s55, 196608
	s_waitcnt lgkmcnt(5)
	v_mfma_f32_16x16x32_bf16 v[80:83], v[112:115], a[32:35], v[80:83]
	ds_read_b128 v[100:103], v1 offset:9216
	buffer_load_dwordx4 a[68:71], v5, s[4:7], s86 offen offset:2048 sc1
	v_mfma_f32_16x16x32_bf16 v[64:67], v[116:119], a[36:39], v[64:67]
	ds_read_b128 v[104:107], v1 offset:10240
	buffer_load_dwordx4 v1, s[4:7], s85 offen offset:0 sc1 lds
	v_mfma_f32_16x16x32_bf16 v[68:71], v[120:123], a[36:39], v[68:71]
	ds_read_b128 v[108:111], v1 offset:11264
	ds_read_b128 v[112:115], v1 offset:12288
	v_mfma_f32_16x16x32_bf16 v[72:75], v[124:127], a[36:39], v[72:75]
	s_add_u32 s86, s86, 4096
	buffer_load_dwordx4 a[72:75], v5, s[4:7], s86 offen offset:0 sc1
	s_waitcnt lgkmcnt(5)
	v_mfma_f32_16x16x32_bf16 v[76:79], v[128:131], a[36:39], v[76:79]
	ds_read_b128 v[116:119], v1 offset:13312
	ds_read_b128 v[120:123], v1 offset:14336
	v_mfma_f32_16x16x32_bf16 v[80:83], v[132:135], a[36:39], v[80:83]
	buffer_load_dwordx4 v1, s[4:7], s85 offen offset:1024 sc1 lds
	v_mfma_f32_16x16x32_bf16 v[64:67], v[136:139], a[40:43], v[64:67]
	ds_read_b128 v[124:127], v1 offset:15360
	buffer_load_dwordx4 a[76:79], v5, s[4:7], s86 offen offset:2048 sc1
	v_mfma_f32_16x16x32_bf16 v[68:71], v[140:143], a[40:43], v[68:71]
	ds_read_b128 v[128:131], v245 offset:16384
	s_waitcnt lgkmcnt(5)
	v_mfma_f32_16x16x32_bf16 v[72:75], v[96:99], a[40:43], v[72:75]
	ds_read_b128 v[132:135], v245 offset:17408
	ds_read_b128 v[136:139], v245 offset:18432
	v_mfma_f32_16x16x32_bf16 v[76:79], v[100:103], a[40:43], v[76:79]
	s_add_u32 s86, s86, 4096
	buffer_load_dwordx4 a[80:83], v5, s[4:7], s86 offen offset:0 sc1
	v_mfma_f32_16x16x32_bf16 v[80:83], v[104:107], a[40:43], v[80:83]
	ds_read_b128 v[140:143], v245 offset:19456
	buffer_load_dwordx4 v1, s[4:7], s85 offen offset:2048 sc1 lds
	v_mfma_f32_16x16x32_bf16 v[64:67], v[108:111], a[44:47], v[64:67]
	ds_read_b128 v[96:99], v245 offset:20480
	s_waitcnt lgkmcnt(5)
	v_mfma_f32_16x16x32_bf16 v[68:71], v[112:115], a[44:47], v[68:71]
	ds_read_b128 v[100:103], v245 offset:21504
	buffer_load_dwordx4 a[84:87], v5, s[4:7], s86 offen offset:2048 sc1
	v_mfma_f32_16x16x32_bf16 v[72:75], v[116:119], a[44:47], v[72:75]
	ds_read_b128 v[104:107], v245 offset:22528
	ds_read_b128 v[108:111], v245 offset:23552
	v_mfma_f32_16x16x32_bf16 v[76:79], v[120:123], a[44:47], v[76:79]
	buffer_load_dwordx4 v1, s[4:7], s85 offen offset:3072 sc1 lds
	v_mfma_f32_16x16x32_bf16 v[80:83], v[124:127], a[44:47], v[80:83]
	ds_read_b128 v[112:115], v245 offset:24576
	s_waitcnt vmcnt(16) lgkmcnt(5)
	v_mfma_f32_16x16x32_bf16 v[64:67], v[128:131], a[48:51], v[64:67]
	ds_read_b128 v[116:119], v245 offset:25600
	ds_read_b128 v[120:123], v245 offset:26624
	v_mfma_f32_16x16x32_bf16 v[68:71], v[132:135], a[48:51], v[68:71]
	s_add_u32 s86, s86, 4096
	buffer_load_dwordx4 a[88:91], v5, s[4:7], s86 offen offset:0 sc1
	v_mfma_f32_16x16x32_bf16 v[72:75], v[136:139], a[48:51], v[72:75]
	s_barrier
	ds_read_b128 v[124:127], v245 offset:27648
	s_add_u32 m0, s51, 131072
	s_add_u32 s85, s55, 212992
	v_mfma_f32_16x16x32_bf16 v[76:79], v[140:143], a[48:51], v[76:79]
	ds_read_b128 v[128:131], v245 offset:28672
	buffer_load_dwordx4 v1, s[4:7], s85 offen offset:0 sc1 lds
	s_waitcnt lgkmcnt(5)
	v_mfma_f32_16x16x32_bf16 v[80:83], v[96:99], a[48:51], v[80:83]
	ds_read_b128 v[132:135], v245 offset:29696
	s_waitcnt vmcnt(16)
	v_mfma_f32_16x16x32_bf16 v[64:67], v[100:103], a[52:55], v[64:67]
	ds_read_b128 v[136:139], v245 offset:30720
	ds_read_b128 v[140:143], v245 offset:31744
	v_mfma_f32_16x16x32_bf16 v[68:71], v[104:107], a[52:55], v[68:71]
	buffer_load_dwordx4 a[92:95], v5, s[4:7], s86 offen offset:2048 sc1
	v_mfma_f32_16x16x32_bf16 v[72:75], v[108:111], a[52:55], v[72:75]
	ds_read_b128 v[96:99], v2 offset:16384
	buffer_load_dwordx4 v1, s[4:7], s85 offen offset:1024 sc1 lds
	s_waitcnt lgkmcnt(5)
	v_mfma_f32_16x16x32_bf16 v[76:79], v[112:115], a[52:55], v[76:79]
	ds_read_b128 v[100:103], v2 offset:17408
	ds_read_b128 v[104:107], v2 offset:18432
	v_mfma_f32_16x16x32_bf16 v[80:83], v[116:119], a[52:55], v[80:83]
	ds_read_b128 v[108:111], v2 offset:19456
	s_waitcnt vmcnt(16)
	v_mfma_f32_16x16x32_bf16 v[64:67], v[120:123], a[56:59], v[64:67]
	ds_read_b128 v[112:115], v2 offset:20480
	ds_read_b128 v[116:119], v2 offset:21504
	v_mfma_f32_16x16x32_bf16 v[68:71], v[124:127], a[56:59], v[68:71]
	s_add_u32 s86, s86, 4096
	buffer_load_dwordx4 a[96:99], v5, s[4:7], s86 offen offset:0 sc1
	s_waitcnt lgkmcnt(6)
	v_mfma_f32_16x16x32_bf16 v[72:75], v[128:131], a[56:59], v[72:75]
	buffer_load_dwordx4 v1, s[4:7], s85 offen offset:2048 sc1 lds
	v_mfma_f32_16x16x32_bf16 v[76:79], v[132:135], a[56:59], v[76:79]
	ds_read_b128 v[120:123], v2 offset:22528
	ds_read_b128 v[124:127], v2 offset:23552
	v_mfma_f32_16x16x32_bf16 v[80:83], v[136:139], a[56:59], v[80:83]
	ds_read_b128 v[128:131], v2 offset:24576
	s_waitcnt vmcnt(17)
	v_mfma_f32_16x16x32_bf16 v[64:67], v[140:143], a[60:63], v[64:67]
	ds_read_b128 v[132:135], v2 offset:25600
	s_waitcnt lgkmcnt(6)
	v_mfma_f32_16x16x32_bf16 v[68:71], v[96:99], a[60:63], v[68:71]
	buffer_load_dwordx4 a[100:103], v5, s[4:7], s86 offen offset:2048 sc1
	v_mfma_f32_16x16x32_bf16 v[72:75], v[100:103], a[60:63], v[72:75]
	ds_read_b128 v[136:139], v2 offset:26624
	buffer_load_dwordx4 v1, s[4:7], s85 offen offset:3072 sc1 lds
	v_mfma_f32_16x16x32_bf16 v[76:79], v[104:107], a[60:63], v[76:79]
	ds_read_b128 v[140:143], v2 offset:27648
	ds_read_b128 v[96:99], v2 offset:28672
	v_mfma_f32_16x16x32_bf16 v[80:83], v[108:111], a[60:63], v[80:83]
	ds_read_b128 v[100:103], v2 offset:29696
	s_waitcnt vmcnt(17) lgkmcnt(6)
	v_mfma_f32_16x16x32_bf16 v[64:67], v[112:115], a[64:67], v[64:67]
	ds_read_b128 v[104:107], v2 offset:30720
	ds_read_b128 v[108:111], v2 offset:31744
	v_mfma_f32_16x16x32_bf16 v[68:71], v[116:119], a[64:67], v[68:71]
	s_add_u32 s86, s86, 4096
	buffer_load_dwordx4 a[104:107], v5, s[4:7], s86 offen offset:0 sc1
	v_mfma_f32_16x16x32_bf16 v[72:75], v[120:123], a[64:67], v[72:75]
	s_barrier
	s_add_u32 m0, s51, 147456
	s_add_u32 s85, s55, 229376
	v_mfma_f32_16x16x32_bf16 v[76:79], v[124:127], a[64:67], v[76:79]
	ds_read_b128 v[112:115], v2 offset:32768
	buffer_load_dwordx4 v1, s[4:7], s85 offen offset:0 sc1 lds
	s_waitcnt lgkmcnt(5)
	v_mfma_f32_16x16x32_bf16 v[80:83], v[128:131], a[64:67], v[80:83]
	ds_read_b128 v[116:119], v2 offset:33792
	s_waitcnt vmcnt(18)
	v_mfma_f32_16x16x32_bf16 v[64:67], v[132:135], a[68:71], v[64:67]
	ds_read_b128 v[120:123], v2 offset:34816
	ds_read_b128 v[124:127], v2 offset:35840
	v_mfma_f32_16x16x32_bf16 v[68:71], v[136:139], a[68:71], v[68:71]
	buffer_load_dwordx4 a[108:111], v5, s[4:7], s86 offen offset:2048 sc1
	v_mfma_f32_16x16x32_bf16 v[72:75], v[140:143], a[68:71], v[72:75]
	ds_read_b128 v[128:131], v2 offset:36864
	buffer_load_dwordx4 v1, s[4:7], s85 offen offset:1024 sc1 lds
	s_waitcnt lgkmcnt(5)
	v_mfma_f32_16x16x32_bf16 v[76:79], v[96:99], a[68:71], v[76:79]
	ds_read_b128 v[132:135], v2 offset:37888
	ds_read_b128 v[136:139], v2 offset:38912
	v_mfma_f32_16x16x32_bf16 v[80:83], v[100:103], a[68:71], v[80:83]
	ds_read_b128 v[140:143], v2 offset:39936
	s_waitcnt vmcnt(18)
	v_mfma_f32_16x16x32_bf16 v[64:67], v[104:107], a[72:75], v[64:67]
	ds_read_b128 v[96:99], v2 offset:40960
	ds_read_b128 v[100:103], v2 offset:41984
	v_mfma_f32_16x16x32_bf16 v[68:71], v[108:111], a[72:75], v[68:71]
	s_add_u32 s86, s86, 4096
	buffer_load_dwordx4 a[112:115], v5, s[4:7], s86 offen offset:0 sc1
	s_waitcnt lgkmcnt(6)
	v_mfma_f32_16x16x32_bf16 v[72:75], v[112:115], a[72:75], v[72:75]
	buffer_load_dwordx4 v1, s[4:7], s85 offen offset:2048 sc1 lds
	v_mfma_f32_16x16x32_bf16 v[76:79], v[116:119], a[72:75], v[76:79]
	ds_read_b128 v[104:107], v2 offset:43008
	ds_read_b128 v[108:111], v2 offset:44032
	v_mfma_f32_16x16x32_bf16 v[80:83], v[120:123], a[72:75], v[80:83]
	ds_read_b128 v[112:115], v2 offset:45056
	s_waitcnt vmcnt(18)
	v_mfma_f32_16x16x32_bf16 v[64:67], v[124:127], a[76:79], v[64:67]
	ds_read_b128 v[116:119], v2 offset:46080
	s_waitcnt lgkmcnt(6)
	v_mfma_f32_16x16x32_bf16 v[68:71], v[128:131], a[76:79], v[68:71]
	buffer_load_dwordx4 a[116:119], v5, s[4:7], s86 offen offset:2048 sc1
	v_mfma_f32_16x16x32_bf16 v[72:75], v[132:135], a[76:79], v[72:75]
	ds_read_b128 v[120:123], v2 offset:47104
	buffer_load_dwordx4 v1, s[4:7], s85 offen offset:3072 sc1 lds
	v_mfma_f32_16x16x32_bf16 v[76:79], v[136:139], a[76:79], v[76:79]
	ds_read_b128 v[124:127], v2 offset:48128
	ds_read_b128 v[128:131], v2 offset:49152
	v_mfma_f32_16x16x32_bf16 v[80:83], v[140:143], a[76:79], v[80:83]
	ds_read_b128 v[132:135], v2 offset:50176
	s_waitcnt vmcnt(19) lgkmcnt(6)
	v_mfma_f32_16x16x32_bf16 v[64:67], v[96:99], a[80:83], v[64:67]
	ds_read_b128 v[136:139], v2 offset:51200
	ds_read_b128 v[140:143], v2 offset:52224
	v_mfma_f32_16x16x32_bf16 v[68:71], v[100:103], a[80:83], v[68:71]
	s_add_u32 s86, s86, 4096
	buffer_load_dwordx4 a[120:123], v5, s[4:7], s86 offen offset:0 sc1
	v_mfma_f32_16x16x32_bf16 v[72:75], v[104:107], a[80:83], v[72:75]
	ds_read_b128 v[96:99], v2 offset:53248
	ds_read_b128 v[100:103], v2 offset:54272
	v_mfma_f32_16x16x32_bf16 v[76:79], v[108:111], a[80:83], v[76:79]
	ds_read_b128 v[104:107], v2 offset:55296
	s_waitcnt lgkmcnt(7)
	v_mfma_f32_16x16x32_bf16 v[80:83], v[112:115], a[80:83], v[80:83]
	ds_read_b128 v[108:111], v2 offset:56320
	s_waitcnt vmcnt(18)
	v_mfma_f32_16x16x32_bf16 v[64:67], v[116:119], a[84:87], v[64:67]
	ds_read_b128 v[112:115], v2 offset:57344
	v_mfma_f32_16x16x32_bf16 v[68:71], v[120:123], a[84:87], v[68:71]
	buffer_load_dwordx4 a[124:127], v5, s[4:7], s86 offen offset:2048 sc1
	v_mfma_f32_16x16x32_bf16 v[72:75], v[124:127], a[84:87], v[72:75]
	ds_read_b128 v[116:119], v2 offset:58368
	s_waitcnt lgkmcnt(6)
	v_mfma_f32_16x16x32_bf16 v[76:79], v[128:131], a[84:87], v[76:79]
	ds_read_b128 v[120:123], v2 offset:59392
	ds_read_b128 v[124:127], v2 offset:60416
	v_mfma_f32_16x16x32_bf16 v[80:83], v[132:135], a[84:87], v[80:83]
	ds_read_b128 v[128:131], v2 offset:61440
	s_waitcnt vmcnt(17)
	v_mfma_f32_16x16x32_bf16 v[64:67], v[136:139], a[88:91], v[64:67]
	ds_read_b128 v[132:135], v2 offset:62464
	v_mfma_f32_16x16x32_bf16 v[68:71], v[140:143], a[88:91], v[68:71]
	s_add_u32 s86, s86, 4096
	buffer_load_dwordx4 a[128:131], v5, s[4:7], s86 offen offset:0 sc1
	s_waitcnt lgkmcnt(6)
	v_mfma_f32_16x16x32_bf16 v[72:75], v[96:99], a[88:91], v[72:75]
	ds_read_b128 v[136:139], v2 offset:63488
	ds_read_b128 v[140:143], v2 offset:64512
	v_mfma_f32_16x16x32_bf16 v[76:79], v[100:103], a[88:91], v[76:79]
	ds_read_b128 v[96:99], v1 offset:16384
	v_mfma_f32_16x16x32_bf16 v[80:83], v[104:107], a[88:91], v[80:83]
	ds_read_b128 v[100:103], v1 offset:17408
	s_waitcnt vmcnt(16)
	v_mfma_f32_16x16x32_bf16 v[64:67], v[108:111], a[92:95], v[64:67]
	ds_read_b128 v[104:107], v1 offset:18432
	s_waitcnt lgkmcnt(7)
	v_mfma_f32_16x16x32_bf16 v[68:71], v[112:115], a[92:95], v[68:71]
	buffer_load_dwordx4 a[132:135], v5, s[4:7], s86 offen offset:2048 sc1
	v_mfma_f32_16x16x32_bf16 v[72:75], v[116:119], a[92:95], v[72:75]
	ds_read_b128 v[108:111], v1 offset:19456
	ds_read_b128 v[112:115], v1 offset:20480
	v_mfma_f32_16x16x32_bf16 v[76:79], v[120:123], a[92:95], v[76:79]
	ds_read_b128 v[116:119], v1 offset:21504
	v_mfma_f32_16x16x32_bf16 v[80:83], v[124:127], a[92:95], v[80:83]
	ds_read_b128 v[120:123], v1 offset:22528
	s_waitcnt vmcnt(15) lgkmcnt(7)
	v_mfma_f32_16x16x32_bf16 v[64:67], v[128:131], a[96:99], v[64:67]
	ds_read_b128 v[124:127], v1 offset:23552
	v_mfma_f32_16x16x32_bf16 v[68:71], v[132:135], a[96:99], v[68:71]
	s_add_u32 s86, s86, 4096
	buffer_load_dwordx4 a[136:139], v5, s[4:7], s86 offen offset:0 sc1
	v_mfma_f32_16x16x32_bf16 v[72:75], v[136:139], a[96:99], v[72:75]
	buffer_load_dwordx2 v[184:185], v0, s[4:7], s96 offen offset:0 sc1
	v_mfma_f32_16x16x32_bf16 v[76:79], v[140:143], a[96:99], v[76:79]
	ds_read_b128 v[128:131], v1 offset:24576
	s_waitcnt lgkmcnt(5)
	v_mfma_f32_16x16x32_bf16 v[80:83], v[96:99], a[96:99], v[80:83]
	ds_read_b128 v[132:135], v1 offset:25600
	s_waitcnt vmcnt(15)
	v_mfma_f32_16x16x32_bf16 v[64:67], v[100:103], a[100:103], v[64:67]
	ds_read_b128 v[136:139], v1 offset:26624
	ds_read_b128 v[140:143], v1 offset:27648
	v_mfma_f32_16x16x32_bf16 v[68:71], v[104:107], a[100:103], v[68:71]
	buffer_load_dwordx4 a[140:143], v5, s[4:7], s86 offen offset:2048 sc1
	v_mfma_f32_16x16x32_bf16 v[72:75], v[108:111], a[100:103], v[72:75]
	ds_read_b128 v[96:99], v1 offset:28672
	s_waitcnt lgkmcnt(5)
	v_mfma_f32_16x16x32_bf16 v[76:79], v[112:115], a[100:103], v[76:79]
	ds_read_b128 v[100:103], v1 offset:29696
	ds_read_b128 v[104:107], v1 offset:30720
	v_mfma_f32_16x16x32_bf16 v[80:83], v[116:119], a[100:103], v[80:83]
	ds_read_b128 v[108:111], v1 offset:31744
	s_waitcnt vmcnt(14)
	v_mfma_f32_16x16x32_bf16 v[64:67], v[120:123], a[104:107], v[64:67]
	ds_read_b128 v[112:115], v1 offset:32768
	ds_read_b128 v[116:119], v1 offset:33792
	v_mfma_f32_16x16x32_bf16 v[68:71], v[124:127], a[104:107], v[68:71]
	s_add_u32 s86, s86, 4096
	buffer_load_dwordx4 a[144:147], v5, s[4:7], s86 offen offset:0 sc1
	s_waitcnt lgkmcnt(6)
	v_mfma_f32_16x16x32_bf16 v[72:75], v[128:131], a[104:107], v[72:75]
	buffer_load_dwordx2 v[186:187], v0, s[4:7], s96 offen offset:256 sc1
	v_mfma_f32_16x16x32_bf16 v[76:79], v[132:135], a[104:107], v[76:79]
	ds_read_b128 v[120:123], v1 offset:34816
	ds_read_b128 v[124:127], v1 offset:35840
	v_mfma_f32_16x16x32_bf16 v[80:83], v[136:139], a[104:107], v[80:83]
	ds_read_b128 v[128:131], v1 offset:36864
	s_waitcnt vmcnt(14)
	v_mfma_f32_16x16x32_bf16 v[64:67], v[140:143], a[108:111], v[64:67]
	ds_read_b128 v[132:135], v1 offset:37888
	s_waitcnt lgkmcnt(6)
	v_mfma_f32_16x16x32_bf16 v[68:71], v[96:99], a[108:111], v[68:71]
	buffer_load_dwordx4 a[148:151], v5, s[4:7], s86 offen offset:2048 sc1
	v_mfma_f32_16x16x32_bf16 v[72:75], v[100:103], a[108:111], v[72:75]
	ds_read_b128 v[136:139], v1 offset:38912
	ds_read_b128 v[140:143], v1 offset:39936
	v_mfma_f32_16x16x32_bf16 v[76:79], v[104:107], a[108:111], v[76:79]
	ds_read_b128 v[96:99], v1 offset:40960
	ds_read_b128 v[100:103], v1 offset:41984
	v_mfma_f32_16x16x32_bf16 v[80:83], v[108:111], a[108:111], v[80:83]
	ds_read_b128 v[104:107], v1 offset:43008
	s_waitcnt vmcnt(13) lgkmcnt(7)
	v_mfma_f32_16x16x32_bf16 v[64:67], v[112:115], a[112:115], v[64:67]
	ds_read_b128 v[108:111], v1 offset:44032
	v_mfma_f32_16x16x32_bf16 v[68:71], v[116:119], a[112:115], v[68:71]
	s_add_u32 s86, s86, 4096
	buffer_load_dwordx4 a[152:155], v5, s[4:7], s86 offen offset:0 sc1
	v_mfma_f32_16x16x32_bf16 v[72:75], v[120:123], a[112:115], v[72:75]
	ds_read_b128 v[112:115], v1 offset:45056
	ds_read_b128 v[116:119], v1 offset:46080
	v_mfma_f32_16x16x32_bf16 v[76:79], v[124:127], a[112:115], v[76:79]
	ds_read_b128 v[120:123], v1 offset:47104
	s_waitcnt lgkmcnt(7)
	v_mfma_f32_16x16x32_bf16 v[80:83], v[128:131], a[112:115], v[80:83]
	ds_read_b128 v[124:127], v1 offset:48128
	s_waitcnt vmcnt(12)
	v_mfma_f32_16x16x32_bf16 v[64:67], v[132:135], a[116:119], v[64:67]
	ds_read_b128 v[128:131], v1 offset:49152
	v_mfma_f32_16x16x32_bf16 v[68:71], v[136:139], a[116:119], v[68:71]
	buffer_load_dwordx4 a[156:159], v5, s[4:7], s86 offen offset:2048 sc1
	v_mfma_f32_16x16x32_bf16 v[72:75], v[140:143], a[116:119], v[72:75]
	ds_read_b128 v[132:135], v1 offset:50176
	s_waitcnt lgkmcnt(6)
	v_mfma_f32_16x16x32_bf16 v[76:79], v[96:99], a[116:119], v[76:79]
	ds_read_b128 v[136:139], v1 offset:51200
	ds_read_b128 v[140:143], v1 offset:52224
	v_mfma_f32_16x16x32_bf16 v[80:83], v[100:103], a[116:119], v[80:83]
	ds_read_b128 v[96:99], v1 offset:53248
	s_waitcnt vmcnt(11)
	v_mfma_f32_16x16x32_bf16 v[64:67], v[104:107], a[120:123], v[64:67]
	ds_read_b128 v[100:103], v1 offset:54272
	v_mfma_f32_16x16x32_bf16 v[68:71], v[108:111], a[120:123], v[68:71]
	s_add_u32 s86, s86, 4096
	buffer_load_dwordx4 a[0:3], v5, s[4:7], s86 offen offset:0 sc1
	s_waitcnt lgkmcnt(6)
	v_mfma_f32_16x16x32_bf16 v[72:75], v[112:115], a[120:123], v[72:75]
	ds_read_b128 v[104:107], v1 offset:55296
	ds_read_b128 v[108:111], v1 offset:56320
	v_mfma_f32_16x16x32_bf16 v[76:79], v[116:119], a[120:123], v[76:79]
	ds_read_b128 v[112:115], v1 offset:57344
	v_mfma_f32_16x16x32_bf16 v[80:83], v[120:123], a[120:123], v[80:83]
	ds_read_b128 v[116:119], v1 offset:58368
	s_waitcnt vmcnt(11)
	v_mfma_f32_16x16x32_bf16 v[64:67], v[124:127], a[124:127], v[64:67]
	ds_read_b128 v[120:123], v1 offset:59392
	s_waitcnt lgkmcnt(7)
	v_mfma_f32_16x16x32_bf16 v[68:71], v[128:131], a[124:127], v[68:71]
	buffer_load_dwordx4 a[4:7], v5, s[4:7], s86 offen offset:2048 sc1
	v_mfma_f32_16x16x32_bf16 v[72:75], v[132:135], a[124:127], v[72:75]
	ds_read_b128 v[124:127], v1 offset:60416
	ds_read_b128 v[128:131], v1 offset:61440
	v_mfma_f32_16x16x32_bf16 v[76:79], v[136:139], a[124:127], v[76:79]
	ds_read_b128 v[132:135], v1 offset:62464
	v_mfma_f32_16x16x32_bf16 v[80:83], v[140:143], a[124:127], v[80:83]
	ds_read_b128 v[136:139], v1 offset:63488
	s_waitcnt vmcnt(11) lgkmcnt(7)
	v_mfma_f32_16x16x32_bf16 v[64:67], v[96:99], a[128:131], v[64:67]
	ds_read_b128 v[140:143], v1 offset:64512
	v_mfma_f32_16x16x32_bf16 v[68:71], v[100:103], a[128:131], v[68:71]
	s_add_u32 s86, s86, 4096
	buffer_load_dwordx4 a[8:11], v5, s[4:7], s86 offen offset:0 sc1
	v_mfma_f32_16x16x32_bf16 v[72:75], v[104:107], a[128:131], v[72:75]
	s_barrier
	ds_read_b128 v[96:99], v2 offset:0
	ds_read_b128 v[100:103], v2 offset:1024
	v_mfma_f32_16x16x32_bf16 v[76:79], v[108:111], a[128:131], v[76:79]
	ds_read_b128 v[104:107], v2 offset:2048
	s_waitcnt lgkmcnt(7)
	v_mfma_f32_16x16x32_bf16 v[80:83], v[112:115], a[128:131], v[80:83]
	ds_read_b128 v[108:111], v2 offset:3072
	s_waitcnt vmcnt(11)
	v_mfma_f32_16x16x32_bf16 v[64:67], v[116:119], a[132:135], v[64:67]
	ds_read_b128 v[112:115], v2 offset:4096
	v_mfma_f32_16x16x32_bf16 v[68:71], v[120:123], a[132:135], v[68:71]
	buffer_load_dwordx4 a[12:15], v5, s[4:7], s86 offen offset:2048 sc1
	v_mfma_f32_16x16x32_bf16 v[72:75], v[124:127], a[132:135], v[72:75]
	ds_read_b128 v[116:119], v2 offset:5120
	s_waitcnt lgkmcnt(6)
	v_mfma_f32_16x16x32_bf16 v[76:79], v[128:131], a[132:135], v[76:79]
	ds_read_b128 v[120:123], v2 offset:6144
	ds_read_b128 v[124:127], v2 offset:7168
	v_mfma_f32_16x16x32_bf16 v[80:83], v[132:135], a[132:135], v[80:83]
	ds_read_b128 v[128:131], v2 offset:8192
	s_waitcnt vmcnt(11)
	v_mfma_f32_16x16x32_bf16 v[64:67], v[136:139], a[136:139], v[64:67]
	ds_read_b128 v[132:135], v2 offset:9216
	v_mfma_f32_16x16x32_bf16 v[68:71], v[140:143], a[136:139], v[68:71]
	ds_read_b128 v[136:139], v2 offset:10240
	s_waitcnt lgkmcnt(7)
	v_mfma_f32_16x16x32_bf16 v[72:75], v[96:99], a[136:139], v[72:75]
	ds_read_b128 v[140:143], v2 offset:11264
	v_mfma_f32_16x16x32_bf16 v[76:79], v[100:103], a[136:139], v[76:79]
	ds_read_b128 v[96:99], v2 offset:12288
	v_mfma_f32_16x16x32_bf16 v[80:83], v[104:107], a[136:139], v[80:83]
	ds_read_b128 v[100:103], v2 offset:13312
	s_waitcnt vmcnt(9)
	v_mfma_f32_16x16x32_bf16 v[64:67], v[108:111], a[140:143], v[64:67]
	ds_read_b128 v[104:107], v2 offset:14336
	s_waitcnt lgkmcnt(7)
	v_mfma_f32_16x16x32_bf16 v[68:71], v[112:115], a[140:143], v[68:71]
	ds_read_b128 v[108:111], v2 offset:15360
	v_mfma_f32_16x16x32_bf16 v[72:75], v[116:119], a[140:143], v[72:75]
	ds_read_b128 v[112:115], v245 offset:0
	v_mfma_f32_16x16x32_bf16 v[76:79], v[120:123], a[140:143], v[76:79]
	ds_read_b128 v[116:119], v245 offset:1024
	v_mfma_f32_16x16x32_bf16 v[80:83], v[124:127], a[140:143], v[80:83]
	ds_read_b128 v[120:123], v245 offset:2048
	s_waitcnt vmcnt(8) lgkmcnt(7)
	v_mfma_f32_16x16x32_bf16 v[64:67], v[128:131], a[144:147], v[64:67]
	s_add_u32 m0, s51, 0
	s_add_u32 s85, s52, 0
	v_mfma_f32_16x16x32_bf16 v[68:71], v[132:135], a[144:147], v[68:71]
	buffer_load_dwordx4 v1, s[4:7], s85 offen offset:0 sc1 lds
	v_mfma_f32_16x16x32_bf16 v[72:75], v[136:139], a[144:147], v[72:75]
	ds_read_b128 v[124:127], v245 offset:3072
	ds_read_b128 v[128:131], v245 offset:4096
	v_mfma_f32_16x16x32_bf16 v[76:79], v[140:143], a[144:147], v[76:79]
	ds_read_b128 v[132:135], v245 offset:5120
	s_waitcnt lgkmcnt(6)
	v_mfma_f32_16x16x32_bf16 v[80:83], v[96:99], a[144:147], v[80:83]
	ds_read_b128 v[136:139], v245 offset:6144
	s_waitcnt vmcnt(7)
	v_mfma_f32_16x16x32_bf16 v[64:67], v[100:103], a[148:151], v[64:67]
	buffer_load_dwordx4 v1, s[4:7], s85 offen offset:1024 sc1 lds
	v_mfma_f32_16x16x32_bf16 v[68:71], v[104:107], a[148:151], v[68:71]
	ds_read_b128 v[140:143], v245 offset:7168
	ds_read_b128 v[96:99], v245 offset:8192
	v_mfma_f32_16x16x32_bf16 v[72:75], v[108:111], a[148:151], v[72:75]
	ds_read_b128 v[100:103], v245 offset:9216
	s_waitcnt lgkmcnt(6)
	v_mfma_f32_16x16x32_bf16 v[76:79], v[112:115], a[148:151], v[76:79]
	ds_read_b128 v[104:107], v245 offset:10240
	ds_read_b128 v[108:111], v245 offset:11264
	v_mfma_f32_16x16x32_bf16 v[80:83], v[116:119], a[148:151], v[80:83]
	buffer_load_dwordx4 v1, s[4:7], s85 offen offset:2048 sc1 lds
	s_waitcnt vmcnt(8)
	v_mfma_f32_16x16x32_bf16 v[64:67], v[120:123], a[152:155], v[64:67]
	ds_read_b128 v[112:115], v245 offset:12288
	ds_read_b128 v[116:119], v245 offset:13312
	v_mfma_f32_16x16x32_bf16 v[68:71], v[124:127], a[152:155], v[68:71]
	ds_read_b128 v[120:123], v245 offset:14336
	s_waitcnt lgkmcnt(7)
	v_mfma_f32_16x16x32_bf16 v[72:75], v[128:131], a[152:155], v[72:75]
	ds_read_b128 v[124:127], v245 offset:15360
	v_mfma_f32_16x16x32_bf16 v[76:79], v[132:135], a[152:155], v[76:79]
	buffer_load_dwordx4 v1, s[4:7], s85 offen offset:3072 sc1 lds
	v_mfma_f32_16x16x32_bf16 v[80:83], v[136:139], a[152:155], v[80:83]
	ds_read_b128 v[128:131], v245 offset:16384
	s_waitcnt vmcnt(8)
	v_mfma_f32_16x16x32_bf16 v[64:67], v[140:143], a[156:159], v[64:67]
	ds_read_b128 v[132:135], v245 offset:17408
	s_waitcnt lgkmcnt(6)
	v_mfma_f32_16x16x32_bf16 v[68:71], v[96:99], a[156:159], v[68:71]
	ds_read_b128 v[136:139], v245 offset:18432
	ds_read_b128 v[140:143], v245 offset:19456
	v_mfma_f32_16x16x32_bf16 v[72:75], v[100:103], a[156:159], v[72:75]
	s_add_u32 m0, s51, 16384
	s_add_u32 s85, s52, 16384
	v_mfma_f32_16x16x32_bf16 v[76:79], v[104:107], a[156:159], v[76:79]
	buffer_load_dwordx4 v1, s[4:7], s85 offen offset:0 sc1 lds
	v_mfma_f32_16x16x32_bf16 v[80:83], v[108:111], a[156:159], v[80:83]
	ds_read_b128 v[96:99], v245 offset:20480
	s_waitcnt vmcnt(8) lgkmcnt(5)
	v_mfma_f32_16x16x32_bf16 v[64:67], v[112:115], a[0:3], v[64:67]
	ds_read_b128 v[100:103], v245 offset:21504
	ds_read_b128 v[104:107], v245 offset:22528
	v_mfma_f32_16x16x32_bf16 v[68:71], v[116:119], a[0:3], v[68:71]
	ds_read_b128 v[108:111], v245 offset:23552
	ds_read_b128 v[112:115], v245 offset:24576
	v_mfma_f32_16x16x32_bf16 v[72:75], v[120:123], a[0:3], v[72:75]
	buffer_load_dwordx4 v1, s[4:7], s85 offen offset:1024 sc1 lds
	v_mfma_f32_16x16x32_bf16 v[76:79], v[124:127], a[0:3], v[76:79]
	ds_read_b128 v[116:119], v245 offset:25600
	s_waitcnt lgkmcnt(6)
	v_mfma_f32_16x16x32_bf16 v[80:83], v[128:131], a[0:3], v[80:83]
	ds_read_b128 v[120:123], v245 offset:26624
	s_waitcnt vmcnt(8)
	v_mfma_f32_16x16x32_bf16 v[64:67], v[132:135], a[4:7], v[64:67]
	ds_read_b128 v[124:127], v245 offset:27648
	ds_read_b128 v[128:131], v245 offset:28672
	v_mfma_f32_16x16x32_bf16 v[68:71], v[136:139], a[4:7], v[68:71]
	buffer_load_dwordx4 v1, s[4:7], s85 offen offset:2048 sc1 lds
	v_mfma_f32_16x16x32_bf16 v[72:75], v[140:143], a[4:7], v[72:75]
	ds_read_b128 v[132:135], v245 offset:29696
	s_waitcnt lgkmcnt(6)
	v_mfma_f32_16x16x32_bf16 v[76:79], v[96:99], a[4:7], v[76:79]
	ds_read_b128 v[136:139], v245 offset:30720
	ds_read_b128 v[140:143], v245 offset:31744
	v_mfma_f32_16x16x32_bf16 v[80:83], v[100:103], a[4:7], v[80:83]
	s_waitcnt vmcnt(8)
	v_mfma_f32_16x16x32_bf16 v[64:67], v[104:107], a[8:11], v[64:67]
	buffer_load_dwordx4 v1, s[4:7], s85 offen offset:3072 sc1 lds
	v_mfma_f32_16x16x32_bf16 v[68:71], v[108:111], a[8:11], v[68:71]
	s_waitcnt lgkmcnt(4)
	v_mfma_f32_16x16x32_bf16 v[72:75], v[112:115], a[8:11], v[72:75]
	v_mfma_f32_16x16x32_bf16 v[76:79], v[116:119], a[8:11], v[76:79]
	v_add_f32 v184, v184, v186
	v_mfma_f32_16x16x32_bf16 v[80:83], v[120:123], a[8:11], v[80:83]
	s_waitcnt vmcnt(8)
	v_mfma_f32_16x16x32_bf16 v[64:67], v[124:127], a[12:15], v[64:67]
	s_waitcnt lgkmcnt(0)
	v_mfma_f32_16x16x32_bf16 v[68:71], v[128:131], a[12:15], v[68:71]
	v_add_f32 v185, v185, v187
	v_mfma_f32_16x16x32_bf16 v[72:75], v[132:135], a[12:15], v[72:75]
	v_mfma_f32_16x16x32_bf16 v[76:79], v[136:139], a[12:15], v[76:79]
	v_mfma_f32_16x16x32_bf16 v[80:83], v[140:143], a[12:15], v[80:83]
	v_permlane32_swap_b32 v184, v185
	v_add_f32 v184, v184, v185
	v_mov_b32 v185, v184
	s_nop 1
	v_permlane16_swap_b32 v184, v185
	v_add_f32 v184, v184, v185
	v_mov_b32 v185, v184
	s_nop 1
	v_permlane32_swap_b32 v184, v185
	v_mul_f32 v184, 0x3acccccd, v184
	v_mul_f32 v185, 0x3acccccd, v185
	v_fma_f32 v185, -v184, v184, v185
	v_max_f32 v185, 0, v185
	v_add_f32 v185, 0x3727c5ac, v185
	v_rsq_f32 v228, v185
	s_nop 0
	v_mul_f32 v224, v228, v228
	v_pk_fma_f32 v[12:13], v[64:65], v[224:225], v[12:13] op_sel_hi:[1,0,1]
	v_pk_fma_f32 v[14:15], v[66:67], v[224:225], v[14:15] op_sel_hi:[1,0,1]
	v_pk_fma_f32 v[16:17], v[68:69], v[224:225], v[16:17] op_sel_hi:[1,0,1]
	v_pk_fma_f32 v[18:19], v[70:71], v[224:225], v[18:19] op_sel_hi:[1,0,1]
	v_pk_fma_f32 v[20:21], v[72:73], v[224:225], v[20:21] op_sel_hi:[1,0,1]
	v_pk_fma_f32 v[22:23], v[74:75], v[224:225], v[22:23] op_sel_hi:[1,0,1]
	v_pk_fma_f32 v[24:25], v[76:77], v[224:225], v[24:25] op_sel_hi:[1,0,1]
	v_pk_fma_f32 v[26:27], v[78:79], v[224:225], v[26:27] op_sel_hi:[1,0,1]
	v_pk_fma_f32 v[28:29], v[80:81], v[224:225], v[28:29] op_sel_hi:[1,0,1]
	v_pk_fma_f32 v[30:31], v[82:83], v[224:225], v[30:31] op_sel_hi:[1,0,1]
	s_cmp_eq_u32 s68, 1
	s_cbranch_scc1 L_final
	s_cmp_eq_u32 s99, 0
	s_cselect_b32 s73, 0, 15495168
	s_mov_b32 s74, 15495168
	s_cselect_b32 s74, 2621440, s74
	s_add_u32 s75, s73, 15204352
	v_cvt_pk_bf16_f32 v128, v12, v13
	v_cvt_pk_bf16_f32 v129, v14, v15
	v_cvt_pk_bf16_f32 v130, v16, v17
	v_cvt_pk_bf16_f32 v131, v18, v19
	v_cvt_pk_bf16_f32 v132, v20, v21
	v_cvt_pk_bf16_f32 v133, v22, v23
	v_cvt_pk_bf16_f32 v134, v24, v25
	v_cvt_pk_bf16_f32 v135, v26, v27
	v_cvt_pk_bf16_f32 v136, v28, v29
	v_cvt_pk_bf16_f32 v137, v30, v31
	s_add_u32 s71, s58, s74
	s_add_u32 s72, s59, s75
	s_cmp_lg_u32 s99, 0
	s_cselect_b64 vcc, -1, 0
	s_cbranch_vccz Lst_39
	buffer_store_dwordx4 v[128:131], v5, s[4:7], s71 offen sc1
	s_branch Lst_39e
Lst_39:
	buffer_store_dwordx4 v[128:131], v5, s[4:7], s71 offen
Lst_39e:
	s_cbranch_vccz Lst_40
	buffer_store_dwordx4 v[132:135], v5, s[4:7], s71 offen offset:2048 sc1
	s_branch Lst_40e
Lst_40:
	buffer_store_dwordx4 v[132:135], v5, s[4:7], s71 offen offset:2048
Lst_40e:
	s_cbranch_vccz Lst_41
	buffer_store_dwordx2 v[136:137], v7, s[4:7], s71 offen sc1
	s_branch Lst_41e
Lst_41:
	buffer_store_dwordx2 v[136:137], v7, s[4:7], s71 offen
Lst_41e:
	v_pk_mul_f32 v[144:145], v[12:13], v[12:13]
	v_pk_mul_f32 v[146:147], v[14:15], v[14:15]
	v_pk_fma_f32 v[144:145], v[16:17], v[16:17], v[144:145]
	v_pk_fma_f32 v[146:147], v[18:19], v[18:19], v[146:147]
	v_pk_fma_f32 v[144:145], v[20:21], v[20:21], v[144:145]
	v_pk_fma_f32 v[146:147], v[22:23], v[22:23], v[146:147]
	v_pk_fma_f32 v[144:145], v[24:25], v[24:25], v[144:145]
	v_pk_fma_f32 v[146:147], v[26:27], v[26:27], v[146:147]
	v_pk_fma_f32 v[144:145], v[28:29], v[28:29], v[144:145]
	v_pk_fma_f32 v[146:147], v[30:31], v[30:31], v[146:147]
	v_pk_add_f32 v[140:141], v[12:13], v[14:15]
	v_pk_add_f32 v[142:143], v[16:17], v[18:19]
	v_pk_add_f32 v[140:141], v[140:141], v[20:21]
	v_pk_add_f32 v[142:143], v[142:143], v[22:23]
	v_pk_add_f32 v[140:141], v[140:141], v[24:25]
	v_pk_add_f32 v[142:143], v[142:143], v[26:27]
	v_pk_add_f32 v[140:141], v[140:141], v[28:29]
	v_pk_add_f32 v[142:143], v[142:143], v[30:31]
	v_pk_add_f32 v[140:141], v[140:141], v[142:143]
	v_add_f32 v140, v140, v141
	v_pk_add_f32 v[144:145], v[144:145], v[146:147]
	v_add_f32 v141, v144, v145
	s_nop 1
	v_permlane32_swap_b32 v140, v141
	v_add_f32 v140, v140, v141
	v_mov_b32 v141, v140
	s_nop 1
	v_permlane16_swap_b32 v140, v141
	v_add_f32 v140, v140, v141
	s_cbranch_vccz Lst_42
	buffer_store_dword v140, v8, s[4:7], s72 offen sc1
	s_branch Lst_42e
Lst_42:
	buffer_store_dword v140, v8, s[4:7], s72 offen
Lst_42e:
	s_add_u32 s71, s66, 15495168
	s_lshl_b32 s72, s46, 2
	s_add_u32 s72, s72, s71
	s_waitcnt vmcnt(0)
	s_barrier
	s_cmp_lg_u32 s44, 0
	s_cbranch_scc1 Lsa_43
	s_mov_b64 exec, 1
	s_cmp_eq_u32 s99, 0
	s_cbranch_scc1 Lfl_45
	buffer_atomic_swap v244, off, s[4:7], s72 sc1
	s_branch Lfl_45e
Lfl_45:
	buffer_store_dword v244, off, s[4:7], s72
Lfl_45e:
	s_mov_b64 exec, -1
	s_mov_b64 exec, 0xffff
	buffer_load_dword v250, v247, s[4:7], s71 offen sc1
	s_mov_b64 exec, -1
	s_add_u32 m0, s51, 32768
	s_add_u32 s85, s52, 32768
	buffer_load_dwordx4 v1, s[4:7], s85 offen offset:0 sc1 lds
	buffer_load_dwordx4 v1, s[4:7], s85 offen offset:1024 sc1 lds
	buffer_load_dwordx4 v1, s[4:7], s85 offen offset:2048 sc1 lds
	buffer_load_dwordx4 v1, s[4:7], s85 offen offset:3072 sc1 lds
	s_add_u32 m0, s51, 49152
	s_add_u32 s85, s52, 49152
	buffer_load_dwordx4 v1, s[4:7], s85 offen offset:0 sc1 lds
	buffer_load_dwordx4 v1, s[4:7], s85 offen offset:1024 sc1 lds
	buffer_load_dwordx4 v1, s[4:7], s85 offen offset:2048 sc1 lds
	buffer_load_dwordx4 v1, s[4:7], s85 offen offset:3072 sc1 lds
	s_mov_b64 exec, 0xffff
	s_waitcnt vmcnt(8)
	v_cmp_ne_u32 vcc, s70, v250
	s_cbranch_vccz Lpollf_48
Lpoll_46:
	buffer_load_dword v250, v247, s[4:7], s71 offen sc1
	s_sub_u32 s69, s69, 1
	s_cselect_b32 s69, 0, s69
	s_cbranch_scc1 Lpolle_47
	s_waitcnt vmcnt(0)
	v_cmp_ne_u32 vcc, s70, v250
	s_cbranch_vccnz Lpoll_46
Lpolle_47:
	s_waitcnt vmcnt(0)
Lpollf_48:
	s_mov_b64 exec, -1
	s_branch Lsb_44
Lsa_43:
	s_add_u32 m0, s51, 32768
	s_add_u32 s85, s52, 32768
	buffer_load_dwordx4 v1, s[4:7], s85 offen offset:0 sc1 lds
	buffer_load_dwordx4 v1, s[4:7], s85 offen offset:1024 sc1 lds
	buffer_load_dwordx4 v1, s[4:7], s85 offen offset:2048 sc1 lds
	buffer_load_dwordx4 v1, s[4:7], s85 offen offset:3072 sc1 lds
	s_add_u32 m0, s51, 49152
	s_add_u32 s85, s52, 49152
	buffer_load_dwordx4 v1, s[4:7], s85 offen offset:0 sc1 lds
	buffer_load_dwordx4 v1, s[4:7], s85 offen offset:1024 sc1 lds
	buffer_load_dwordx4 v1, s[4:7], s85 offen offset:2048 sc1 lds
	buffer_load_dwordx4 v1, s[4:7], s85 offen offset:3072 sc1 lds
Lsb_44:
	s_barrier
	s_sub_u32 s74, s74, s73
	s_add_u32 s56, s56, s73
	s_add_u32 s57, s57, s73
	s_add_u32 s58, s58, s73
	s_add_u32 s59, s59, s73
	s_add_u32 s60, s60, s73
	s_add_u32 s61, s61, s73
	s_add_u32 s62, s62, s73
	s_add_u32 s63, s63, s73
	s_add_u32 s64, s64, 15495168
	s_add_u32 s65, s65, 15495168
	s_add_u32 s66, s66, 15495168
	s_add_u32 s67, s67, 15495168
	s_add_u32 s96, s96, s73
	s_add_u32 s77, s77, s73
	s_add_u32 s68, s68, 1
	s_add_u32 s86, s56, s74
	buffer_load_dwordx4 a[0:3], v4, s[4:7], s86 offen offset:0 sc1
	buffer_load_dwordx4 a[4:7], v4, s[4:7], s86 offen offset:256 sc1
	buffer_load_dwordx4 a[8:11], v4, s[4:7], s86 offen offset:2048 sc1
	buffer_load_dwordx4 a[12:15], v4, s[4:7], s86 offen offset:2304 sc1
	s_add_u32 s86, s86, 4096
	buffer_load_dwordx4 a[16:19], v4, s[4:7], s86 offen offset:0 sc1
	buffer_load_dwordx4 a[20:23], v4, s[4:7], s86 offen offset:256 sc1
	ds_read_b128 v[32:35], v1 offset:0
	ds_read_b128 v[36:39], v1 offset:1024
	ds_read_b128 v[40:43], v1 offset:2048
	ds_read_b128 v[44:47], v1 offset:3072
	ds_read_b128 v[48:51], v1 offset:4096
	ds_read_b128 v[52:55], v1 offset:5120
	ds_read_b128 v[56:59], v1 offset:6144
	s_waitcnt vmcnt(4) lgkmcnt(3)
	v_mfma_f32_16x16x32_bf16 v[64:67], v[32:35], a[0:3], 0
	ds_read_b128 v[60:63], v1 offset:7168
	v_mfma_f32_16x16x32_bf16 v[68:71], v[32:35], a[4:7], 0
	buffer_load_dwordx4 a[24:27], v4, s[4:7], s86 offen offset:2048 sc1
	v_mfma_f32_16x16x32_bf16 v[72:75], v[36:39], a[0:3], 0
	ds_read_b128 v[32:35], v1 offset:8192
	v_mfma_f32_16x16x32_bf16 v[76:79], v[36:39], a[4:7], 0
	buffer_load_dwordx4 a[28:31], v4, s[4:7], s86 offen offset:2304 sc1
	v_mfma_f32_16x16x32_bf16 v[80:83], v[40:43], a[0:3], 0
	ds_read_b128 v[36:39], v1 offset:9216
	v_mfma_f32_16x16x32_bf16 v[84:87], v[40:43], a[4:7], 0
	s_add_u32 m0, s51, 65536
	s_add_u32 s85, s52, 65536
	v_mfma_f32_16x16x32_bf16 v[88:91], v[44:47], a[0:3], 0
	ds_read_b128 v[40:43], v1 offset:10240
	s_add_u32 s86, s86, 4096
	v_mfma_f32_16x16x32_bf16 v[92:95], v[44:47], a[4:7], 0
	buffer_load_dwordx4 a[32:35], v4, s[4:7], s86 offen offset:0 sc1
	s_waitcnt lgkmcnt(3)
	v_mfma_f32_16x16x32_bf16 v[96:99], v[48:51], a[0:3], 0
	ds_read_b128 v[44:47], v1 offset:11264
	v_mfma_f32_16x16x32_bf16 v[100:103], v[48:51], a[4:7], 0
	buffer_load_dwordx4 a[36:39], v4, s[4:7], s86 offen offset:256 sc1
	v_mfma_f32_16x16x32_bf16 v[104:107], v[52:55], a[0:3], 0
	ds_read_b128 v[48:51], v1 offset:12288
	s_waitcnt vmcnt(6)
	v_mfma_f32_16x16x32_bf16 v[108:111], v[52:55], a[4:7], 0
	buffer_load_dwordx4 v1, s[4:7], s85 offen offset:0 sc1 lds
	v_mfma_f32_16x16x32_bf16 v[64:67], v[56:59], a[8:11], v[64:67]
	ds_read_b128 v[52:55], v1 offset:13312
	v_mfma_f32_16x16x32_bf16 v[68:71], v[56:59], a[12:15], v[68:71]
	buffer_load_dwordx4 a[40:43], v4, s[4:7], s86 offen offset:2048 sc1
	v_mfma_f32_16x16x32_bf16 v[72:75], v[60:63], a[8:11], v[72:75]
	ds_read_b128 v[56:59], v1 offset:14336
	s_waitcnt lgkmcnt(3)
	v_mfma_f32_16x16x32_bf16 v[76:79], v[60:63], a[12:15], v[76:79]
	buffer_load_dwordx4 a[44:47], v4, s[4:7], s86 offen offset:2304 sc1
	v_mfma_f32_16x16x32_bf16 v[80:83], v[32:35], a[8:11], v[80:83]
	ds_read_b128 v[60:63], v1 offset:15360
	v_mfma_f32_16x16x32_bf16 v[84:87], v[32:35], a[12:15], v[84:87]
	v_mfma_f32_16x16x32_bf16 v[88:91], v[36:39], a[8:11], v[88:91]
	ds_read_b128 v[32:35], v1 offset:16384
	s_add_u32 s86, s86, 4096
	v_mfma_f32_16x16x32_bf16 v[92:95], v[36:39], a[12:15], v[92:95]
	buffer_load_dwordx4 a[48:51], v4, s[4:7], s86 offen offset:0 sc1
	v_mfma_f32_16x16x32_bf16 v[96:99], v[40:43], a[8:11], v[96:99]
	ds_read_b128 v[36:39], v1 offset:17408
	v_mfma_f32_16x16x32_bf16 v[100:103], v[40:43], a[12:15], v[100:103]
	buffer_load_dwordx4 a[52:55], v4, s[4:7], s86 offen offset:256 sc1
	v_mfma_f32_16x16x32_bf16 v[104:107], v[44:47], a[8:11], v[104:107]
	ds_read_b128 v[40:43], v1 offset:18432
	s_waitcnt vmcnt(9) lgkmcnt(3)
	v_mfma_f32_16x16x32_bf16 v[108:111], v[44:47], a[12:15], v[108:111]
	buffer_load_dwordx4 v1, s[4:7], s85 offen offset:1024 sc1 lds
	v_mfma_f32_16x16x32_bf16 v[64:67], v[48:51], a[16:19], v[64:67]
	ds_read_b128 v[44:47], v1 offset:19456
	v_mfma_f32_16x16x32_bf16 v[68:71], v[48:51], a[20:23], v[68:71]
	buffer_load_dwordx4 a[56:59], v4, s[4:7], s86 offen offset:2048 sc1
	v_mfma_f32_16x16x32_bf16 v[72:75], v[52:55], a[16:19], v[72:75]
	ds_read_b128 v[48:51], v1 offset:20480
	v_mfma_f32_16x16x32_bf16 v[76:79], v[52:55], a[20:23], v[76:79]
	v_mfma_f32_16x16x32_bf16 v[80:83], v[56:59], a[16:19], v[80:83]
	ds_read_b128 v[52:55], v1 offset:21504
	v_mfma_f32_16x16x32_bf16 v[84:87], v[56:59], a[20:23], v[84:87]
	v_mfma_f32_16x16x32_bf16 v[88:91], v[60:63], a[16:19], v[88:91]
	ds_read_b128 v[56:59], v1 offset:22528
	s_waitcnt lgkmcnt(3)
	v_mfma_f32_16x16x32_bf16 v[92:95], v[60:63], a[20:23], v[92:95]
	buffer_load_dwordx4 a[60:63], v4, s[4:7], s86 offen offset:2304 sc1
	v_mfma_f32_16x16x32_bf16 v[96:99], v[32:35], a[16:19], v[96:99]
	ds_read_b128 v[60:63], v1 offset:23552
	v_mfma_f32_16x16x32_bf16 v[100:103], v[32:35], a[20:23], v[100:103]
	buffer_load_dwordx4 v1, s[4:7], s85 offen offset:2048 sc1 lds
	v_mfma_f32_16x16x32_bf16 v[104:107], v[36:39], a[16:19], v[104:107]
	ds_read_b128 v[32:35], v1 offset:24576
	v_mfma_f32_16x16x32_bf16 v[108:111], v[36:39], a[20:23], v[108:111]
	s_waitcnt vmcnt(11)
	v_mfma_f32_16x16x32_bf16 v[64:67], v[40:43], a[24:27], v[64:67]
	ds_read_b128 v[36:39], v1 offset:25600
	s_add_u32 s86, s86, 4096
	v_mfma_f32_16x16x32_bf16 v[68:71], v[40:43], a[28:31], v[68:71]
	buffer_load_dwordx4 a[64:67], v4, s[4:7], s86 offen offset:0 sc1
	v_mfma_f32_16x16x32_bf16 v[72:75], v[44:47], a[24:27], v[72:75]
	ds_read_b128 v[40:43], v1 offset:26624
	v_mfma_f32_16x16x32_bf16 v[76:79], v[44:47], a[28:31], v[76:79]
	s_waitcnt lgkmcnt(3)
	v_mfma_f32_16x16x32_bf16 v[80:83], v[48:51], a[24:27], v[80:83]
	ds_read_b128 v[44:47], v1 offset:27648
	v_mfma_f32_16x16x32_bf16 v[84:87], v[48:51], a[28:31], v[84:87]
	v_mfma_f32_16x16x32_bf16 v[88:91], v[52:55], a[24:27], v[88:91]
	ds_read_b128 v[48:51], v1 offset:28672
	v_mfma_f32_16x16x32_bf16 v[92:95], v[52:55], a[28:31], v[92:95]
	buffer_load_dwordx4 a[68:71], v4, s[4:7], s86 offen offset:256 sc1
	v_mfma_f32_16x16x32_bf16 v[96:99], v[56:59], a[24:27], v[96:99]
	ds_read_b128 v[52:55], v1 offset:29696
	v_mfma_f32_16x16x32_bf16 v[100:103], v[56:59], a[28:31], v[100:103]
	buffer_load_dwordx4 v1, s[4:7], s85 offen offset:3072 sc1 lds
	v_mfma_f32_16x16x32_bf16 v[104:107], v[60:63], a[24:27], v[104:107]
	ds_read_b128 v[56:59], v1 offset:30720
	v_mfma_f32_16x16x32_bf16 v[108:111], v[60:63], a[28:31], v[108:111]
	s_waitcnt vmcnt(12) lgkmcnt(3)
	v_mfma_f32_16x16x32_bf16 v[64:67], v[32:35], a[32:35], v[64:67]
	ds_read_b128 v[60:63], v1 offset:31744
	v_mfma_f32_16x16x32_bf16 v[68:71], v[32:35], a[36:39], v[68:71]
	buffer_load_dwordx4 a[72:75], v4, s[4:7], s86 offen offset:2048 sc1
	v_mfma_f32_16x16x32_bf16 v[72:75], v[36:39], a[32:35], v[72:75]
	s_barrier
	ds_read_b128 v[32:35], v1 offset:32768
	v_mfma_f32_16x16x32_bf16 v[76:79], v[36:39], a[36:39], v[76:79]
	v_mfma_f32_16x16x32_bf16 v[80:83], v[40:43], a[32:35], v[80:83]
	ds_read_b128 v[36:39], v1 offset:33792
	v_mfma_f32_16x16x32_bf16 v[84:87], v[40:43], a[36:39], v[84:87]
	v_mfma_f32_16x16x32_bf16 v[88:91], v[44:47], a[32:35], v[88:91]
	ds_read_b128 v[40:43], v1 offset:34816
	s_waitcnt lgkmcnt(3)
	v_mfma_f32_16x16x32_bf16 v[92:95], v[44:47], a[36:39], v[92:95]
	buffer_load_dwordx4 a[76:79], v4, s[4:7], s86 offen offset:2304 sc1
	v_mfma_f32_16x16x32_bf16 v[96:99], v[48:51], a[32:35], v[96:99]
	ds_read_b128 v[44:47], v1 offset:35840
	v_mfma_f32_16x16x32_bf16 v[100:103], v[48:51], a[36:39], v[100:103]
	s_add_u32 m0, s51, 131072
	s_add_u32 s85, s52, 81920
	v_mfma_f32_16x16x32_bf16 v[104:107], v[52:55], a[32:35], v[104:107]
	ds_read_b128 v[48:51], v1 offset:36864
	s_waitcnt vmcnt(11)
	v_mfma_f32_16x16x32_bf16 v[108:111], v[52:55], a[36:39], v[108:111]
	buffer_load_dwordx4 v1, s[4:7], s85 offen offset:0 sc1 lds
	v_mfma_f32_16x16x32_bf16 v[64:67], v[56:59], a[40:43], v[64:67]
	ds_read_b128 v[52:55], v1 offset:37888
	s_add_u32 s86, s86, 4096
	v_mfma_f32_16x16x32_bf16 v[68:71], v[56:59], a[44:47], v[68:71]
	buffer_load_dwordx4 a[80:83], v4, s[4:7], s86 offen offset:0 sc1
	v_mfma_f32_16x16x32_bf16 v[72:75], v[60:63], a[40:43], v[72:75]
	ds_read_b128 v[56:59], v1 offset:38912
	v_mfma_f32_16x16x32_bf16 v[76:79], v[60:63], a[44:47], v[76:79]
	s_waitcnt lgkmcnt(3)
	v_mfma_f32_16x16x32_bf16 v[80:83], v[32:35], a[40:43], v[80:83]
	ds_read_b128 v[60:63], v1 offset:39936
	v_mfma_f32_16x16x32_bf16 v[84:87], v[32:35], a[44:47], v[84:87]
	v_mfma_f32_16x16x32_bf16 v[88:91], v[36:39], a[40:43], v[88:91]
	ds_read_b128 v[32:35], v1 offset:40960
	v_mfma_f32_16x16x32_bf16 v[92:95], v[36:39], a[44:47], v[92:95]
	buffer_load_dwordx4 a[84:87], v4, s[4:7], s86 offen offset:256 sc1
	v_mfma_f32_16x16x32_bf16 v[96:99], v[40:43], a[40:43], v[96:99]
	ds_read_b128 v[36:39], v1 offset:41984
	v_mfma_f32_16x16x32_bf16 v[100:103], v[40:43], a[44:47], v[100:103]
	buffer_load_dwordx4 v1, s[4:7], s85 offen offset:1024 sc1 lds
	v_mfma_f32_16x16x32_bf16 v[104:107], v[44:47], a[40:43], v[104:107]
	ds_read_b128 v[40:43], v1 offset:43008
	v_mfma_f32_16x16x32_bf16 v[108:111], v[44:47], a[44:47], v[108:111]
	s_waitcnt vmcnt(13) lgkmcnt(3)
	v_mfma_f32_16x16x32_bf16 v[64:67], v[48:51], a[48:51], v[64:67]
	ds_read_b128 v[44:47], v1 offset:44032
	v_mfma_f32_16x16x32_bf16 v[68:71], v[48:51], a[52:55], v[68:71]
	buffer_load_dwordx4 a[88:91], v4, s[4:7], s86 offen offset:2048 sc1
	v_mfma_f32_16x16x32_bf16 v[72:75], v[52:55], a[48:51], v[72:75]
	ds_read_b128 v[48:51], v1 offset:45056
	v_mfma_f32_16x16x32_bf16 v[76:79], v[52:55], a[52:55], v[76:79]
	v_mfma_f32_16x16x32_bf16 v[80:83], v[56:59], a[48:51], v[80:83]
	ds_read_b128 v[52:55], v1 offset:46080
	v_mfma_f32_16x16x32_bf16 v[84:87], v[56:59], a[52:55], v[84:87]
	v_mfma_f32_16x16x32_bf16 v[88:91], v[60:63], a[48:51], v[88:91]
	ds_read_b128 v[56:59], v1 offset:47104
	s_waitcnt lgkmcnt(3)
	v_mfma_f32_16x16x32_bf16 v[92:95], v[60:63], a[52:55], v[92:95]
	buffer_load_dwordx4 a[92:95], v4, s[4:7], s86 offen offset:2304 sc1
	v_mfma_f32_16x16x32_bf16 v[96:99], v[32:35], a[48:51], v[96:99]
	ds_read_b128 v[60:63], v1 offset:48128
	v_mfma_f32_16x16x32_bf16 v[100:103], v[32:35], a[52:55], v[100:103]
	buffer_load_dwordx4 v1, s[4:7], s85 offen offset:2048 sc1 lds
	v_mfma_f32_16x16x32_bf16 v[104:107], v[36:39], a[48:51], v[104:107]
	ds_read_b128 v[32:35], v1 offset:49152
	s_add_u32 s76, s57, 15204352
	v_mfma_f32_16x16x32_bf16 v[108:111], v[36:39], a[52:55], v[108:111]
	buffer_load_dwordx2 v[184:185], v9, s[4:7], s76 offen offset:0 sc1
	s_waitcnt vmcnt(14)
	v_mfma_f32_16x16x32_bf16 v[64:67], v[40:43], a[56:59], v[64:67]
	ds_read_b128 v[36:39], v1 offset:50176
	s_add_u32 s86, s86, 4096
	v_mfma_f32_16x16x32_bf16 v[68:71], v[40:43], a[60:63], v[68:71]
	buffer_load_dwordx4 a[96:99], v4, s[4:7], s86 offen offset:0 sc1
	v_mfma_f32_16x16x32_bf16 v[72:75], v[44:47], a[56:59], v[72:75]
	ds_read_b128 v[40:43], v1 offset:51200
	v_mfma_f32_16x16x32_bf16 v[76:79], v[44:47], a[60:63], v[76:79]
	s_waitcnt lgkmcnt(3)
	v_mfma_f32_16x16x32_bf16 v[80:83], v[48:51], a[56:59], v[80:83]
	ds_read_b128 v[44:47], v1 offset:52224
	v_mfma_f32_16x16x32_bf16 v[84:87], v[48:51], a[60:63], v[84:87]
	buffer_load_dwordx2 v[186:187], v9, s[4:7], s76 offen offset:256 sc1
	v_mfma_f32_16x16x32_bf16 v[88:91], v[52:55], a[56:59], v[88:91]
	ds_read_b128 v[48:51], v1 offset:53248
	v_mfma_f32_16x16x32_bf16 v[92:95], v[52:55], a[60:63], v[92:95]
	buffer_load_dwordx4 a[100:103], v4, s[4:7], s86 offen offset:256 sc1
	v_mfma_f32_16x16x32_bf16 v[96:99], v[56:59], a[56:59], v[96:99]
	ds_read_b128 v[52:55], v1 offset:54272
	v_mfma_f32_16x16x32_bf16 v[100:103], v[56:59], a[60:63], v[100:103]
	buffer_load_dwordx4 v1, s[4:7], s85 offen offset:3072 sc1 lds
	v_mfma_f32_16x16x32_bf16 v[104:107], v[60:63], a[56:59], v[104:107]
	ds_read_b128 v[56:59], v1 offset:55296
	s_waitcnt vmcnt(15) lgkmcnt(3)
	v_mfma_f32_16x16x32_bf16 v[108:111], v[60:63], a[60:63], v[108:111]
	buffer_load_dwordx2 v[188:189], v9, s[4:7], s76 offen offset:512 sc1
	v_mfma_f32_16x16x32_bf16 v[64:67], v[32:35], a[64:67], v[64:67]
	ds_read_b128 v[60:63], v1 offset:56320
	v_mfma_f32_16x16x32_bf16 v[68:71], v[32:35], a[68:71], v[68:71]
	buffer_load_dwordx4 a[104:107], v4, s[4:7], s86 offen offset:2048 sc1
	v_mfma_f32_16x16x32_bf16 v[72:75], v[36:39], a[64:67], v[72:75]
	ds_read_b128 v[32:35], v1 offset:57344
	v_mfma_f32_16x16x32_bf16 v[76:79], v[36:39], a[68:71], v[76:79]
	v_mfma_f32_16x16x32_bf16 v[80:83], v[40:43], a[64:67], v[80:83]
	ds_read_b128 v[36:39], v1 offset:58368
	v_mfma_f32_16x16x32_bf16 v[84:87], v[40:43], a[68:71], v[84:87]
	buffer_load_dwordx2 v[190:191], v9, s[4:7], s76 offen offset:768 sc1
	v_mfma_f32_16x16x32_bf16 v[88:91], v[44:47], a[64:67], v[88:91]
	ds_read_b128 v[40:43], v1 offset:59392
	s_waitcnt lgkmcnt(3)
	v_mfma_f32_16x16x32_bf16 v[92:95], v[44:47], a[68:71], v[92:95]
	buffer_load_dwordx4 a[108:111], v4, s[4:7], s86 offen offset:2304 sc1
	v_mfma_f32_16x16x32_bf16 v[96:99], v[48:51], a[64:67], v[96:99]
	ds_read_b128 v[44:47], v1 offset:60416
	v_mfma_f32_16x16x32_bf16 v[100:103], v[48:51], a[68:71], v[100:103]
	s_add_u32 m0, s51, 147456
	s_add_u32 s85, s52, 98304
	v_mfma_f32_16x16x32_bf16 v[104:107], v[52:55], a[64:67], v[104:107]
	ds_read_b128 v[48:51], v1 offset:61440
	s_waitcnt vmcnt(16)
	v_mfma_f32_16x16x32_bf16 v[108:111], v[52:55], a[68:71], v[108:111]
	buffer_load_dwordx4 v1, s[4:7], s85 offen offset:0 sc1 lds
	v_mfma_f32_16x16x32_bf16 v[64:67], v[56:59], a[72:75], v[64:67]
	ds_read_b128 v[52:55], v1 offset:62464
	s_add_u32 s86, s86, 4096
	v_mfma_f32_16x16x32_bf16 v[68:71], v[56:59], a[76:79], v[68:71]
	buffer_load_dwordx4 a[112:115], v4, s[4:7], s86 offen offset:0 sc1
	v_mfma_f32_16x16x32_bf16 v[72:75], v[60:63], a[72:75], v[72:75]
	ds_read_b128 v[56:59], v1 offset:63488
	v_mfma_f32_16x16x32_bf16 v[76:79], v[60:63], a[76:79], v[76:79]
	s_waitcnt lgkmcnt(3)
	v_mfma_f32_16x16x32_bf16 v[80:83], v[32:35], a[72:75], v[80:83]
	ds_read_b128 v[60:63], v1 offset:64512
	v_mfma_f32_16x16x32_bf16 v[84:87], v[32:35], a[76:79], v[84:87]
	v_mfma_f32_16x16x32_bf16 v[88:91], v[36:39], a[72:75], v[88:91]
	s_barrier
	ds_read_b128 v[32:35], v2 offset:0
	v_mfma_f32_16x16x32_bf16 v[92:95], v[36:39], a[76:79], v[92:95]
	buffer_load_dwordx4 a[116:119], v4, s[4:7], s86 offen offset:256 sc1
	v_mfma_f32_16x16x32_bf16 v[96:99], v[40:43], a[72:75], v[96:99]
	ds_read_b128 v[36:39], v2 offset:1024
	v_mfma_f32_16x16x32_bf16 v[100:103], v[40:43], a[76:79], v[100:103]
	buffer_load_dwordx4 v1, s[4:7], s85 offen offset:1024 sc1 lds
	v_mfma_f32_16x16x32_bf16 v[104:107], v[44:47], a[72:75], v[104:107]
	ds_read_b128 v[40:43], v2 offset:2048
	v_mfma_f32_16x16x32_bf16 v[108:111], v[44:47], a[76:79], v[108:111]
	s_waitcnt vmcnt(17) lgkmcnt(3)
	v_mfma_f32_16x16x32_bf16 v[64:67], v[48:51], a[80:83], v[64:67]
	ds_read_b128 v[44:47], v2 offset:3072
	v_mfma_f32_16x16x32_bf16 v[68:71], v[48:51], a[84:87], v[68:71]
	buffer_load_dwordx4 a[120:123], v4, s[4:7], s86 offen offset:2048 sc1
	v_mfma_f32_16x16x32_bf16 v[72:75], v[52:55], a[80:83], v[72:75]
	ds_read_b128 v[48:51], v2 offset:4096
	v_mfma_f32_16x16x32_bf16 v[76:79], v[52:55], a[84:87], v[76:79]
	v_mfma_f32_16x16x32_bf16 v[80:83], v[56:59], a[80:83], v[80:83]
	ds_read_b128 v[52:55], v2 offset:5120
	v_mfma_f32_16x16x32_bf16 v[84:87], v[56:59], a[84:87], v[84:87]
	v_mfma_f32_16x16x32_bf16 v[88:91], v[60:63], a[80:83], v[88:91]
	ds_read_b128 v[56:59], v2 offset:6144
	s_waitcnt lgkmcnt(3)
	v_mfma_f32_16x16x32_bf16 v[92:95], v[60:63], a[84:87], v[92:95]
	buffer_load_dwordx4 a[124:127], v4, s[4:7], s86 offen offset:2304 sc1
	v_mfma_f32_16x16x32_bf16 v[96:99], v[32:35], a[80:83], v[96:99]
	ds_read_b128 v[60:63], v2 offset:7168
	v_mfma_f32_16x16x32_bf16 v[100:103], v[32:35], a[84:87], v[100:103]
	buffer_load_dwordx4 v1, s[4:7], s85 offen offset:2048 sc1 lds
	v_mfma_f32_16x16x32_bf16 v[104:107], v[36:39], a[80:83], v[104:107]
	ds_read_b128 v[32:35], v2 offset:8192
	v_mfma_f32_16x16x32_bf16 v[108:111], v[36:39], a[84:87], v[108:111]
	s_waitcnt vmcnt(17)
	v_mfma_f32_16x16x32_bf16 v[64:67], v[40:43], a[88:91], v[64:67]
	ds_read_b128 v[36:39], v2 offset:9216
	s_add_u32 s86, s86, 4096
	v_mfma_f32_16x16x32_bf16 v[68:71], v[40:43], a[92:95], v[68:71]
	buffer_load_dwordx4 a[128:131], v4, s[4:7], s86 offen offset:0 sc1
	v_mfma_f32_16x16x32_bf16 v[72:75], v[44:47], a[88:91], v[72:75]
	ds_read_b128 v[40:43], v2 offset:10240
	v_mfma_f32_16x16x32_bf16 v[76:79], v[44:47], a[92:95], v[76:79]
	s_waitcnt lgkmcnt(3)
	v_mfma_f32_16x16x32_bf16 v[80:83], v[48:51], a[88:91], v[80:83]
	ds_read_b128 v[44:47], v2 offset:11264
	v_mfma_f32_16x16x32_bf16 v[84:87], v[48:51], a[92:95], v[84:87]
	v_mfma_f32_16x16x32_bf16 v[88:91], v[52:55], a[88:91], v[88:91]
	ds_read_b128 v[48:51], v2 offset:12288
	v_mfma_f32_16x16x32_bf16 v[92:95], v[52:55], a[92:95], v[92:95]
	buffer_load_dwordx4 a[132:135], v4, s[4:7], s86 offen offset:256 sc1
	v_mfma_f32_16x16x32_bf16 v[96:99], v[56:59], a[88:91], v[96:99]
	ds_read_b128 v[52:55], v2 offset:13312
	v_mfma_f32_16x16x32_bf16 v[100:103], v[56:59], a[92:95], v[100:103]
	buffer_load_dwordx4 v1, s[4:7], s85 offen offset:3072 sc1 lds
	v_mfma_f32_16x16x32_bf16 v[104:107], v[60:63], a[88:91], v[104:107]
	ds_read_b128 v[56:59], v2 offset:14336
	v_mfma_f32_16x16x32_bf16 v[108:111], v[60:63], a[92:95], v[108:111]
	s_waitcnt vmcnt(15) lgkmcnt(3)
	v_mfma_f32_16x16x32_bf16 v[64:67], v[32:35], a[96:99], v[64:67]
	ds_read_b128 v[60:63], v2 offset:15360
	v_mfma_f32_16x16x32_bf16 v[68:71], v[32:35], a[100:103], v[68:71]
	buffer_load_dwordx4 a[136:139], v4, s[4:7], s86 offen offset:2048 sc1
	v_mfma_f32_16x16x32_bf16 v[72:75], v[36:39], a[96:99], v[72:75]
	s_waitcnt vmcnt(15)
	s_barrier
	ds_read_b128 v[32:35], v245 offset:0
	v_mfma_f32_16x16x32_bf16 v[76:79], v[36:39], a[100:103], v[76:79]
	v_mfma_f32_16x16x32_bf16 v[80:83], v[40:43], a[96:99], v[80:83]
	ds_read_b128 v[36:39], v245 offset:1024
	v_mfma_f32_16x16x32_bf16 v[84:87], v[40:43], a[100:103], v[84:87]
	v_mfma_f32_16x16x32_bf16 v[88:91], v[44:47], a[96:99], v[88:91]
	ds_read_b128 v[40:43], v245 offset:2048
	s_waitcnt lgkmcnt(3)
	v_mfma_f32_16x16x32_bf16 v[92:95], v[44:47], a[100:103], v[92:95]
	buffer_load_dwordx4 a[140:143], v4, s[4:7], s86 offen offset:2304 sc1
	v_mfma_f32_16x16x32_bf16 v[96:99], v[48:51], a[96:99], v[96:99]
	ds_read_b128 v[44:47], v245 offset:3072
	v_mfma_f32_16x16x32_bf16 v[100:103], v[48:51], a[100:103], v[100:103]
	s_add_u32 m0, s51, 81920
	s_add_u32 s85, s52, 114688
	v_mfma_f32_16x16x32_bf16 v[104:107], v[52:55], a[96:99], v[104:107]
	ds_read_b128 v[48:51], v245 offset:4096
	s_waitcnt vmcnt(12)
	v_mfma_f32_16x16x32_bf16 v[108:111], v[52:55], a[100:103], v[108:111]
	buffer_load_dwordx4 v1, s[4:7], s85 offen offset:0 sc1 lds
	v_mfma_f32_16x16x32_bf16 v[64:67], v[56:59], a[104:107], v[64:67]
	ds_read_b128 v[52:55], v245 offset:5120
	s_add_u32 s86, s86, 4096
	v_mfma_f32_16x16x32_bf16 v[68:71], v[56:59], a[108:111], v[68:71]
	buffer_load_dwordx4 a[144:147], v4, s[4:7], s86 offen offset:0 sc1
	v_mfma_f32_16x16x32_bf16 v[72:75], v[60:63], a[104:107], v[72:75]
	ds_read_b128 v[56:59], v245 offset:6144
	v_mfma_f32_16x16x32_bf16 v[76:79], v[60:63], a[108:111], v[76:79]
	s_waitcnt lgkmcnt(3)
	v_mfma_f32_16x16x32_bf16 v[80:83], v[32:35], a[104:107], v[80:83]
	ds_read_b128 v[60:63], v245 offset:7168
	v_mfma_f32_16x16x32_bf16 v[84:87], v[32:35], a[108:111], v[84:87]
	v_mfma_f32_16x16x32_bf16 v[88:91], v[36:39], a[104:107], v[88:91]
	ds_read_b128 v[32:35], v245 offset:8192
	v_mfma_f32_16x16x32_bf16 v[92:95], v[36:39], a[108:111], v[92:95]
	buffer_load_dwordx4 a[148:151], v4, s[4:7], s86 offen offset:256 sc1
	v_mfma_f32_16x16x32_bf16 v[96:99], v[40:43], a[104:107], v[96:99]
	ds_read_b128 v[36:39], v245 offset:9216
	v_mfma_f32_16x16x32_bf16 v[100:103], v[40:43], a[108:111], v[100:103]
	buffer_load_dwordx4 v1, s[4:7], s85 offen offset:1024 sc1 lds
	v_mfma_f32_16x16x32_bf16 v[104:107], v[44:47], a[104:107], v[104:107]
	ds_read_b128 v[40:43], v245 offset:10240
	v_mfma_f32_16x16x32_bf16 v[108:111], v[44:47], a[108:111], v[108:111]
	s_waitcnt vmcnt(13) lgkmcnt(3)
	v_mfma_f32_16x16x32_bf16 v[64:67], v[48:51], a[112:115], v[64:67]
	ds_read_b128 v[44:47], v245 offset:11264
	v_add_f32 v168, v184, v188
	v_mfma_f32_16x16x32_bf16 v[68:71], v[48:51], a[116:119], v[68:71]
	buffer_load_dwordx4 a[152:155], v4, s[4:7], s86 offen offset:2048 sc1
	v_mfma_f32_16x16x32_bf16 v[72:75], v[52:55], a[112:115], v[72:75]
	ds_read_b128 v[48:51], v245 offset:12288
	v_add_f32 v169, v185, v189
	v_mfma_f32_16x16x32_bf16 v[76:79], v[52:55], a[116:119], v[76:79]
	v_add_f32 v170, v186, v190
	v_add_f32 v171, v187, v191
	v_mfma_f32_16x16x32_bf16 v[80:83], v[56:59], a[112:115], v[80:83]
	ds_read_b128 v[52:55], v245 offset:13312
	v_add_f32 v168, v168, v170
	v_mfma_f32_16x16x32_bf16 v[84:87], v[56:59], a[116:119], v[84:87]
	v_add_f32 v169, v169, v171
	v_mov_b32 v186, 0
	v_mfma_f32_16x16x32_bf16 v[88:91], v[60:63], a[112:115], v[88:91]
	ds_read_b128 v[56:59], v245 offset:14336
	s_waitcnt lgkmcnt(3)
	v_mfma_f32_16x16x32_bf16 v[92:95], v[60:63], a[116:119], v[92:95]
	buffer_load_dwordx4 a[156:159], v4, s[4:7], s86 offen offset:2304 sc1
	v_mfma_f32_16x16x32_bf16 v[96:99], v[32:35], a[112:115], v[96:99]
	ds_read_b128 v[60:63], v245 offset:15360
	v_mov_b32 v187, 0
	v_mfma_f32_16x16x32_bf16 v[100:103], v[32:35], a[116:119], v[100:103]
	buffer_load_dwordx4 v1, s[4:7], s85 offen offset:2048 sc1 lds
	v_mfma_f32_16x16x32_bf16 v[104:107], v[36:39], a[112:115], v[104:107]
	s_waitcnt vmcnt(9)
	s_barrier
	ds_read_b128 v[32:35], v245 offset:16384
	v_mfma_f32_16x16x32_bf16 v[108:111], v[36:39], a[116:119], v[108:111]
	v_permlane32_swap_b32 v168, v169
	v_add_f32 v168, v168, v169
	v_mfma_f32_16x16x32_bf16 v[64:67], v[40:43], a[120:123], v[64:67]
	ds_read_b128 v[36:39], v245 offset:17408
	v_mov_b32 v169, v168
	v_mfma_f32_16x16x32_bf16 v[68:71], v[40:43], a[124:127], v[68:71]
	v_mov_b32 v190, 0
	v_mov_b32 v191, 0
	v_mfma_f32_16x16x32_bf16 v[72:75], v[44:47], a[120:123], v[72:75]
	ds_read_b128 v[40:43], v245 offset:18432
	v_permlane32_swap_b32 v168, v169
	v_mfma_f32_16x16x32_bf16 v[76:79], v[44:47], a[124:127], v[76:79]
	v_mul_f32 v170, 0xbacccccd, v168
	s_waitcnt lgkmcnt(3)
	v_mfma_f32_16x16x32_bf16 v[80:83], v[48:51], a[120:123], v[80:83]
	ds_read_b128 v[44:47], v245 offset:19456
	v_mul_f32 v171, 0xbacccccd, v168
	v_mfma_f32_16x16x32_bf16 v[84:87], v[48:51], a[124:127], v[84:87]
	s_mov_b32 s78, 0xffff
	s_mov_b32 s79, 0
	v_mfma_f32_16x16x32_bf16 v[88:91], v[52:55], a[120:123], v[88:91]
	ds_read_b128 v[48:51], v245 offset:20480
	v_permlane16_swap_b32 v170, v171
	v_mfma_f32_16x16x32_bf16 v[92:95], v[52:55], a[124:127], v[92:95]
	buffer_load_dwordx4 v1, s[4:7], s85 offen offset:3072 sc1 lds
	v_mfma_f32_16x16x32_bf16 v[96:99], v[56:59], a[120:123], v[96:99]
	ds_read_b128 v[52:55], v245 offset:21504
	v_cndmask_b32 v170, 0, v170, s[78:79]
	v_mfma_f32_16x16x32_bf16 v[100:103], v[56:59], a[124:127], v[100:103]
	v_cvt_pk_bf16_f32 v184, v170, v170
	v_lshlrev_b32 v185, 16, v184
	v_mfma_f32_16x16x32_bf16 v[104:107], v[60:63], a[120:123], v[104:107]
	ds_read_b128 v[56:59], v245 offset:22528
	v_sub_f32 v170, v170, v185
	v_mfma_f32_16x16x32_bf16 v[108:111], v[60:63], a[124:127], v[108:111]
	v_cvt_pk_bf16_f32 v185, v170, 0
	s_waitcnt lgkmcnt(3)
	v_mfma_f32_16x16x32_bf16 v[64:67], v[32:35], a[128:131], v[64:67]
	ds_read_b128 v[60:63], v245 offset:23552
	v_cndmask_b32 v171, 0, v171, s[78:79]
	v_mfma_f32_16x16x32_bf16 v[68:71], v[32:35], a[132:135], v[68:71]
	v_cvt_pk_bf16_f32 v188, v171, v171
	v_lshlrev_b32 v189, 16, v188
	v_mfma_f32_16x16x32_bf16 v[72:75], v[36:39], a[128:131], v[72:75]
	ds_read_b128 v[32:35], v245 offset:24576
	v_sub_f32 v171, v171, v189
	v_mfma_f32_16x16x32_bf16 v[76:79], v[36:39], a[132:135], v[76:79]
	v_cvt_pk_bf16_f32 v189, v171, 0
	v_mul_f32 v168, 0x3acccccd, v168
	v_mfma_f32_16x16x32_bf16 v[80:83], v[40:43], a[128:131], v[80:83]
	ds_read_b128 v[36:39], v245 offset:25600
	v_mul_f32 v169, 0x3acccccd, v169
	v_mfma_f32_16x16x32_bf16 v[84:87], v[40:43], a[132:135], v[84:87]
	v_fma_f32 v169, -v168, v168, v169
	v_max_f32 v169, 0, v169
	v_mfma_f32_16x16x32_bf16 v[88:91], v[44:47], a[128:131], v[88:91]
	ds_read_b128 v[40:43], v245 offset:26624
	v_add_f32 v169, 0x3727c5ac, v169
	v_mfma_f32_16x16x32_bf16 v[92:95], v[44:47], a[132:135], v[92:95]
	s_waitcnt lgkmcnt(3)
	v_mfma_f32_16x16x32_bf16 v[96:99], v[48:51], a[128:131], v[96:99]
	ds_read_b128 v[44:47], v245 offset:27648
	v_mfma_f32_16x16x32_bf16 v[100:103], v[48:51], a[132:135], v[100:103]
	v_rsq_f32 v228, v169
	v_mfma_f32_16x16x32_bf16 v[104:107], v[52:55], a[128:131], v[104:107]
	ds_read_b128 v[48:51], v245 offset:28672
	v_mov_b32 v170, 0
	v_mfma_f32_16x16x32_bf16 v[108:111], v[52:55], a[132:135], v[108:111]
	v_mul_f32 v224, 0x3fb8aa3b, v228
	s_waitcnt vmcnt(8)
	v_mfma_f32_16x16x32_bf16 v[64:67], v[56:59], a[136:139], v[64:67]
	ds_read_b128 v[52:55], v245 offset:29696
	v_mul_f32 v225, 0xbfb8aa3b, v228
	v_mfma_f32_16x16x32_bf16 v[68:71], v[56:59], a[140:143], v[68:71]
	v_mfma_f32_16x16x32_bf16 v[72:75], v[60:63], a[136:139], v[72:75]
	ds_read_b128 v[56:59], v245 offset:30720
	v_mfma_f32_16x16x32_bf16 v[76:79], v[60:63], a[140:143], v[76:79]
	s_waitcnt lgkmcnt(3)
	v_mfma_f32_16x16x32_bf16 v[80:83], v[32:35], a[136:139], v[80:83]
	ds_read_b128 v[60:63], v245 offset:31744
	v_mfma_f32_16x16x32_bf16 v[84:87], v[32:35], a[140:143], v[84:87]
	v_mfma_f32_16x16x32_bf16 v[88:91], v[36:39], a[136:139], v[88:91]
	s_waitcnt vmcnt(0)
	s_barrier
	ds_read_b128 v[32:35], v2 offset:16384
	v_mfma_f32_16x16x32_bf16 v[92:95], v[36:39], a[140:143], v[92:95]
	v_mfma_f32_16x16x32_bf16 v[96:99], v[40:43], a[136:139], v[96:99]
	ds_read_b128 v[36:39], v2 offset:17408
	v_mfma_f32_16x16x32_bf16 v[100:103], v[40:43], a[140:143], v[100:103]
	v_mfma_f32_16x16x32_bf16 v[104:107], v[44:47], a[136:139], v[104:107]
	ds_read_b128 v[40:43], v2 offset:18432
	v_mfma_f32_16x16x32_bf16 v[108:111], v[44:47], a[140:143], v[108:111]
	s_waitcnt lgkmcnt(3)
	v_mfma_f32_16x16x32_bf16 v[64:67], v[48:51], a[144:147], v[64:67]
	ds_read_b128 v[44:47], v2 offset:19456
	v_mfma_f32_16x16x32_bf16 v[68:71], v[48:51], a[148:151], v[68:71]
	v_mfma_f32_16x16x32_bf16 v[72:75], v[52:55], a[144:147], v[72:75]
	ds_read_b128 v[48:51], v2 offset:20480
	v_mfma_f32_16x16x32_bf16 v[76:79], v[52:55], a[148:151], v[76:79]
	v_mfma_f32_16x16x32_bf16 v[80:83], v[56:59], a[144:147], v[80:83]
	ds_read_b128 v[52:55], v2 offset:21504
	v_mfma_f32_16x16x32_bf16 v[84:87], v[56:59], a[148:151], v[84:87]
	v_mfma_f32_16x16x32_bf16 v[88:91], v[60:63], a[144:147], v[88:91]
	ds_read_b128 v[56:59], v2 offset:22528
	v_mfma_f32_16x16x32_bf16 v[92:95], v[60:63], a[148:151], v[92:95]
	s_waitcnt lgkmcnt(3)
	v_mfma_f32_16x16x32_bf16 v[96:99], v[32:35], a[144:147], v[96:99]
	ds_read_b128 v[60:63], v2 offset:23552
	v_mfma_f32_16x16x32_bf16 v[100:103], v[32:35], a[148:151], v[100:103]
	v_mfma_f32_16x16x32_bf16 v[104:107], v[36:39], a[144:147], v[104:107]
	ds_read_b128 v[32:35], v2 offset:24576
	v_mfma_f32_16x16x32_bf16 v[108:111], v[36:39], a[148:151], v[108:111]
	v_mfma_f32_16x16x32_bf16 v[64:67], v[40:43], a[152:155], v[64:67]
	ds_read_b128 v[36:39], v2 offset:25600
	v_mfma_f32_16x16x32_bf16 v[68:71], v[40:43], a[156:159], v[68:71]
	v_mfma_f32_16x16x32_bf16 v[72:75], v[44:47], a[152:155], v[72:75]
	ds_read_b128 v[40:43], v2 offset:26624
	v_mfma_f32_16x16x32_bf16 v[76:79], v[44:47], a[156:159], v[76:79]
	s_waitcnt lgkmcnt(3)
	v_mfma_f32_16x16x32_bf16 v[80:83], v[48:51], a[152:155], v[80:83]
	ds_read_b128 v[44:47], v2 offset:27648
	v_mfma_f32_16x16x32_bf16 v[84:87], v[48:51], a[156:159], v[84:87]
	v_mfma_f32_16x16x32_bf16 v[88:91], v[52:55], a[152:155], v[88:91]
	ds_read_b128 v[48:51], v2 offset:28672
	v_mfma_f32_16x16x32_bf16 v[92:95], v[52:55], a[156:159], v[92:95]
	v_mfma_f32_16x16x32_bf16 v[96:99], v[56:59], a[152:155], v[96:99]
	ds_read_b128 v[52:55], v2 offset:29696
	v_mfma_f32_16x16x32_bf16 v[100:103], v[56:59], a[156:159], v[100:103]
	v_mfma_f32_16x16x32_bf16 v[104:107], v[60:63], a[152:155], v[104:107]
	ds_read_b128 v[56:59], v2 offset:30720
	v_mfma_f32_16x16x32_bf16 v[108:111], v[60:63], a[156:159], v[108:111]
	v_mfma_f32_16x16x32_bf16 v[64:67], a[176:179], v[184:187], v[64:67]
	v_mfma_f32_16x16x32_bf16 v[68:71], a[176:179], v[188:191], v[68:71]
	v_mfma_f32_16x16x32_bf16 v[72:75], a[178:181], v[184:187], v[72:75]
	v_mfma_f32_16x16x32_bf16 v[76:79], a[178:181], v[188:191], v[76:79]
	v_mfma_f32_16x16x32_bf16 v[80:83], a[180:183], v[184:187], v[80:83]
	v_mfma_f32_16x16x32_bf16 v[84:87], a[180:183], v[188:191], v[84:87]
	v_mfma_f32_16x16x32_bf16 v[88:91], a[182:185], v[184:187], v[88:91]
	v_mfma_f32_16x16x32_bf16 v[92:95], a[182:185], v[188:191], v[92:95]
	v_mfma_f32_16x16x32_bf16 v[96:99], a[184:187], v[184:187], v[96:99]
	v_mfma_f32_16x16x32_bf16 v[100:103], a[184:187], v[188:191], v[100:103]
	v_mfma_f32_16x16x32_bf16 v[104:107], a[186:189], v[184:187], v[104:107]
	v_mfma_f32_16x16x32_bf16 v[108:111], a[186:189], v[188:191], v[108:111]
	s_waitcnt vmcnt(0) lgkmcnt(0)
	s_branch L_join
L_final:
	v_cvt_pk_bf16_f32 v128, v12, v13
	v_cvt_pk_bf16_f32 v129, v14, v15
	v_cvt_pk_bf16_f32 v130, v16, v17
	v_cvt_pk_bf16_f32 v131, v18, v19
	v_cvt_pk_bf16_f32 v132, v20, v21
	v_cvt_pk_bf16_f32 v133, v22, v23
	v_cvt_pk_bf16_f32 v134, v24, v25
	v_cvt_pk_bf16_f32 v135, v26, v27
	v_cvt_pk_bf16_f32 v136, v28, v29
	v_cvt_pk_bf16_f32 v137, v30, v31
	buffer_store_dwordx4 v[128:131], v10, s[8:11], 0 offen
	buffer_store_dwordx4 v[132:135], v10, s[8:11], 0 offen offset:64
	buffer_store_dwordx2 v[136:137], v11, s[8:11], 0 offen
	s_or_b32 s71, s2, s44
	s_cmp_lg_u32 s71, 0
	s_cbranch_scc1 L_done
	s_mov_b64 exec, 1
	buffer_store_dword v244, off, s[4:7], 0 sc1
	s_mov_b64 exec, -1
L_done:
L_exit:
	s_endpgm
Lslow_6:
	s_mov_b64 exec, 0xffff
Lpoll_49:
	buffer_load_dword v250, v214, s[4:7], 0 offen sc1
	s_sub_u32 s69, s69, 1
	s_cselect_b32 s69, 0, s69
	s_cbranch_scc1 Lpolle_50
	s_waitcnt vmcnt(0)
	v_xor_b32 v250, s70, v250
	v_lshlrev_b32 v215, 4, v250
	v_cmp_ne_u32 vcc, 0, v215
	s_cbranch_vccnz Lpoll_49
Lpolle_50:
	s_waitcnt vmcnt(0)
	s_mov_b64 exec, -1
	s_nop 1
	s_branch Lslow_6r
Lslow_7:
	s_mov_b32 exec_lo, 0xffffffff
	s_mov_b32 exec_hi, 0xffffffff
Lpoll_52:
	buffer_load_dword v250, v220, s[4:7], 0 offen sc1
	s_sub_u32 s69, s69, 1
	s_cselect_b32 s69, 0, s69
	s_cbranch_scc1 Lpolle_53
	s_waitcnt vmcnt(0)
	v_cmp_ne_u32 vcc, s70, v250
	s_cbranch_vccnz Lpoll_52
Lpolle_53:
	s_waitcnt vmcnt(0)
	s_mov_b64 exec, -1
	s_nop 1
	s_branch Lslow_7r
Lslow_8:
	s_mov_b64 exec, 0xffffff
Lpoll_55:
	buffer_load_dword v250, v222, s[4:7], 0 offen sc1
	s_sub_u32 s69, s69, 1
	s_cselect_b32 s69, 0, s69
	s_cbranch_scc1 Lpolle_56
	s_waitcnt vmcnt(0)
	v_cmp_ne_u32 vcc, s70, v250
	s_cbranch_vccnz Lpoll_55
Lpolle_56:
	s_waitcnt vmcnt(0)
	s_mov_b64 exec, -1
	s_nop 1
	s_branch Lslow_8r
Lslow_35:
	s_mov_b64 exec, 0xffff
Lpoll_58:
	buffer_load_dword v250, v247, s[4:7], s71 offen sc1
	s_sub_u32 s69, s69, 1
	s_cselect_b32 s69, 0, s69
	s_cbranch_scc1 Lpolle_59
	s_waitcnt vmcnt(0)
	v_cmp_ne_u32 vcc, s70, v250
	s_cbranch_vccnz Lpoll_58
Lpolle_59:
	s_waitcnt vmcnt(0)
	s_mov_b64 exec, -1
	s_nop 1
	s_branch Lslow_35r
Lslow_38:
	s_mov_b64 exec, 0xffff
Lpoll_61:
	buffer_load_dword v250, v247, s[4:7], s71 offen sc1
	s_sub_u32 s69, s69, 1
	s_cselect_b32 s69, 0, s69
	s_cbranch_scc1 Lpolle_62
	s_waitcnt vmcnt(0)
	v_cmp_ne_u32 vcc, s70, v250
	s_cbranch_vccnz Lpoll_61
Lpolle_62:
	s_waitcnt vmcnt(0)
	s_mov_b64 exec, -1
	s_nop 1
	s_branch Lslow_38r
.fill 13400 - (. - interleave_layers__linear_kernel_hedgehog__glu_gated_reglu__prompt_kernel) / 4, 4, 0xbf800000
.section .rodata,"a"
.p2align 6
.amdhsa_kernel interleave_layers__linear_kernel_hedgehog__glu_gated_reglu__prompt_kernel
  .amdhsa_next_free_vgpr 512
  .amdhsa_next_free_sgpr 102
  .amdhsa_accum_offset 256
  .amdhsa_group_segment_fixed_size 0
  .amdhsa_kernarg_size 88
  .amdhsa_user_sgpr_count 2
  .amdhsa_user_sgpr_kernarg_segment_ptr 1
  .amdhsa_system_sgpr_workgroup_id_x 1
.end_amdhsa_kernel
```
